```python
import torch

def _softmax(x, axis=-1):
    return torch.softmax(x, dim=axis)

def _gelu(x):
    return torch.nn.functional.gelu(x, approximate='tanh')

def _silu(x):
    return torch.nn.functional.silu(x)

def _sigmoid(x):
    return torch.sigmoid(x)

def _layernorm(x, axis=-1, eps=1e-05):
    m = x.mean(dim=axis, keepdim=True)
    v = x.var(dim=axis, keepdim=True, unbiased=False)
    return (x - m) / torch.sqrt(v + eps)

def _scatter_add(tgt, idx, src, axis=0):
    return tgt.clone().index_add_(axis, idx, src)

def _segment_sum(src, seg, n):
    out = torch.zeros((n,) + src.shape[1:], dtype=src.dtype)
    return out.index_add_(0, seg, src)

def _pad(x, pw):
    flat = tuple((v for pair in reversed(pw) for v in pair))
    return torch.nn.functional.pad(x, flat)
kernel_name = 'adaLN_cond__ssm_conv_s4d__mixer_gmlp__prompt'

def setup_inputs():

    _w = lambda a: (lambda t: t.to(torch.bfloat16) if t.is_floating_point() else t)(torch.as_tensor(a))

    def _A_setup():
        Bsz, L, D, N = (1, 2048, 512, 128)
        return {'u': _w((lambda *s: torch.randn(*s, dtype=torch.bfloat16) * 0.05)(Bsz, L, D)), 'log_A_real': _w((lambda *s: torch.randn(*s, dtype=torch.bfloat16) * 3.2)(D, N) * 0.5), 'A_imag': _w((lambda *s: torch.randn(*s, dtype=torch.bfloat16) * 0.2)(D, N) * 3.14), 'C_real': _w((lambda *s: torch.randn(*s, dtype=torch.bfloat16) * 0.8)(D, N) / N ** 0.5), 'C_imag': _w((lambda *s: torch.randn(*s, dtype=torch.bfloat16) * 0.8)(D, N) / N ** 0.5), 'log_dt': _w((lambda *s: torch.randn(*s, dtype=torch.bfloat16) * 0.2)(D) * 0.5 - 4.0), 'D_skip': _w((lambda *s: torch.randn(*s, dtype=torch.bfloat16) * 0.2)(D))}
    _A_in = _A_setup()

    def _B_setup():
        B, S, D, F = (1, 2048, 512, 1376)
        Fh = F // 2
        return {'x': _w((lambda *s: torch.randn(*s, dtype=torch.bfloat16) * 0.05)(B, S, D)), 'w_in': _w((lambda *s: torch.randn(*s, dtype=torch.bfloat16) * 0.4)(D, 2 * Fh)), 'w_sp': _w(0.01 * (lambda *s: torch.randn(*s, dtype=torch.bfloat16) * 0.4)(S, S)), 'b_sp': _w(1.0 + 0.01 * (lambda *s: torch.randn(*s, dtype=torch.bfloat16) * 0.05)(S)), 'w_out': _w((lambda *s: torch.randn(*s, dtype=torch.bfloat16) * 0.05)(Fh, D))}
    _B_in = _B_setup()
    return {'A_u': _A_in['u'], 'A_log_A_real': _A_in['log_A_real'], 'A_A_imag': _A_in['A_imag'], 'A_C_real': _A_in['C_real'], 'A_C_imag': _A_in['C_imag'], 'A_log_dt': _A_in['log_dt'], 'A_D_skip': _A_in['D_skip'], 'B_x': _B_in['x'], 'B_w_in': _B_in['w_in'], 'B_w_sp': _B_in['w_sp'], 'B_b_sp': _B_in['b_sp'], 'B_w_out': _B_in['w_out'], 'c': _w((lambda *s: torch.randn(*s, dtype=torch.bfloat16) * 0.2)(1, 512) * 8.0), 'w_mod': _w((lambda *s: torch.randn(*s, dtype=torch.bfloat16) * 0.2)(512, 6 * 512) * 512 ** (-0.5) * 8.0)}

def reference(A_u, A_log_A_real, A_A_imag, A_C_real, A_C_imag, A_log_dt, A_D_skip, B_x, B_w_in, B_w_sp, B_b_sp, B_w_out, c, w_mod):

    def _A_ref(u, log_A_real, A_imag, C_real, C_imag, log_dt, D_skip):
        L = u.shape[1]
        dt = torch.exp(log_dt)
        A = -torch.exp(log_A_real) + 1j * A_imag
        C = (C_real + 1j * C_imag) * dt[:, None]
        pos = (lambda x, dt: x.to(dt))(torch.arange(L), log_dt.dtype)
        P = torch.exp((A * dt[:, None])[:, :, None] * pos[None, None, :])
        K = 2.0 * torch.einsum('dn,dnl->dl', C, P).real
        L2 = 2 * L
        u_t = (lambda x, *d: x.permute(*d))(u, 0, 2, 1)
        Kf = (lambda x, *a, **k: torch.fft.rfft(x.float(), *a, **k))(K, L2)
        Uf = (lambda x, *a, **k: torch.fft.rfft(x.float(), *a, **k))(u_t, L2)
        y = (lambda x, *a, **k: torch.fft.irfft(x, *a, **k).to(torch.bfloat16))(Uf * Kf[None, :, :], L2)[:, :, :L]
        y = (lambda x, *d: x.permute(*d))(y, 0, 2, 1)
        return y + u * D_skip[None, None, :]

    def _B_ref(x, w_in, w_sp, b_sp, w_out):
        B, S, D = x.shape
        F = w_in.shape[-1]
        Fh = F // 2
        z = _gelu(torch.einsum('bsd,df->bsf', x, w_in))
        z1 = z[..., :Fh].clone()
        z2 = _layernorm(z[..., Fh:], axis=-1)
        g = torch.einsum('ts,bsf->btf', w_sp, z2) + b_sp[None, :, None]
        return torch.einsum('bsf,fd->bsd', z1 * g, w_out)
    x = A_u
    mod = (_silu(c) @ w_mod).reshape(c.shape[0], 6, 1, -1)
    sa, ca, ga, sb, cb, gb = (mod[:, 0].clone(), mod[:, 1].clone(), mod[:, 2].clone(), mod[:, 3].clone(), mod[:, 4].clone(), mod[:, 5].clone())
    h = _layernorm(x, axis=-1) * (1 + ca) + sa
    x = x + ga * _A_ref(h, A_log_A_real, A_A_imag, A_C_real, A_C_imag, A_log_dt, A_D_skip)
    h = _layernorm(x, axis=-1) * (1 + cb) + sb
    x = x + gb * _B_ref(h, B_w_in, B_w_sp, B_b_sp, B_w_out)
    return x
```

```asm
; @launch kernel=f1_kernel grid=(624,1,1) block=(256,1,1) lds=51712
; @launch kernel=g123_kernel grid=(256,1,1) block=(256,1,1) lds=159744
.amdgcn_target "amdgcn-amd-amdhsa--gfx950"
.text
.globl f1_kernel
.p2align 8
.type f1_kernel,@function
f1_kernel:
  s_cmp_ge_u32 s2, 8
  s_cbranch_scc1 F_GO
  s_getpc_b64 s[4:5]
F_PC:
  v_lshlrev_b32 v1, 7, v0
  v_min_u32 v2, G_CODE_END-F_PC-4, v1
  global_load_dword v3, v2, s[4:5]
  v_add_u32 v1, 32768, v1
  v_min_u32 v2, G_CODE_END-F_PC-4, v1
  global_load_dword v4, v2, s[4:5]
  s_endpgm
F_GO:
  s_sub_u32 s2, s2, 8
  s_load_dword s78, s[0:1], 0
  s_load_dword s79, s[0:1], 64
  s_load_dword s69, s[0:1], 128
  v_and_b32 v1, 63, v0
  v_lshrrev_b32 v2, 6, v0
  s_nop 0
  v_readfirstlane_b32 s20, v2
  s_cmp_ge_u32 s2, 616
  s_cbranch_scc1 F_END
  s_cmp_ge_u32 s2, 568
  s_cbranch_scc1 F_WOUT
  s_cmp_ge_u32 s2, 480
  s_cbranch_scc1 F_PACK
  s_cmp_ge_u32 s2, 384
  s_cbranch_scc1 F_MOD
  s_cmp_ge_u32 s2, 256
  s_cbranch_scc1 F_X
  s_load_dwordx2 s[24:25], s[0:1], 8
  s_load_dwordx2 s[28:29], s[0:1], 16
  s_load_dwordx2 s[32:33], s[0:1], 24
  s_load_dwordx2 s[36:37], s[0:1], 32
  s_load_dwordx2 s[40:41], s[0:1], 40
  s_load_dwordx2 s[44:45], s[0:1], 128
  s_load_dwordx2 s[48:49], s[0:1], 72
  s_load_dwordx2 s[52:53], s[0:1], 0
  s_load_dwordx2 s[56:57], s[0:1], 120
  s_load_dwordx2 s[60:61], s[0:1], 48
  s_sub_u32 s68, s2, 0
  s_setprio 3
  s_lshr_b32 s21, s20, 1
  s_and_b32 s23, s20, 1
  s_and_b32 s19, s68, 7
  s_lshl_b32 s19, s19, 5
  s_lshr_b32 s6, s68, 3
  s_add_u32 s19, s19, s6
  s_lshl_b32 s22, s19, 1
  s_add_u32 s22, s22, s21
  s_lshl_b32 s4, s22, 8
  s_lshl_b32 s5, s23, 7
  v_lshlrev_b32 v2, 1, v1
  v_add_u32 v2, s5, v2
  v_xor_b32 v3, 128, v2
  s_lshl_b32 s6, s22, 1
  v_mov_b32 v4, s6
  s_waitcnt lgkmcnt(0)
  s_mov_b32 s26, 0x20000
  s_mov_b32 s27, 0x20000
  s_mov_b32 s30, 0x20000
  s_mov_b32 s31, 0x20000
  s_mov_b32 s34, 0x20000
  s_mov_b32 s35, 0x20000
  s_mov_b32 s38, 0x20000
  s_mov_b32 s39, 0x20000
  s_mov_b32 s42, 0x400
  s_mov_b32 s43, 0x20000
  buffer_load_ushort v10, v4, s[40:43], 0 offen
  buffer_load_ushort v11, v2, s[24:27], s4 offen
  buffer_load_ushort v12, v2, s[28:31], s4 offen
  buffer_load_ushort v13, v2, s[32:35], s4 offen
  buffer_load_ushort v14, v2, s[36:39], s4 offen
  buffer_load_ushort v15, v3, s[32:35], s4 offen
  buffer_load_ushort v16, v3, s[36:39], s4 offen
  s_setprio 0
  s_mov_b32 s46, 0x2000000
  s_mov_b32 s47, 0x20000
  s_mov_b32 s50, 0x800000
  s_mov_b32 s51, 0x20000
  s_mov_b32 s54, 0x200000
  s_mov_b32 s55, 0x20000
  s_mov_b32 s58, 0x100
  s_mov_b32 s59, 0x20000
  s_mov_b32 s62, 0x400
  s_mov_b32 s63, 0x20000
  buffer_load_ushort v49, v4, s[60:63], 0 offen
  v_mov_b32 v56, -1
  v_mov_b32 v57, -1
  v_lshlrev_b32 v58, 3, v1
  s_lshl_b32 s16, s68, 9
  s_add_u32 s16, s16, 65536
  buffer_store_dwordx2 v[56:57], v58, s[44:47], s16 offen sc1
  s_mul_i32 s7, s20, 9248
  v_lshl_add_u32 v5, v1, 2, s7
  v_and_b32 v6, 15, v1
  v_lshrrev_b32 v7, 4, v1
  v_lshl_add_u32 v9, v7, 4, s7
  v_mul_u32_u24 v8, 272, v6
  v_add_u32 v8, v8, v9
  v_mov_b32 v92, 0
  v_mov_b32 v93, 0
  v_mov_b32 v94, 0
  v_mov_b32 v95, 0
  v_mov_b32 v96, 0
  v_mov_b32 v97, 0
  v_mov_b32 v98, 0
  v_mov_b32 v99, 0
  v_mov_b32 v100, 0
  v_mov_b32 v101, 0
  v_mov_b32 v102, 0
  v_mov_b32 v103, 0
  v_mov_b32 v104, 0
  v_mov_b32 v105, 0
  v_mov_b32 v106, 0
  v_mov_b32 v107, 0
  s_mul_i32 s15, s21, 1536
  s_add_u32 s15, s15, 48656
  v_mov_b32 v55, s15
  v_subrev_u32 v55, 8, v55
  ds_write_b64 v55, v[92:93]
  v_lshlrev_b32 v22, 7, v7
  v_lshl_add_u32 v22, v6, 3, v22
  v_add_u32 v22, s15, v22
  v_cmp_gt_u32 vcc, 2, v7
  v_lshlrev_b32 v23, 1, v6
  v_lshlrev_b32 v24, 2, v6
  v_cndmask_b32 v23, v23, v24, vcc
  v_lshl_add_u32 v23, v7, 7, v23
  v_add_u32 v23, s15, v23
  v_mov_b32 v24, 32
  v_cndmask_b32 v24, v24, 2, vcc
  v_add_u32 v24, v24, v23
  v_lshlrev_b32 v25, 6, v7
  v_add_u32 v25, v25, v6
  v_add_u32 v25, s15, v25
  v_add_u32 v26, s15, v6
  s_lshl_b32 s16, s23, 6
  v_add_u32 v29, s16, v1
  v_lshlrev_b32 v60, 4, v29
  v_sub_u32 v60, 2047, v60
  v_cvt_f32_u32 v61, v60
  v_lshl_add_u32 v60, v60, 1, s15
  s_add_u32 s16, s15, 256
  s_sub_u32 s17, s15, 0x8500
  v_subrev_f32 v62, 0x00000000, v61
  v_subrev_f32 v63, 0x3f800000, v61
  v_cvt_pk_bf16_f32 v62, v62, v63
  v_lshrrev_b32 v63, 16, v62
  v_and_b32 v62, 0xffff, v62
  v_lshl_add_u32 v62, v62, 1, s17
  v_subrev_u32 v64, 0, v60
  v_med3_i32 v108, v62, v64, s16
  v_lshl_add_u32 v63, v63, 1, s17
  v_subrev_u32 v64, 2, v60
  v_med3_i32 v109, v63, v64, s16
  v_subrev_f32 v62, 0x40000000, v61
  v_subrev_f32 v63, 0x40400000, v61
  v_cvt_pk_bf16_f32 v62, v62, v63
  v_lshrrev_b32 v63, 16, v62
  v_and_b32 v62, 0xffff, v62
  v_lshl_add_u32 v62, v62, 1, s17
  v_subrev_u32 v64, 4, v60
  v_med3_i32 v110, v62, v64, s16
  v_lshl_add_u32 v63, v63, 1, s17
  v_subrev_u32 v64, 6, v60
  v_med3_i32 v111, v63, v64, s16
  v_subrev_f32 v62, 0x40800000, v61
  v_subrev_f32 v63, 0x40a00000, v61
  v_cvt_pk_bf16_f32 v62, v62, v63
  v_lshrrev_b32 v63, 16, v62
  v_and_b32 v62, 0xffff, v62
  v_lshl_add_u32 v62, v62, 1, s17
  v_subrev_u32 v64, 8, v60
  v_med3_i32 v112, v62, v64, s16
  v_lshl_add_u32 v63, v63, 1, s17
  v_subrev_u32 v64, 10, v60
  v_med3_i32 v113, v63, v64, s16
  v_subrev_f32 v62, 0x40c00000, v61
  v_subrev_f32 v63, 0x40e00000, v61
  v_cvt_pk_bf16_f32 v62, v62, v63
  v_lshrrev_b32 v63, 16, v62
  v_and_b32 v62, 0xffff, v62
  v_lshl_add_u32 v62, v62, 1, s17
  v_subrev_u32 v64, 12, v60
  v_med3_i32 v114, v62, v64, s16
  v_lshl_add_u32 v63, v63, 1, s17
  v_subrev_u32 v64, 14, v60
  v_med3_i32 v115, v63, v64, s16
  v_subrev_f32 v62, 0x41000000, v61
  v_subrev_f32 v63, 0x41100000, v61
  v_cvt_pk_bf16_f32 v62, v62, v63
  v_lshrrev_b32 v63, 16, v62
  v_and_b32 v62, 0xffff, v62
  v_lshl_add_u32 v62, v62, 1, s17
  v_subrev_u32 v64, 16, v60
  v_med3_i32 v116, v62, v64, s16
  v_lshl_add_u32 v63, v63, 1, s17
  v_subrev_u32 v64, 18, v60
  v_med3_i32 v117, v63, v64, s16
  v_subrev_f32 v62, 0x41200000, v61
  v_subrev_f32 v63, 0x41300000, v61
  v_cvt_pk_bf16_f32 v62, v62, v63
  v_lshrrev_b32 v63, 16, v62
  v_and_b32 v62, 0xffff, v62
  v_lshl_add_u32 v62, v62, 1, s17
  v_subrev_u32 v64, 20, v60
  v_med3_i32 v118, v62, v64, s16
  v_lshl_add_u32 v63, v63, 1, s17
  v_subrev_u32 v64, 22, v60
  v_med3_i32 v119, v63, v64, s16
  v_subrev_f32 v62, 0x41400000, v61
  v_subrev_f32 v63, 0x41500000, v61
  v_cvt_pk_bf16_f32 v62, v62, v63
  v_lshrrev_b32 v63, 16, v62
  v_and_b32 v62, 0xffff, v62
  v_lshl_add_u32 v62, v62, 1, s17
  v_subrev_u32 v64, 24, v60
  v_med3_i32 v120, v62, v64, s16
  v_lshl_add_u32 v63, v63, 1, s17
  v_subrev_u32 v64, 26, v60
  v_med3_i32 v121, v63, v64, s16
  v_subrev_f32 v62, 0x41600000, v61
  v_subrev_f32 v63, 0x41700000, v61
  v_cvt_pk_bf16_f32 v62, v62, v63
  v_lshrrev_b32 v63, 16, v62
  v_and_b32 v62, 0xffff, v62
  v_lshl_add_u32 v62, v62, 1, s17
  v_subrev_u32 v64, 28, v60
  v_med3_i32 v122, v62, v64, s16
  v_lshl_add_u32 v63, v63, 1, s17
  v_subrev_u32 v64, 30, v60
  v_med3_i32 v123, v63, v64, s16
  v_subrev_f32 v62, 0x41800000, v61
  v_subrev_f32 v63, 0x41880000, v61
  v_max_f32 v62, 0, v62
  v_max_f32 v63, 0, v63
  v_cvt_pk_bf16_f32 v62, v62, v63
  v_lshrrev_b32 v63, 16, v62
  v_and_b32 v62, 0xffff, v62
  v_lshl_add_u32 v62, v62, 1, s17
  v_subrev_u32 v64, 32, v60
  v_med3_i32 v124, v62, v64, s16
  v_lshl_add_u32 v63, v63, 1, s17
  v_subrev_u32 v64, 34, v60
  v_med3_i32 v125, v63, v64, s16
  v_subrev_f32 v62, 0x41900000, v61
  v_subrev_f32 v63, 0x41980000, v61
  v_max_f32 v62, 0, v62
  v_max_f32 v63, 0, v63
  v_cvt_pk_bf16_f32 v62, v62, v63
  v_lshrrev_b32 v63, 16, v62
  v_and_b32 v62, 0xffff, v62
  v_lshl_add_u32 v62, v62, 1, s17
  v_subrev_u32 v64, 36, v60
  v_med3_i32 v126, v62, v64, s16
  s_mul_i32 s14, s21, 16640
  v_lshl_add_u32 v29, v29, 5, s14
  v_lshlrev_b32 v18, 4, v1
  v_add_u32 v27, s7, v18
  s_xor_b32 s18, s20, 1
  s_mul_i32 s18, s18, 9248
  v_add_u32 v28, s18, v18
  v_lshlrev_b32 v139, 4, v1
  v_and_b32 v128, 31, v1
  v_lshrrev_b32 v129, 5, v1
  v_and_b32 v130, 3, v128
  v_sub_u32 v130, 3, v130
  v_mul_u32_u24 v130, 4160, v130
  v_lshrrev_b32 v140, 2, v128
  v_lshlrev_b32 v140, 3, v140
  v_sub_u32 v130, v130, v140
  v_lshl_add_u32 v130, v129, 4, v130
  s_lshl_b32 s99, s23, 5
  s_add_u32 s98, s14, s99
  s_add_u32 s98, s98, 56
  v_add_u32 v130, s98, v130
  v_mul_u32_u24 v140, 80, v128
  v_lshl_add_u32 v131, v129, 4, v140
  s_mul_i32 s100, s21, 7680
  s_add_u32 s98, s100, s99
  s_add_u32 s98, s98, 33280
  v_add_u32 v131, s98, v131
  v_lshl_add_u32 v132, v129, 3, v140
  s_mul_i32 s98, s23, 2560
  s_add_u32 s98, s98, s100
  s_add_u32 s98, s98, 35760
  v_add_u32 v132, s98, v132
  v_lshlrev_b32 v137, 8, v128
  v_lshl_add_u32 v137, v129, 3, v137
  v_lshrrev_b32 v133, 3, v0
  v_mul_u32_u24 v133, 80, v133
  v_bfe_u32 v141, v0, 1, 2
  v_lshl_add_u32 v133, v141, 4, v133
  v_and_b32 v141, 1, v0
  v_mul_u32_u24 v142, 7680, v141
  v_add_u32 v133, v133, v142
  v_cmp_eq_u32 s[64:65], 1, v141
  v_lshrrev_b32 v134, 1, v0
  v_lshlrev_b32 v134, 6, v134
  v_lshl_add_u32 v134, v141, 4, v134
  s_lshr_b32 s10, s19, 1
  s_lshl_b32 s10, s10, 14
  s_and_b32 s11, s19, 1
  s_lshl_b32 s11, s11, 5
  s_add_u32 s10, s10, s11
  s_add_u32 s11, s10, 1048576
  s_add_u32 s10, s10, 1048576
  v_lshrrev_b32 v135, 1, v0
  v_lshlrev_b32 v135, 5, v135
  s_mov_b32 s96, 3145728
  s_mov_b32 s97, 3149824
  s_lshl_b32 s13, s23, 13
  s_add_u32 s11, s11, s13
  s_lshl_b32 s13, s21, 4
  s_add_u32 s11, s11, s13
  v_lshrrev_b32 v136, 2, v1
  v_lshlrev_b32 v136, 11, v136
  v_and_b32 v143, 3, v1
  v_mul_u32_u24 v143, 12288, v143
  v_add_u32 v136, v136, v143
  s_lshl_b32 s12, s19, 3
  s_add_u32 s12, s12, 262144
  s_and_b32 s66, s68, 7
  s_lshl_b32 s66, s66, 8
  s_lshr_b32 s67, s68, 3
  s_lshl_b32 s67, s67, 3
  s_add_u32 s66, s66, s67
  s_lshl_b32 s67, s20, 1
  s_add_u32 s66, s66, s67
  s_lshl_b32 s66, s66, 12
  v_lshlrev_b32 v138, 7, v1
  v_lshrrev_b32 v144, 7, v0
  v_mul_u32_u24 v144, 7680, v144
  v_and_b32 v145, 127, v0
  v_add_u32 v146, 128, v145
  v_min_u32 v146, 154, v146
  v_lshl_add_u32 v145, v145, 4, v144
  v_lshl_add_u32 v146, v146, 4, v144
  v_bfe_u32 v144, v0, 2, 3
  v_mul_u32_u24 v144, 4160, v144
  v_and_b32 v147, 3, v0
  v_lshl_add_u32 v144, v147, 4, v144
  s_waitcnt vmcnt(6)
  v_lshlrev_b32 v10, 16, v10
  v_lshlrev_b32 v11, 16, v11
  v_lshlrev_b32 v12, 16, v12
  v_mul_f32 v20, 0x3fb8aa3b, v10
  v_mov_b32 v21, 0x3fb8aa3b
  v_fma_f32 v21, v10, v21, -v20
  v_fmac_f32 v21, 0x32a57060, v10
  v_exp_f32 v20, v20
  v_mul_f32 v21, 0x3f317218, v21
  v_fma_f32 v10, v20, v21, v20
  v_cvt_pk_bf16_f32 v10, v10, v10
  v_and_b32 v10, 0xffff0000, v10
  v_mul_f32 v20, 0x3fb8aa3b, v11
  v_mov_b32 v21, 0x3fb8aa3b
  v_fma_f32 v21, v11, v21, -v20
  v_fmac_f32 v21, 0x32a57060, v11
  v_exp_f32 v20, v20
  v_mul_f32 v21, 0x3f317218, v21
  v_fma_f32 v11, v20, v21, v20
  v_cvt_pk_bf16_f32 v11, v11, v11
  v_and_b32 v11, 0xffff0000, v11
  v_mul_f32 v11, v11, v10
  v_mul_f32 v12, v12, v10
  v_mul_f32 v11, 0xbfb8aa3b, v11
  v_mul_f32 v12, 0x3e22f983, v12
  v_exp_f32 v20, v11
  v_fract_f32 v21, v12
  v_cos_f32 v30, v21
  v_sin_f32 v31, v21
  v_mul_f32 v30, v30, v20
  v_mul_f32 v31, v31, v20
  v_mul_f32 v20, 0x40800000, v11
  v_mul_f32 v21, 0x40800000, v12
  v_exp_f32 v20, v20
  v_fract_f32 v21, v21
  v_cos_f32 v36, v21
  v_sin_f32 v37, v21
  v_mul_f32 v36, v36, v20
  v_mul_f32 v37, v37, v20
  v_mul_f32 v20, 0x42800000, v11
  v_mul_f32 v21, 0x42800000, v12
  v_exp_f32 v20, v20
  v_fract_f32 v21, v21
  v_cos_f32 v38, v21
  v_sin_f32 v39, v21
  v_mul_f32 v38, v38, v20
  v_mul_f32 v39, v39, v20
  v_mul_f32 v20, 0x44800000, v11
  v_mul_f32 v21, 0x44800000, v12
  v_exp_f32 v20, v20
  v_fract_f32 v21, v21
  v_cos_f32 v40, v21
  v_sin_f32 v41, v21
  v_mul_f32 v40, v40, v20
  v_mul_f32 v41, v41, v20
  v_pk_mul_f32 v[32:33], v[30:31], v[30:31] op_sel_hi:[1,0]
  v_pk_fma_f32 v[32:33], v[30:31], v[30:31], v[32:33] op_sel:[1,1,0] op_sel_hi:[0,1,1] neg_lo:[1,0,0]
  v_pk_mul_f32 v[34:35], v[32:33], v[30:31] op_sel_hi:[1,0]
  v_pk_fma_f32 v[34:35], v[32:33], v[30:31], v[34:35] op_sel:[1,1,0] op_sel_hi:[0,1,1] neg_lo:[1,0,0]
  s_waitcnt vmcnt(1)
  v_and_b32 v17, 0x7fff, v13
  v_and_b32 v19, 0x7fff, v14
  v_and_b32 v15, 0x7fff, v15
  v_and_b32 v16, 0x7fff, v16
  v_max3_u32 v17, v17, v19, v15
  v_max_u32 v17, v17, v16
  s_nop 1
  v_max_u32_dpp v17, v17, v17 row_shr:1 row_mask:0xf bank_mask:0xf
  s_nop 1
  v_max_u32_dpp v17, v17, v17 row_shr:2 row_mask:0xf bank_mask:0xf
  s_nop 1
  v_max_u32_dpp v17, v17, v17 row_shr:4 row_mask:0xf bank_mask:0xf
  s_nop 1
  v_max_u32_dpp v17, v17, v17 row_shr:8 row_mask:0xf bank_mask:0xf
  s_nop 1
  v_max_u32_dpp v17, v17, v17 row_bcast:15 row_mask:0xa bank_mask:0xf
  s_nop 1
  v_max_u32_dpp v17, v17, v17 row_bcast:31 row_mask:0xc bank_mask:0xf
  s_nop 0
  v_readlane_b32 s8, v17, 63
  s_nop 0
  s_lshl_b32 s8, s8, 16
  s_and_b32 s8, s8, 0x7f800000
  s_min_u32 s8, s8, 0x7e800000
  s_sub_u32 s9, 0x7f000000, s8
  v_lshlrev_b32 v13, 16, v13
  v_lshlrev_b32 v14, 16, v14
  v_mul_f32 v42, s9, v13
  v_mul_f32 v43, s9, v14
  v_mul_f32 v48, s8, v10
  v_add_f32 v48, v48, v48
  v_cvt_pk_f16_f32 v50, v42, -v43
  ds_write_b32 v5, v50 offset:0
  v_pk_mul_f32 v[44:45], v[42:43], v[36:37] op_sel_hi:[1,0]
  v_pk_fma_f32 v[44:45], v[42:43], v[36:37], v[44:45] op_sel:[1,1,0] op_sel_hi:[0,1,1] neg_lo:[1,0,0]
  v_cvt_pk_f16_f32 v51, v44, -v45
  ds_write_b32 v5, v51 offset:272
  v_pk_mul_f32 v[42:43], v[44:45], v[36:37] op_sel_hi:[1,0]
  v_pk_fma_f32 v[42:43], v[44:45], v[36:37], v[42:43] op_sel:[1,1,0] op_sel_hi:[0,1,1] neg_lo:[1,0,0]
  v_cvt_pk_f16_f32 v52, v42, -v43
  ds_write_b32 v5, v52 offset:544
  v_pk_mul_f32 v[44:45], v[42:43], v[36:37] op_sel_hi:[1,0]
  v_pk_fma_f32 v[44:45], v[42:43], v[36:37], v[44:45] op_sel:[1,1,0] op_sel_hi:[0,1,1] neg_lo:[1,0,0]
  v_cvt_pk_f16_f32 v53, v44, -v45
  ds_write_b32 v5, v53 offset:816
  v_pk_mul_f32 v[42:43], v[44:45], v[36:37] op_sel_hi:[1,0]
  v_pk_fma_f32 v[42:43], v[44:45], v[36:37], v[42:43] op_sel:[1,1,0] op_sel_hi:[0,1,1] neg_lo:[1,0,0]
  v_cvt_pk_f16_f32 v54, v42, -v43
  ds_write_b32 v5, v54 offset:1088
  v_pk_mul_f32 v[44:45], v[42:43], v[36:37] op_sel_hi:[1,0]
  v_pk_fma_f32 v[44:45], v[42:43], v[36:37], v[44:45] op_sel:[1,1,0] op_sel_hi:[0,1,1] neg_lo:[1,0,0]
  v_cvt_pk_f16_f32 v55, v44, -v45
  ds_write_b32 v5, v55 offset:1360
  v_pk_mul_f32 v[42:43], v[44:45], v[36:37] op_sel_hi:[1,0]
  v_pk_fma_f32 v[42:43], v[44:45], v[36:37], v[42:43] op_sel:[1,1,0] op_sel_hi:[0,1,1] neg_lo:[1,0,0]
  v_cvt_pk_f16_f32 v56, v42, -v43
  ds_write_b32 v5, v56 offset:1632
  v_pk_mul_f32 v[44:45], v[42:43], v[36:37] op_sel_hi:[1,0]
  v_pk_fma_f32 v[44:45], v[42:43], v[36:37], v[44:45] op_sel:[1,1,0] op_sel_hi:[0,1,1] neg_lo:[1,0,0]
  v_cvt_pk_f16_f32 v57, v44, -v45
  ds_write_b32 v5, v57 offset:1904
  v_pk_mul_f32 v[42:43], v[44:45], v[36:37] op_sel_hi:[1,0]
  v_pk_fma_f32 v[42:43], v[44:45], v[36:37], v[42:43] op_sel:[1,1,0] op_sel_hi:[0,1,1] neg_lo:[1,0,0]
  v_cvt_pk_f16_f32 v50, v42, -v43
  ds_write_b32 v5, v50 offset:2176
  v_pk_mul_f32 v[44:45], v[42:43], v[36:37] op_sel_hi:[1,0]
  v_pk_fma_f32 v[44:45], v[42:43], v[36:37], v[44:45] op_sel:[1,1,0] op_sel_hi:[0,1,1] neg_lo:[1,0,0]
  v_cvt_pk_f16_f32 v51, v44, -v45
  ds_write_b32 v5, v51 offset:2448
  v_pk_mul_f32 v[42:43], v[44:45], v[36:37] op_sel_hi:[1,0]
  v_pk_fma_f32 v[42:43], v[44:45], v[36:37], v[42:43] op_sel:[1,1,0] op_sel_hi:[0,1,1] neg_lo:[1,0,0]
  v_cvt_pk_f16_f32 v52, v42, -v43
  ds_write_b32 v5, v52 offset:2720
  v_pk_mul_f32 v[44:45], v[42:43], v[36:37] op_sel_hi:[1,0]
  v_pk_fma_f32 v[44:45], v[42:43], v[36:37], v[44:45] op_sel:[1,1,0] op_sel_hi:[0,1,1] neg_lo:[1,0,0]
  v_cvt_pk_f16_f32 v53, v44, -v45
  ds_write_b32 v5, v53 offset:2992
  v_pk_mul_f32 v[42:43], v[44:45], v[36:37] op_sel_hi:[1,0]
  v_pk_fma_f32 v[42:43], v[44:45], v[36:37], v[42:43] op_sel:[1,1,0] op_sel_hi:[0,1,1] neg_lo:[1,0,0]
  v_cvt_pk_f16_f32 v54, v42, -v43
  ds_write_b32 v5, v54 offset:3264
  v_pk_mul_f32 v[44:45], v[42:43], v[36:37] op_sel_hi:[1,0]
  v_pk_fma_f32 v[44:45], v[42:43], v[36:37], v[44:45] op_sel:[1,1,0] op_sel_hi:[0,1,1] neg_lo:[1,0,0]
  v_cvt_pk_f16_f32 v55, v44, -v45
  ds_write_b32 v5, v55 offset:3536
  v_pk_mul_f32 v[42:43], v[44:45], v[36:37] op_sel_hi:[1,0]
  v_pk_fma_f32 v[42:43], v[44:45], v[36:37], v[42:43] op_sel:[1,1,0] op_sel_hi:[0,1,1] neg_lo:[1,0,0]
  v_cvt_pk_f16_f32 v56, v42, -v43
  ds_write_b32 v5, v56 offset:3808
  v_pk_mul_f32 v[44:45], v[42:43], v[36:37] op_sel_hi:[1,0]
  v_pk_fma_f32 v[44:45], v[42:43], v[36:37], v[44:45] op_sel:[1,1,0] op_sel_hi:[0,1,1] neg_lo:[1,0,0]
  v_cvt_pk_f16_f32 v57, v44, -v45
  ds_write_b32 v5, v57 offset:4080
  ds_read_b128 v[60:63], v8 offset:0
  ds_read_b128 v[64:67], v8 offset:64
  ds_read_b128 v[68:71], v8 offset:128
  ds_read_b128 v[72:75], v8 offset:192
  v_mov_b32 v42, 1.0
  v_mov_b32 v43, 0
  v_cvt_pk_f16_f32 v50, v42, v43
  ds_write_b32 v5, v50 offset:4624
  v_cvt_pk_f16_f32 v51, v30, v31
  ds_write_b32 v5, v51 offset:4896
  v_cvt_pk_f16_f32 v52, v32, v33
  ds_write_b32 v5, v52 offset:5168
  v_cvt_pk_f16_f32 v53, v34, v35
  ds_write_b32 v5, v53 offset:5440
  v_cvt_pk_f16_f32 v54, v38, v39
  ds_write_b32 v5, v54 offset:5712
  v_pk_mul_f32 v[46:47], v[38:39], v[30:31] op_sel_hi:[1,0]
  v_pk_fma_f32 v[46:47], v[38:39], v[30:31], v[46:47] op_sel:[1,1,0] op_sel_hi:[0,1,1] neg_lo:[1,0,0]
  v_cvt_pk_f16_f32 v55, v46, v47
  ds_write_b32 v5, v55 offset:5984
  v_pk_mul_f32 v[46:47], v[38:39], v[32:33] op_sel_hi:[1,0]
  v_pk_fma_f32 v[46:47], v[38:39], v[32:33], v[46:47] op_sel:[1,1,0] op_sel_hi:[0,1,1] neg_lo:[1,0,0]
  v_cvt_pk_f16_f32 v56, v46, v47
  ds_write_b32 v5, v56 offset:6256
  v_pk_mul_f32 v[46:47], v[38:39], v[34:35] op_sel_hi:[1,0]
  v_pk_fma_f32 v[46:47], v[38:39], v[34:35], v[46:47] op_sel:[1,1,0] op_sel_hi:[0,1,1] neg_lo:[1,0,0]
  v_cvt_pk_f16_f32 v57, v46, v47
  ds_write_b32 v5, v57 offset:6528
  v_pk_mul_f32 v[42:43], v[38:39], v[38:39] op_sel_hi:[1,0]
  v_pk_fma_f32 v[42:43], v[38:39], v[38:39], v[42:43] op_sel:[1,1,0] op_sel_hi:[0,1,1] neg_lo:[1,0,0]
  v_cvt_pk_f16_f32 v50, v42, v43
  ds_write_b32 v5, v50 offset:6800
  v_pk_mul_f32 v[46:47], v[42:43], v[30:31] op_sel_hi:[1,0]
  v_pk_fma_f32 v[46:47], v[42:43], v[30:31], v[46:47] op_sel:[1,1,0] op_sel_hi:[0,1,1] neg_lo:[1,0,0]
  v_cvt_pk_f16_f32 v51, v46, v47
  ds_write_b32 v5, v51 offset:7072
  v_pk_mul_f32 v[46:47], v[42:43], v[32:33] op_sel_hi:[1,0]
  v_pk_fma_f32 v[46:47], v[42:43], v[32:33], v[46:47] op_sel:[1,1,0] op_sel_hi:[0,1,1] neg_lo:[1,0,0]
  v_cvt_pk_f16_f32 v52, v46, v47
  ds_write_b32 v5, v52 offset:7344
  v_pk_mul_f32 v[46:47], v[42:43], v[34:35] op_sel_hi:[1,0]
  v_pk_fma_f32 v[46:47], v[42:43], v[34:35], v[46:47] op_sel:[1,1,0] op_sel_hi:[0,1,1] neg_lo:[1,0,0]
  v_cvt_pk_f16_f32 v53, v46, v47
  ds_write_b32 v5, v53 offset:7616
  v_pk_mul_f32 v[44:45], v[42:43], v[38:39] op_sel_hi:[1,0]
  v_pk_fma_f32 v[44:45], v[42:43], v[38:39], v[44:45] op_sel:[1,1,0] op_sel_hi:[0,1,1] neg_lo:[1,0,0]
  v_cvt_pk_f16_f32 v54, v44, v45
  ds_write_b32 v5, v54 offset:7888
  v_pk_mul_f32 v[46:47], v[44:45], v[30:31] op_sel_hi:[1,0]
  v_pk_fma_f32 v[46:47], v[44:45], v[30:31], v[46:47] op_sel:[1,1,0] op_sel_hi:[0,1,1] neg_lo:[1,0,0]
  v_cvt_pk_f16_f32 v55, v46, v47
  ds_write_b32 v5, v55 offset:8160
  v_pk_mul_f32 v[46:47], v[44:45], v[32:33] op_sel_hi:[1,0]
  v_pk_fma_f32 v[46:47], v[44:45], v[32:33], v[46:47] op_sel:[1,1,0] op_sel_hi:[0,1,1] neg_lo:[1,0,0]
  v_cvt_pk_f16_f32 v56, v46, v47
  ds_write_b32 v5, v56 offset:8432
  v_pk_mul_f32 v[46:47], v[44:45], v[34:35] op_sel_hi:[1,0]
  v_pk_fma_f32 v[46:47], v[44:45], v[34:35], v[46:47] op_sel:[1,1,0] op_sel_hi:[0,1,1] neg_lo:[1,0,0]
  v_cvt_pk_f16_f32 v57, v46, v47
  ds_write_b32 v5, v57 offset:8704
  v_pk_mul_f32 v[42:43], v[44:45], v[38:39] op_sel_hi:[1,0]
  v_pk_fma_f32 v[42:43], v[44:45], v[38:39], v[42:43] op_sel:[1,1,0] op_sel_hi:[0,1,1] neg_lo:[1,0,0]
  ds_read_b128 v[76:79], v8 offset:4624
  ds_read_b128 v[80:83], v8 offset:4688
  ds_read_b128 v[84:87], v8 offset:4752
  ds_read_b128 v[88:91], v8 offset:4816
  v_cvt_pk_f16_f32 v50, v42, v43
  ds_write_b32 v5, v50 offset:0
  v_pk_mul_f32 v[46:47], v[42:43], v[32:33] op_sel_hi:[1,0]
  v_pk_fma_f32 v[46:47], v[42:43], v[32:33], v[46:47] op_sel:[1,1,0] op_sel_hi:[0,1,1] neg_lo:[1,0,0]
  v_cvt_pk_f16_f32 v51, v46, v47
  ds_write_b32 v5, v51 offset:272
  v_pk_mul_f32 v[44:45], v[42:43], v[38:39] op_sel_hi:[1,0]
  v_pk_fma_f32 v[44:45], v[42:43], v[38:39], v[44:45] op_sel:[1,1,0] op_sel_hi:[0,1,1] neg_lo:[1,0,0]
  v_cvt_pk_f16_f32 v52, v44, v45
  ds_write_b32 v5, v52 offset:544
  v_pk_mul_f32 v[46:47], v[44:45], v[32:33] op_sel_hi:[1,0]
  v_pk_fma_f32 v[46:47], v[44:45], v[32:33], v[46:47] op_sel:[1,1,0] op_sel_hi:[0,1,1] neg_lo:[1,0,0]
  v_cvt_pk_f16_f32 v53, v46, v47
  ds_write_b32 v5, v53 offset:816
  s_waitcnt lgkmcnt(0)
  v_mfma_f32_16x16x32_f16 v[92:95], v[76:79], v[60:63], v[92:95]
  v_mfma_f32_16x16x32_f16 v[92:95], v[80:83], v[64:67], v[92:95]
  v_mfma_f32_16x16x32_f16 v[92:95], v[84:87], v[68:71], v[92:95]
  v_mfma_f32_16x16x32_f16 v[92:95], v[88:91], v[72:75], v[92:95]
  v_pk_mul_f32 v[42:43], v[44:45], v[38:39] op_sel_hi:[1,0]
  v_pk_fma_f32 v[42:43], v[44:45], v[38:39], v[42:43] op_sel:[1,1,0] op_sel_hi:[0,1,1] neg_lo:[1,0,0]
  v_cvt_pk_f16_f32 v54, v42, v43
  ds_write_b32 v5, v54 offset:1088
  v_pk_mul_f32 v[46:47], v[42:43], v[32:33] op_sel_hi:[1,0]
  v_pk_fma_f32 v[46:47], v[42:43], v[32:33], v[46:47] op_sel:[1,1,0] op_sel_hi:[0,1,1] neg_lo:[1,0,0]
  v_cvt_pk_f16_f32 v55, v46, v47
  ds_write_b32 v5, v55 offset:1360
  v_pk_mul_f32 v[44:45], v[42:43], v[38:39] op_sel_hi:[1,0]
  v_pk_fma_f32 v[44:45], v[42:43], v[38:39], v[44:45] op_sel:[1,1,0] op_sel_hi:[0,1,1] neg_lo:[1,0,0]
  v_cvt_pk_f16_f32 v56, v44, v45
  ds_write_b32 v5, v56 offset:1632
  v_pk_mul_f32 v[46:47], v[44:45], v[32:33] op_sel_hi:[1,0]
  v_pk_fma_f32 v[46:47], v[44:45], v[32:33], v[46:47] op_sel:[1,1,0] op_sel_hi:[0,1,1] neg_lo:[1,0,0]
  v_cvt_pk_f16_f32 v57, v46, v47
  ds_write_b32 v5, v57 offset:1904
  v_pk_mul_f32 v[42:43], v[44:45], v[38:39] op_sel_hi:[1,0]
  v_pk_fma_f32 v[42:43], v[44:45], v[38:39], v[42:43] op_sel:[1,1,0] op_sel_hi:[0,1,1] neg_lo:[1,0,0]
  v_cvt_pk_f16_f32 v50, v42, v43
  ds_write_b32 v5, v50 offset:2176
  v_pk_mul_f32 v[44:45], v[42:43], v[38:39] op_sel_hi:[1,0]
  v_pk_fma_f32 v[44:45], v[42:43], v[38:39], v[44:45] op_sel:[1,1,0] op_sel_hi:[0,1,1] neg_lo:[1,0,0]
  v_cvt_pk_f16_f32 v51, v44, v45
  ds_write_b32 v5, v51 offset:2448
  v_pk_mul_f32 v[42:43], v[44:45], v[38:39] op_sel_hi:[1,0]
  v_pk_fma_f32 v[42:43], v[44:45], v[38:39], v[42:43] op_sel:[1,1,0] op_sel_hi:[0,1,1] neg_lo:[1,0,0]
  v_cvt_pk_f16_f32 v52, v42, v43
  ds_write_b32 v5, v52 offset:2720
  v_pk_mul_f32 v[44:45], v[42:43], v[38:39] op_sel_hi:[1,0]
  v_pk_fma_f32 v[44:45], v[42:43], v[38:39], v[44:45] op_sel:[1,1,0] op_sel_hi:[0,1,1] neg_lo:[1,0,0]
  v_cvt_pk_f16_f32 v53, v44, v45
  ds_write_b32 v5, v53 offset:2992
  v_pk_mul_f32 v[42:43], v[44:45], v[38:39] op_sel_hi:[1,0]
  v_pk_fma_f32 v[42:43], v[44:45], v[38:39], v[42:43] op_sel:[1,1,0] op_sel_hi:[0,1,1] neg_lo:[1,0,0]
  v_cvt_pk_f16_f32 v54, v42, v43
  ds_write_b32 v5, v54 offset:3264
  v_pk_mul_f32 v[44:45], v[42:43], v[38:39] op_sel_hi:[1,0]
  v_pk_fma_f32 v[44:45], v[42:43], v[38:39], v[44:45] op_sel:[1,1,0] op_sel_hi:[0,1,1] neg_lo:[1,0,0]
  v_cvt_pk_f16_f32 v55, v44, v45
  ds_write_b32 v5, v55 offset:3536
  v_pk_mul_f32 v[42:43], v[44:45], v[38:39] op_sel_hi:[1,0]
  v_pk_fma_f32 v[42:43], v[44:45], v[38:39], v[42:43] op_sel:[1,1,0] op_sel_hi:[0,1,1] neg_lo:[1,0,0]
  v_cvt_pk_f16_f32 v56, v42, v43
  ds_write_b32 v5, v56 offset:3808
  v_pk_mul_f32 v[44:45], v[42:43], v[38:39] op_sel_hi:[1,0]
  v_pk_fma_f32 v[44:45], v[42:43], v[38:39], v[44:45] op_sel:[1,1,0] op_sel_hi:[0,1,1] neg_lo:[1,0,0]
  v_cvt_pk_f16_f32 v57, v44, v45
  ds_write_b32 v5, v57 offset:4080
  ds_read_b128 v[76:79], v8 offset:0
  ds_read_b128 v[80:83], v8 offset:64
  ds_read_b128 v[84:87], v8 offset:128
  ds_read_b128 v[88:91], v8 offset:192
  v_cvt_pk_f16_f32 v50, v40, v41
  ds_write_b32 v5, v50 offset:4624
  v_pk_mul_f32 v[42:43], v[40:41], v[38:39] op_sel_hi:[1,0]
  v_pk_fma_f32 v[42:43], v[40:41], v[38:39], v[42:43] op_sel:[1,1,0] op_sel_hi:[0,1,1] neg_lo:[1,0,0]
  v_cvt_pk_f16_f32 v51, v42, v43
  ds_write_b32 v5, v51 offset:4896
  v_pk_mul_f32 v[44:45], v[42:43], v[38:39] op_sel_hi:[1,0]
  v_pk_fma_f32 v[44:45], v[42:43], v[38:39], v[44:45] op_sel:[1,1,0] op_sel_hi:[0,1,1] neg_lo:[1,0,0]
  v_cvt_pk_f16_f32 v52, v44, v45
  ds_write_b32 v5, v52 offset:5168
  s_waitcnt lgkmcnt(0)
  v_mfma_f32_16x16x32_f16 v[96:99], v[76:79], v[60:63], v[96:99]
  v_mfma_f32_16x16x32_f16 v[96:99], v[80:83], v[64:67], v[96:99]
  v_mfma_f32_16x16x32_f16 v[96:99], v[84:87], v[68:71], v[96:99]
  v_mfma_f32_16x16x32_f16 v[96:99], v[88:91], v[72:75], v[96:99]
  v_pk_mul_f32 v[42:43], v[44:45], v[38:39] op_sel_hi:[1,0]
  v_pk_fma_f32 v[42:43], v[44:45], v[38:39], v[42:43] op_sel:[1,1,0] op_sel_hi:[0,1,1] neg_lo:[1,0,0]
  v_cvt_pk_f16_f32 v53, v42, v43
  ds_write_b32 v5, v53 offset:5440
  v_pk_mul_f32 v[44:45], v[42:43], v[38:39] op_sel_hi:[1,0]
  v_pk_fma_f32 v[44:45], v[42:43], v[38:39], v[44:45] op_sel:[1,1,0] op_sel_hi:[0,1,1] neg_lo:[1,0,0]
  v_cvt_pk_f16_f32 v54, v44, v45
  ds_write_b32 v5, v54 offset:5712
  v_pk_mul_f32 v[42:43], v[44:45], v[38:39] op_sel_hi:[1,0]
  v_pk_fma_f32 v[42:43], v[44:45], v[38:39], v[42:43] op_sel:[1,1,0] op_sel_hi:[0,1,1] neg_lo:[1,0,0]
  v_cvt_pk_f16_f32 v55, v42, v43
  ds_write_b32 v5, v55 offset:5984
  v_pk_mul_f32 v[44:45], v[42:43], v[38:39] op_sel_hi:[1,0]
  v_pk_fma_f32 v[44:45], v[42:43], v[38:39], v[44:45] op_sel:[1,1,0] op_sel_hi:[0,1,1] neg_lo:[1,0,0]
  v_cvt_pk_f16_f32 v56, v44, v45
  ds_write_b32 v5, v56 offset:6256
  v_pk_mul_f32 v[42:43], v[44:45], v[38:39] op_sel_hi:[1,0]
  v_pk_fma_f32 v[42:43], v[44:45], v[38:39], v[42:43] op_sel:[1,1,0] op_sel_hi:[0,1,1] neg_lo:[1,0,0]
  v_cvt_pk_f16_f32 v57, v42, v43
  ds_write_b32 v5, v57 offset:6528
  v_pk_mul_f32 v[44:45], v[42:43], v[38:39] op_sel_hi:[1,0]
  v_pk_fma_f32 v[44:45], v[42:43], v[38:39], v[44:45] op_sel:[1,1,0] op_sel_hi:[0,1,1] neg_lo:[1,0,0]
  v_cvt_pk_f16_f32 v50, v44, v45
  ds_write_b32 v5, v50 offset:6800
  v_pk_mul_f32 v[42:43], v[44:45], v[38:39] op_sel_hi:[1,0]
  v_pk_fma_f32 v[42:43], v[44:45], v[38:39], v[42:43] op_sel:[1,1,0] op_sel_hi:[0,1,1] neg_lo:[1,0,0]
  v_cvt_pk_f16_f32 v51, v42, v43
  ds_write_b32 v5, v51 offset:7072
  v_pk_mul_f32 v[44:45], v[42:43], v[38:39] op_sel_hi:[1,0]
  v_pk_fma_f32 v[44:45], v[42:43], v[38:39], v[44:45] op_sel:[1,1,0] op_sel_hi:[0,1,1] neg_lo:[1,0,0]
  v_cvt_pk_f16_f32 v52, v44, v45
  ds_write_b32 v5, v52 offset:7344
  v_pk_mul_f32 v[42:43], v[44:45], v[38:39] op_sel_hi:[1,0]
  v_pk_fma_f32 v[42:43], v[44:45], v[38:39], v[42:43] op_sel:[1,1,0] op_sel_hi:[0,1,1] neg_lo:[1,0,0]
  v_cvt_pk_f16_f32 v53, v42, v43
  ds_write_b32 v5, v53 offset:7616
  v_pk_mul_f32 v[44:45], v[42:43], v[38:39] op_sel_hi:[1,0]
  v_pk_fma_f32 v[44:45], v[42:43], v[38:39], v[44:45] op_sel:[1,1,0] op_sel_hi:[0,1,1] neg_lo:[1,0,0]
  v_cvt_pk_f16_f32 v54, v44, v45
  ds_write_b32 v5, v54 offset:7888
  v_pk_mul_f32 v[42:43], v[44:45], v[38:39] op_sel_hi:[1,0]
  v_pk_fma_f32 v[42:43], v[44:45], v[38:39], v[42:43] op_sel:[1,1,0] op_sel_hi:[0,1,1] neg_lo:[1,0,0]
  v_cvt_pk_f16_f32 v55, v42, v43
  ds_write_b32 v5, v55 offset:8160
  v_pk_mul_f32 v[44:45], v[42:43], v[38:39] op_sel_hi:[1,0]
  v_pk_fma_f32 v[44:45], v[42:43], v[38:39], v[44:45] op_sel:[1,1,0] op_sel_hi:[0,1,1] neg_lo:[1,0,0]
  v_cvt_pk_f16_f32 v56, v44, v45
  ds_write_b32 v5, v56 offset:8432
  v_pk_mul_f32 v[42:43], v[44:45], v[38:39] op_sel_hi:[1,0]
  v_pk_fma_f32 v[42:43], v[44:45], v[38:39], v[42:43] op_sel:[1,1,0] op_sel_hi:[0,1,1] neg_lo:[1,0,0]
  v_cvt_pk_f16_f32 v57, v42, v43
  ds_write_b32 v5, v57 offset:8704
  v_pk_mul_f32 v[44:45], v[42:43], v[38:39] op_sel_hi:[1,0]
  v_pk_fma_f32 v[44:45], v[42:43], v[38:39], v[44:45] op_sel:[1,1,0] op_sel_hi:[0,1,1] neg_lo:[1,0,0]
  v_cvt_pk_f16_f32 v50, v44, v45
  ds_write_b32 v5, v50 offset:8976
  ds_read_b128 v[76:79], v8 offset:4624
  ds_read_b128 v[80:83], v8 offset:4688
  ds_read_b128 v[84:87], v8 offset:4752
  ds_read_b128 v[88:91], v8 offset:4816
  ds_read_b128 v[30:33], v9 offset:8976
  ds_read_b128 v[34:37], v9 offset:9040
  ds_read_b128 v[38:41], v9 offset:9104
  ds_read_b128 v[42:45], v9 offset:9168
  s_waitcnt lgkmcnt(0)
  v_mfma_f32_16x16x32_f16 v[100:103], v[76:79], v[60:63], v[100:103]
  v_mfma_f32_16x16x32_f16 v[100:103], v[80:83], v[64:67], v[100:103]
  v_mfma_f32_16x16x32_f16 v[100:103], v[84:87], v[68:71], v[100:103]
  v_mfma_f32_16x16x32_f16 v[100:103], v[88:91], v[72:75], v[100:103]
  s_waitcnt lgkmcnt(0)
  v_mfma_f32_16x16x32_f16 v[104:107], v[30:33], v[60:63], v[104:107]
  v_mfma_f32_16x16x32_f16 v[104:107], v[34:37], v[64:67], v[104:107]
  v_mfma_f32_16x16x32_f16 v[104:107], v[38:41], v[68:71], v[104:107]
  v_mfma_f32_16x16x32_f16 v[104:107], v[42:45], v[72:75], v[104:107]
  s_cmp_eq_u32 s23, 0
  s_cbranch_scc0 KG_H1
  s_nop 0
  ds_write_b128 v27, v[100:103]
  s_nop 3
  ds_write_b128 v27, v[104:107] offset:1024
  s_waitcnt lgkmcnt(0)
  s_barrier
  ds_read_b128 v[60:63], v28
  ds_read_b128 v[64:67], v28 offset:1024
  s_waitcnt lgkmcnt(0)
  v_pk_add_f32 v[60:61], v[60:61], v[92:93]
  v_pk_add_f32 v[62:63], v[62:63], v[94:95]
  v_pk_add_f32 v[64:65], v[64:65], v[96:97]
  v_pk_add_f32 v[66:67], v[66:67], v[98:99]
  v_cvt_pk_f16_f32 v68, v60, v61
  v_cvt_pk_f16_f32 v69, v62, v63
  v_cvt_pk_f16_f32 v70, v64, v65
  v_cvt_pk_f16_f32 v71, v66, v67
  ds_write_b64 v22, v[68:69]
  ds_write_b16 v23, v70 offset:512
  ds_write_b16_d16_hi v24, v70 offset:512
  ds_write_b16 v23, v71 offset:576
  ds_write_b16_d16_hi v24, v71 offset:576
  s_branch KG_G
KG_H1:
  ds_write_b128 v27, v[92:95]
  ds_write_b128 v27, v[96:99] offset:1024
  s_waitcnt lgkmcnt(0)
  s_barrier
  ds_read_b128 v[60:63], v28
  ds_read_b128 v[64:67], v28 offset:1024
  s_waitcnt lgkmcnt(0)
  v_pk_add_f32 v[60:61], v[60:61], v[100:101]
  v_pk_add_f32 v[62:63], v[62:63], v[102:103]
  v_pk_add_f32 v[64:65], v[64:65], v[104:105]
  v_pk_add_f32 v[66:67], v[66:67], v[106:107]
  v_cvt_pk_f16_f32 v68, v60, v61
  v_cvt_pk_f16_f32 v69, v62, v63
  v_cvt_pk_f16_f32 v70, v64, v65
  v_cvt_pk_f16_f32 v71, v66, v67
  s_mov_b32 exec_lo, 0x55555555
  s_mov_b32 exec_hi, 0x55555555
  ds_write_b16 v25, v68 offset:1024
  ds_write_b16_d16_hi v25, v68 offset:1040
  ds_write_b16 v25, v69 offset:1056
  ds_write_b16_d16_hi v25, v69 offset:1072
  ds_write_b16 v26, v70 offset:1280
  s_mov_b64 exec, -1
KG_G:
  s_waitcnt lgkmcnt(0)
  s_barrier
  ds_read_u16 v108, v108
  ds_read_u16 v109, v109
  ds_read_u16 v110, v110
  ds_read_u16 v111, v111
  ds_read_u16 v112, v112
  ds_read_u16 v113, v113
  ds_read_u16 v114, v114
  ds_read_u16 v115, v115
  ds_read_u16 v116, v116
  ds_read_u16 v117, v117
  ds_read_u16 v118, v118
  ds_read_u16 v119, v119
  ds_read_u16 v120, v120
  ds_read_u16 v121, v121
  ds_read_u16 v122, v122
  ds_read_u16 v123, v123
  ds_read_u16 v124, v124
  ds_read_u16 v125, v125
  ds_read_u16 v126, v126
  v_mov_b32 v32, 0
  v_mov_b32 v33, 0
  v_mov_b32 v34, 0
  v_mov_b32 v35, 0
  s_waitcnt lgkmcnt(0)
  ds_write_b128 v145, v[32:35] offset:33280
  ds_write_b128 v146, v[32:35] offset:33280
  ds_write_b128 v144, v[32:35] offset:4096
  v_lshl_or_b32 v60, v109, 16, v108
  v_lshl_or_b32 v61, v111, 16, v110
  v_lshl_or_b32 v62, v113, 16, v112
  v_lshl_or_b32 v63, v115, 16, v114
  v_lshl_or_b32 v64, v117, 16, v116
  v_lshl_or_b32 v65, v119, 16, v118
  v_lshl_or_b32 v66, v121, 16, v120
  v_lshl_or_b32 v67, v123, 16, v122
  v_lshl_or_b32 v68, v125, 16, v124
  v_lshl_or_b32 v70, v110, 16, v109
  v_lshl_or_b32 v71, v112, 16, v111
  v_lshl_or_b32 v72, v114, 16, v113
  v_lshl_or_b32 v73, v116, 16, v115
  v_lshl_or_b32 v74, v118, 16, v117
  v_lshl_or_b32 v75, v120, 16, v119
  v_lshl_or_b32 v76, v122, 16, v121
  v_lshl_or_b32 v77, v124, 16, v123
  v_lshl_or_b32 v78, v126, 16, v125
  ds_write_b128 v29, v[60:63] offset:0
  ds_write_b128 v29, v[64:67] offset:16
  ds_write_b128 v29, v[70:73] offset:4160
  ds_write_b128 v29, v[74:77] offset:4176
  v_add_u32 v36, 8320, v29
  v_add_u32 v37, 12480, v29
  ds_write2_b32 v36, v61, v62 offset0:0 offset1:1
  ds_write2_b32 v36, v63, v64 offset0:2 offset1:3
  ds_write2_b32 v36, v65, v66 offset0:4 offset1:5
  ds_write2_b32 v36, v67, v68 offset0:6 offset1:7
  ds_write2_b32 v37, v71, v72 offset0:0 offset1:1
  ds_write2_b32 v37, v73, v74 offset0:2 offset1:3
  ds_write2_b32 v37, v75, v76 offset0:4 offset1:5
  ds_write2_b32 v37, v77, v78 offset0:6 offset1:7
  s_cmp_eq_u32 s20, 0
  s_cbranch_scc1 CV_P0
  s_branch CV_W
CV_P0:
  v_lshlrev_b32 v38, 2, v1
  s_mov_b32 s71, 0
  s_mov_b64 exec, 3
CV_POLL:
  buffer_load_dword v39, v38, s[56:59], 0 offen offset:128 sc1
  s_add_u32 s71, s71, 1
  s_waitcnt vmcnt(0)
  v_cmp_ne_u32 vcc, 1, v39
  s_cmp_gt_u32 s71, 400000
  s_cbranch_scc1 CV_POLL_X
  s_cbranch_vccz CV_POLL_X
  s_sleep 2
  s_branch CV_POLL
CV_POLL_X:
  s_mov_b64 exec, -1
CV_W:
  s_waitcnt lgkmcnt(0)
  s_barrier
  s_mov_b64 exec, 0xfff
  buffer_load_dwordx2 v[38:39], v136, s[44:47], s12 offen sc0 sc1
  s_mov_b64 exec, -1
  buffer_load_dwordx4 v[8:11], v134, s[44:47], s10 offen sc0 sc1
  buffer_load_dwordx4 v[52:55], v135, s[44:47], s96 offen sc0 sc1
  buffer_load_dwordx4 v[56:59], v135, s[44:47], s96 offen offset:16 sc0 sc1
  s_add_u32 s10, s10, 8192
  buffer_load_dwordx4 v[12:15], v134, s[44:47], s10 offen sc0 sc1
  buffer_load_dwordx4 v[60:63], v135, s[44:47], s97 offen sc0 sc1
  buffer_load_dwordx4 v[64:67], v135, s[44:47], s97 offen offset:16 sc0 sc1
  s_waitcnt vmcnt(6)
  v_add_f32_dpp v38, v38, v38 quad_perm:[1,0,3,2] row_mask:0xf bank_mask:0xf
  s_nop 1
  v_add_f32_dpp v38, v38, v38 quad_perm:[2,3,0,1] row_mask:0xf bank_mask:0xf
  v_add_f32_dpp v39, v39, v39 quad_perm:[1,0,3,2] row_mask:0xf bank_mask:0xf
  s_nop 1
  v_add_f32_dpp v39, v39, v39 quad_perm:[2,3,0,1] row_mask:0xf bank_mask:0xf
  v_cvt_pk_bf16_f32 v38, v38, v39
  v_and_b32 v39, 0xffff0000, v38
  v_lshlrev_b32 v38, 16, v38
  s_nop 0
  v_readlane_b32 s72, v38, 0
  v_readlane_b32 s73, v39, 0
  v_readlane_b32 s74, v38, 4
  v_readlane_b32 s75, v39, 4
  v_readlane_b32 s76, v38, 8
  v_readlane_b32 s77, v39, 8
  v_mov_b32 v40, s74
  v_mov_b32 v41, s75
  v_mov_b32 v42, s72
  v_mov_b32 v43, s73
  v_pk_add_f32 v[40:41], v[40:41], 1.0 op_sel_hi:[1,0]
  v_cvt_pk_bf16_f32 v40, v40, v41
  v_and_b32 v41, 0xffff0000, v40
  v_lshlrev_b32 v40, 16, v40
  v_mul_f32 v44, 0x41b80000, v40
  v_add_f32 v44, abs(v44), abs(v42)
  v_and_b32 v44, 0x7f800000, v44
  v_max_u32 v44, 0x7000000, v44
  v_min_u32 v44, 0x7f000000, v44
  v_sub_u32 v46, 0x85800000, v44
  v_subrev_u32 v44, 0x6800000, v44
  v_mul_f32 v45, 0x41b80000, v41
  v_add_f32 v45, abs(v45), abs(v43)
  v_and_b32 v45, 0x7f800000, v45
  v_max_u32 v45, 0x7000000, v45
  v_min_u32 v45, 0x7f000000, v45
  v_sub_u32 v47, 0x85800000, v45
  v_subrev_u32 v45, 0x6800000, v45
  v_pk_mul_f32 v[40:41], v[40:41], v[46:47]
  v_pk_mul_f32 v[42:43], v[42:43], v[46:47]
  s_cmp_eq_u32 s21, 0
  s_cselect_b64 vcc, -1, 0
  s_cselect_b32 s28, s76, s77
  v_cndmask_b32 v44, v45, v44, vcc
  v_lshlrev_b32 v49, 16, v49
  v_mul_f32 v48, v48, v44
  v_mul_f32 v49, v49, v44
  v_readfirstlane_b32 s24, v48
  v_readfirstlane_b32 s26, v49
  v_cndmask_b32 v40, v40, v41, s[64:65]
  v_cndmask_b32 v42, v42, v43, s[64:65]
  s_waitcnt vmcnt(3)
  v_and_b32 v76, 0xffff0000, v52
  v_and_b32 v77, 0xffff0000, v53
  v_rcp_f32 v76, v76
  v_rcp_f32 v77, v77
  v_lshlrev_b32 v74, 16, v52
  v_lshlrev_b32 v75, 16, v53
  v_lshlrev_b32 v70, 16, v8
  v_and_b32 v71, 0xffff0000, v8
  v_pk_add_f32 v[70:71], v[70:71], v[74:75] neg_lo:[0,1] neg_hi:[0,1]
  v_cvt_pk_bf16_f32 v70, v70, v71
  v_and_b32 v71, 0xffff0000, v70
  v_lshlrev_b32 v70, 16, v70
  v_pk_mul_f32 v[70:71], v[70:71], v[76:77]
  v_cvt_pk_bf16_f32 v70, v70, v71
  v_and_b32 v71, 0xffff0000, v70
  v_lshlrev_b32 v70, 16, v70
  v_pk_mul_f32 v[70:71], v[70:71], v[40:41] op_sel_hi:[1,0]
  v_cvt_pk_bf16_f32 v70, v70, v71
  v_and_b32 v71, 0xffff0000, v70
  v_lshlrev_b32 v70, 16, v70
  v_pk_add_f32 v[70:71], v[70:71], v[42:43] op_sel_hi:[1,0]
  v_cvt_pk_bf16_f32 v70, v70, v71
  v_and_b32 v71, 0xffff0000, v70
  v_lshlrev_b32 v70, 16, v70
  v_cvt_pk_f16_f32 v8, v70, v71
  v_and_b32 v76, 0xffff0000, v54
  v_and_b32 v77, 0xffff0000, v55
  v_rcp_f32 v76, v76
  v_rcp_f32 v77, v77
  v_lshlrev_b32 v74, 16, v54
  v_lshlrev_b32 v75, 16, v55
  v_lshlrev_b32 v72, 16, v9
  v_and_b32 v73, 0xffff0000, v9
  v_pk_add_f32 v[72:73], v[72:73], v[74:75] neg_lo:[0,1] neg_hi:[0,1]
  v_cvt_pk_bf16_f32 v72, v72, v73
  v_and_b32 v73, 0xffff0000, v72
  v_lshlrev_b32 v72, 16, v72
  v_pk_mul_f32 v[72:73], v[72:73], v[76:77]
  v_cvt_pk_bf16_f32 v72, v72, v73
  v_and_b32 v73, 0xffff0000, v72
  v_lshlrev_b32 v72, 16, v72
  v_pk_mul_f32 v[72:73], v[72:73], v[40:41] op_sel_hi:[1,0]
  v_cvt_pk_bf16_f32 v72, v72, v73
  v_and_b32 v73, 0xffff0000, v72
  v_lshlrev_b32 v72, 16, v72
  v_pk_add_f32 v[72:73], v[72:73], v[42:43] op_sel_hi:[1,0]
  v_cvt_pk_bf16_f32 v72, v72, v73
  v_and_b32 v73, 0xffff0000, v72
  v_lshlrev_b32 v72, 16, v72
  v_cvt_pk_f16_f32 v9, v72, v73
  v_and_b32 v76, 0xffff0000, v56
  v_and_b32 v77, 0xffff0000, v57
  v_rcp_f32 v76, v76
  v_rcp_f32 v77, v77
  v_lshlrev_b32 v74, 16, v56
  v_lshlrev_b32 v75, 16, v57
  v_lshlrev_b32 v70, 16, v10
  v_and_b32 v71, 0xffff0000, v10
  v_pk_add_f32 v[70:71], v[70:71], v[74:75] neg_lo:[0,1] neg_hi:[0,1]
  v_cvt_pk_bf16_f32 v70, v70, v71
  v_and_b32 v71, 0xffff0000, v70
  v_lshlrev_b32 v70, 16, v70
  v_pk_mul_f32 v[70:71], v[70:71], v[76:77]
  v_cvt_pk_bf16_f32 v70, v70, v71
  v_and_b32 v71, 0xffff0000, v70
  v_lshlrev_b32 v70, 16, v70
  v_pk_mul_f32 v[70:71], v[70:71], v[40:41] op_sel_hi:[1,0]
  v_cvt_pk_bf16_f32 v70, v70, v71
  v_and_b32 v71, 0xffff0000, v70
  v_lshlrev_b32 v70, 16, v70
  v_pk_add_f32 v[70:71], v[70:71], v[42:43] op_sel_hi:[1,0]
  v_cvt_pk_bf16_f32 v70, v70, v71
  v_and_b32 v71, 0xffff0000, v70
  v_lshlrev_b32 v70, 16, v70
  v_cvt_pk_f16_f32 v10, v70, v71
  v_and_b32 v76, 0xffff0000, v58
  v_and_b32 v77, 0xffff0000, v59
  v_rcp_f32 v76, v76
  v_rcp_f32 v77, v77
  v_lshlrev_b32 v74, 16, v58
  v_lshlrev_b32 v75, 16, v59
  v_lshlrev_b32 v72, 16, v11
  v_and_b32 v73, 0xffff0000, v11
  v_pk_add_f32 v[72:73], v[72:73], v[74:75] neg_lo:[0,1] neg_hi:[0,1]
  v_cvt_pk_bf16_f32 v72, v72, v73
  v_and_b32 v73, 0xffff0000, v72
  v_lshlrev_b32 v72, 16, v72
  v_pk_mul_f32 v[72:73], v[72:73], v[76:77]
  v_cvt_pk_bf16_f32 v72, v72, v73
  v_and_b32 v73, 0xffff0000, v72
  v_lshlrev_b32 v72, 16, v72
  v_pk_mul_f32 v[72:73], v[72:73], v[40:41] op_sel_hi:[1,0]
  v_cvt_pk_bf16_f32 v72, v72, v73
  v_and_b32 v73, 0xffff0000, v72
  v_lshlrev_b32 v72, 16, v72
  v_pk_add_f32 v[72:73], v[72:73], v[42:43] op_sel_hi:[1,0]
  v_cvt_pk_bf16_f32 v72, v72, v73
  v_and_b32 v73, 0xffff0000, v72
  v_lshlrev_b32 v72, 16, v72
  v_cvt_pk_f16_f32 v11, v72, v73
  ds_write_b128 v133, v[8:11] offset:35760
  s_waitcnt vmcnt(0)
  v_and_b32 v76, 0xffff0000, v60
  v_and_b32 v77, 0xffff0000, v61
  v_rcp_f32 v76, v76
  v_rcp_f32 v77, v77
  v_lshlrev_b32 v74, 16, v60
  v_lshlrev_b32 v75, 16, v61
  v_lshlrev_b32 v70, 16, v12
  v_and_b32 v71, 0xffff0000, v12
  v_pk_add_f32 v[70:71], v[70:71], v[74:75] neg_lo:[0,1] neg_hi:[0,1]
  v_cvt_pk_bf16_f32 v70, v70, v71
  v_and_b32 v71, 0xffff0000, v70
  v_lshlrev_b32 v70, 16, v70
  v_pk_mul_f32 v[70:71], v[70:71], v[76:77]
  v_cvt_pk_bf16_f32 v70, v70, v71
  v_and_b32 v71, 0xffff0000, v70
  v_lshlrev_b32 v70, 16, v70
  v_pk_mul_f32 v[70:71], v[70:71], v[40:41] op_sel_hi:[1,0]
  v_cvt_pk_bf16_f32 v70, v70, v71
  v_and_b32 v71, 0xffff0000, v70
  v_lshlrev_b32 v70, 16, v70
  v_pk_add_f32 v[70:71], v[70:71], v[42:43] op_sel_hi:[1,0]
  v_cvt_pk_bf16_f32 v70, v70, v71
  v_and_b32 v71, 0xffff0000, v70
  v_lshlrev_b32 v70, 16, v70
  v_cvt_pk_f16_f32 v12, v70, v71
  v_and_b32 v76, 0xffff0000, v62
  v_and_b32 v77, 0xffff0000, v63
  v_rcp_f32 v76, v76
  v_rcp_f32 v77, v77
  v_lshlrev_b32 v74, 16, v62
  v_lshlrev_b32 v75, 16, v63
  v_lshlrev_b32 v72, 16, v13
  v_and_b32 v73, 0xffff0000, v13
  v_pk_add_f32 v[72:73], v[72:73], v[74:75] neg_lo:[0,1] neg_hi:[0,1]
  v_cvt_pk_bf16_f32 v72, v72, v73
  v_and_b32 v73, 0xffff0000, v72
  v_lshlrev_b32 v72, 16, v72
  v_pk_mul_f32 v[72:73], v[72:73], v[76:77]
  v_cvt_pk_bf16_f32 v72, v72, v73
  v_and_b32 v73, 0xffff0000, v72
  v_lshlrev_b32 v72, 16, v72
  v_pk_mul_f32 v[72:73], v[72:73], v[40:41] op_sel_hi:[1,0]
  v_cvt_pk_bf16_f32 v72, v72, v73
  v_and_b32 v73, 0xffff0000, v72
  v_lshlrev_b32 v72, 16, v72
  v_pk_add_f32 v[72:73], v[72:73], v[42:43] op_sel_hi:[1,0]
  v_cvt_pk_bf16_f32 v72, v72, v73
  v_and_b32 v73, 0xffff0000, v72
  v_lshlrev_b32 v72, 16, v72
  v_cvt_pk_f16_f32 v13, v72, v73
  v_and_b32 v76, 0xffff0000, v64
  v_and_b32 v77, 0xffff0000, v65
  v_rcp_f32 v76, v76
  v_rcp_f32 v77, v77
  v_lshlrev_b32 v74, 16, v64
  v_lshlrev_b32 v75, 16, v65
  v_lshlrev_b32 v70, 16, v14
  v_and_b32 v71, 0xffff0000, v14
  v_pk_add_f32 v[70:71], v[70:71], v[74:75] neg_lo:[0,1] neg_hi:[0,1]
  v_cvt_pk_bf16_f32 v70, v70, v71
  v_and_b32 v71, 0xffff0000, v70
  v_lshlrev_b32 v70, 16, v70
  v_pk_mul_f32 v[70:71], v[70:71], v[76:77]
  v_cvt_pk_bf16_f32 v70, v70, v71
  v_and_b32 v71, 0xffff0000, v70
  v_lshlrev_b32 v70, 16, v70
  v_pk_mul_f32 v[70:71], v[70:71], v[40:41] op_sel_hi:[1,0]
  v_cvt_pk_bf16_f32 v70, v70, v71
  v_and_b32 v71, 0xffff0000, v70
  v_lshlrev_b32 v70, 16, v70
  v_pk_add_f32 v[70:71], v[70:71], v[42:43] op_sel_hi:[1,0]
  v_cvt_pk_bf16_f32 v70, v70, v71
  v_and_b32 v71, 0xffff0000, v70
  v_lshlrev_b32 v70, 16, v70
  v_cvt_pk_f16_f32 v14, v70, v71
  v_and_b32 v76, 0xffff0000, v66
  v_and_b32 v77, 0xffff0000, v67
  v_rcp_f32 v76, v76
  v_rcp_f32 v77, v77
  v_lshlrev_b32 v74, 16, v66
  v_lshlrev_b32 v75, 16, v67
  v_lshlrev_b32 v72, 16, v15
  v_and_b32 v73, 0xffff0000, v15
  v_pk_add_f32 v[72:73], v[72:73], v[74:75] neg_lo:[0,1] neg_hi:[0,1]
  v_cvt_pk_bf16_f32 v72, v72, v73
  v_and_b32 v73, 0xffff0000, v72
  v_lshlrev_b32 v72, 16, v72
  v_pk_mul_f32 v[72:73], v[72:73], v[76:77]
  v_cvt_pk_bf16_f32 v72, v72, v73
  v_and_b32 v73, 0xffff0000, v72
  v_lshlrev_b32 v72, 16, v72
  v_pk_mul_f32 v[72:73], v[72:73], v[40:41] op_sel_hi:[1,0]
  v_cvt_pk_bf16_f32 v72, v72, v73
  v_and_b32 v73, 0xffff0000, v72
  v_lshlrev_b32 v72, 16, v72
  v_pk_add_f32 v[72:73], v[72:73], v[42:43] op_sel_hi:[1,0]
  v_cvt_pk_bf16_f32 v72, v72, v73
  v_and_b32 v73, 0xffff0000, v72
  v_lshlrev_b32 v72, 16, v72
  v_cvt_pk_f16_f32 v15, v72, v73
  ds_write_b128 v133, v[12:15] offset:38320
  s_waitcnt lgkmcnt(0)
  s_barrier
  ds_read_b64 v[40:41], v130 offset:4032
  ds_read_b64 v[42:43], v130 offset:4040
  ds_read_b64 v[44:45], v130 offset:1984
  ds_read_b64 v[46:47], v130 offset:1992
  ds_read_b128 v[48:51], v131 offset:2480
  ds_read_b128 v[52:55], v131 offset:5040
  ds_read_b64 v[56:57], v130 offset:3968
  ds_read_b64 v[58:59], v130 offset:3976
  ds_read_b64 v[60:61], v130 offset:1920
  ds_read_b64 v[62:63], v130 offset:1928
  ds_read_b128 v[64:67], v131 offset:2400
  ds_read_b128 v[68:71], v131 offset:4960
  s_waitcnt lgkmcnt(6)
  v_mfma_f32_32x32x16_f16 v[96:111], v[40:43], v[48:51], 0
  ds_read_b64 v[72:73], v130 offset:3904
  ds_read_b64 v[74:75], v130 offset:3912
  v_mfma_f32_32x32x16_f16 v[112:127], v[40:43], v[52:55], 0
  ds_read_b64 v[76:77], v130 offset:1856
  ds_read_b64 v[78:79], v130 offset:1864
  v_mfma_f32_32x32x16_f16 v[112:127], v[44:47], v[48:51], v[112:127]
  ds_read_b128 v[80:83], v131 offset:2320
  ds_read_b128 v[84:87], v131 offset:4880
  buffer_load_dwordx2 v[16:17], v137, s[44:47], s11 offen offset:0 sc0 sc1
  s_waitcnt lgkmcnt(6)
  v_mfma_f32_32x32x16_f16 v[96:111], v[56:59], v[64:67], v[96:111]
  ds_read_b64 v[40:41], v130 offset:3840
  ds_read_b64 v[42:43], v130 offset:3848
  v_mfma_f32_32x32x16_f16 v[112:127], v[56:59], v[68:71], v[112:127]
  ds_read_b64 v[44:45], v130 offset:1792
  ds_read_b64 v[46:47], v130 offset:1800
  v_mfma_f32_32x32x16_f16 v[112:127], v[60:63], v[64:67], v[112:127]
  ds_read_b128 v[48:51], v131 offset:2240
  ds_read_b128 v[52:55], v131 offset:4800
  buffer_load_dwordx2 v[18:19], v137, s[44:47], s11 offen offset:64 sc0 sc1
  s_waitcnt lgkmcnt(6)
  v_mfma_f32_32x32x16_f16 v[96:111], v[72:75], v[80:83], v[96:111]
  ds_read_b64 v[56:57], v130 offset:3776
  ds_read_b64 v[58:59], v130 offset:3784
  v_mfma_f32_32x32x16_f16 v[112:127], v[72:75], v[84:87], v[112:127]
  ds_read_b64 v[60:61], v130 offset:1728
  ds_read_b64 v[62:63], v130 offset:1736
  v_mfma_f32_32x32x16_f16 v[112:127], v[76:79], v[80:83], v[112:127]
  ds_read_b128 v[64:67], v131 offset:2160
  ds_read_b128 v[68:71], v131 offset:4720
  buffer_load_dwordx2 v[20:21], v137, s[44:47], s11 offen offset:128 sc0 sc1
  s_waitcnt lgkmcnt(6)
  v_mfma_f32_32x32x16_f16 v[96:111], v[40:43], v[48:51], v[96:111]
  ds_read_b64 v[72:73], v130 offset:3712
  ds_read_b64 v[74:75], v130 offset:3720
  v_mfma_f32_32x32x16_f16 v[112:127], v[40:43], v[52:55], v[112:127]
  ds_read_b64 v[76:77], v130 offset:1664
  ds_read_b64 v[78:79], v130 offset:1672
  v_mfma_f32_32x32x16_f16 v[112:127], v[44:47], v[48:51], v[112:127]
  ds_read_b128 v[80:83], v131 offset:2080
  ds_read_b128 v[84:87], v131 offset:4640
  buffer_load_dwordx2 v[22:23], v137, s[44:47], s11 offen offset:192 sc0 sc1
  s_waitcnt lgkmcnt(6)
  v_mfma_f32_32x32x16_f16 v[96:111], v[56:59], v[64:67], v[96:111]
  ds_read_b64 v[40:41], v130 offset:3648
  ds_read_b64 v[42:43], v130 offset:3656
  v_mfma_f32_32x32x16_f16 v[112:127], v[56:59], v[68:71], v[112:127]
  ds_read_b64 v[44:45], v130 offset:1600
  ds_read_b64 v[46:47], v130 offset:1608
  v_mfma_f32_32x32x16_f16 v[112:127], v[60:63], v[64:67], v[112:127]
  ds_read_b128 v[48:51], v131 offset:2000
  ds_read_b128 v[52:55], v131 offset:4560
  buffer_load_dword v93, v138, s[48:51], s66 offen
  s_add_u32 s66, s66, 8192
  s_waitcnt lgkmcnt(6)
  v_mfma_f32_32x32x16_f16 v[96:111], v[72:75], v[80:83], v[96:111]
  ds_read_b64 v[56:57], v130 offset:3584
  ds_read_b64 v[58:59], v130 offset:3592
  v_mfma_f32_32x32x16_f16 v[112:127], v[72:75], v[84:87], v[112:127]
  ds_read_b64 v[60:61], v130 offset:1536
  ds_read_b64 v[62:63], v130 offset:1544
  v_mfma_f32_32x32x16_f16 v[112:127], v[76:79], v[80:83], v[112:127]
  ds_read_b128 v[64:67], v131 offset:1920
  ds_read_b128 v[68:71], v131 offset:4480
  s_waitcnt lgkmcnt(6)
  v_mfma_f32_32x32x16_f16 v[96:111], v[40:43], v[48:51], v[96:111]
  ds_read_b64 v[72:73], v130 offset:3520
  ds_read_b64 v[74:75], v130 offset:3528
  v_mfma_f32_32x32x16_f16 v[112:127], v[40:43], v[52:55], v[112:127]
  ds_read_b64 v[76:77], v130 offset:1472
  ds_read_b64 v[78:79], v130 offset:1480
  v_mfma_f32_32x32x16_f16 v[112:127], v[44:47], v[48:51], v[112:127]
  ds_read_b128 v[80:83], v131 offset:1840
  ds_read_b128 v[84:87], v131 offset:4400
  s_waitcnt lgkmcnt(6)
  v_mfma_f32_32x32x16_f16 v[96:111], v[56:59], v[64:67], v[96:111]
  ds_read_b64 v[40:41], v130 offset:3456
  ds_read_b64 v[42:43], v130 offset:3464
  v_mfma_f32_32x32x16_f16 v[112:127], v[56:59], v[68:71], v[112:127]
  ds_read_b64 v[44:45], v130 offset:1408
  ds_read_b64 v[46:47], v130 offset:1416
  v_mfma_f32_32x32x16_f16 v[112:127], v[60:63], v[64:67], v[112:127]
  ds_read_b128 v[48:51], v131 offset:1760
  ds_read_b128 v[52:55], v131 offset:4320
  s_waitcnt lgkmcnt(6)
  v_mfma_f32_32x32x16_f16 v[96:111], v[72:75], v[80:83], v[96:111]
  ds_read_b64 v[56:57], v130 offset:3392
  ds_read_b64 v[58:59], v130 offset:3400
  v_mfma_f32_32x32x16_f16 v[112:127], v[72:75], v[84:87], v[112:127]
  ds_read_b64 v[60:61], v130 offset:1344
  ds_read_b64 v[62:63], v130 offset:1352
  v_mfma_f32_32x32x16_f16 v[112:127], v[76:79], v[80:83], v[112:127]
  ds_read_b128 v[64:67], v131 offset:1680
  ds_read_b128 v[68:71], v131 offset:4240
  s_waitcnt lgkmcnt(6)
  v_mfma_f32_32x32x16_f16 v[96:111], v[40:43], v[48:51], v[96:111]
  ds_read_b64 v[72:73], v130 offset:3328
  ds_read_b64 v[74:75], v130 offset:3336
  v_mfma_f32_32x32x16_f16 v[112:127], v[40:43], v[52:55], v[112:127]
  ds_read_b64 v[76:77], v130 offset:1280
  ds_read_b64 v[78:79], v130 offset:1288
  v_mfma_f32_32x32x16_f16 v[112:127], v[44:47], v[48:51], v[112:127]
  ds_read_b128 v[80:83], v131 offset:1600
  ds_read_b128 v[84:87], v131 offset:4160
  s_waitcnt lgkmcnt(6)
  v_mfma_f32_32x32x16_f16 v[96:111], v[56:59], v[64:67], v[96:111]
  ds_read_b64 v[40:41], v130 offset:3264
  ds_read_b64 v[42:43], v130 offset:3272
  v_mfma_f32_32x32x16_f16 v[112:127], v[56:59], v[68:71], v[112:127]
  ds_read_b64 v[44:45], v130 offset:1216
  ds_read_b64 v[46:47], v130 offset:1224
  v_mfma_f32_32x32x16_f16 v[112:127], v[60:63], v[64:67], v[112:127]
  ds_read_b128 v[48:51], v131 offset:1520
  ds_read_b128 v[52:55], v131 offset:4080
  s_waitcnt lgkmcnt(6)
  v_mfma_f32_32x32x16_f16 v[96:111], v[72:75], v[80:83], v[96:111]
  ds_read_b64 v[56:57], v130 offset:3200
  ds_read_b64 v[58:59], v130 offset:3208
  v_mfma_f32_32x32x16_f16 v[112:127], v[72:75], v[84:87], v[112:127]
  ds_read_b64 v[60:61], v130 offset:1152
  ds_read_b64 v[62:63], v130 offset:1160
  v_mfma_f32_32x32x16_f16 v[112:127], v[76:79], v[80:83], v[112:127]
  ds_read_b128 v[64:67], v131 offset:1440
  ds_read_b128 v[68:71], v131 offset:4000
  s_waitcnt lgkmcnt(6)
  v_mfma_f32_32x32x16_f16 v[96:111], v[40:43], v[48:51], v[96:111]
  ds_read_b64 v[72:73], v130 offset:3136
  ds_read_b64 v[74:75], v130 offset:3144
  v_mfma_f32_32x32x16_f16 v[112:127], v[40:43], v[52:55], v[112:127]
  ds_read_b64 v[76:77], v130 offset:1088
  ds_read_b64 v[78:79], v130 offset:1096
  v_mfma_f32_32x32x16_f16 v[112:127], v[44:47], v[48:51], v[112:127]
  ds_read_b128 v[80:83], v131 offset:1360
  ds_read_b128 v[84:87], v131 offset:3920
  s_waitcnt lgkmcnt(6)
  v_mfma_f32_32x32x16_f16 v[96:111], v[56:59], v[64:67], v[96:111]
  ds_read_b64 v[40:41], v130 offset:3072
  ds_read_b64 v[42:43], v130 offset:3080
  v_mfma_f32_32x32x16_f16 v[112:127], v[56:59], v[68:71], v[112:127]
  ds_read_b64 v[44:45], v130 offset:1024
  ds_read_b64 v[46:47], v130 offset:1032
  v_mfma_f32_32x32x16_f16 v[112:127], v[60:63], v[64:67], v[112:127]
  ds_read_b128 v[48:51], v131 offset:1280
  ds_read_b128 v[52:55], v131 offset:3840
  s_waitcnt lgkmcnt(6)
  v_mfma_f32_32x32x16_f16 v[96:111], v[72:75], v[80:83], v[96:111]
  ds_read_b64 v[56:57], v130 offset:3008
  ds_read_b64 v[58:59], v130 offset:3016
  v_mfma_f32_32x32x16_f16 v[112:127], v[72:75], v[84:87], v[112:127]
  ds_read_b64 v[60:61], v130 offset:960
  ds_read_b64 v[62:63], v130 offset:968
  v_mfma_f32_32x32x16_f16 v[112:127], v[76:79], v[80:83], v[112:127]
  ds_read_b128 v[64:67], v131 offset:1200
  ds_read_b128 v[68:71], v131 offset:3760
  s_waitcnt lgkmcnt(6)
  v_mfma_f32_32x32x16_f16 v[96:111], v[40:43], v[48:51], v[96:111]
  ds_read_b64 v[72:73], v130 offset:2944
  ds_read_b64 v[74:75], v130 offset:2952
  v_mfma_f32_32x32x16_f16 v[112:127], v[40:43], v[52:55], v[112:127]
  ds_read_b64 v[76:77], v130 offset:896
  ds_read_b64 v[78:79], v130 offset:904
  v_mfma_f32_32x32x16_f16 v[112:127], v[44:47], v[48:51], v[112:127]
  ds_read_b128 v[80:83], v131 offset:1120
  ds_read_b128 v[84:87], v131 offset:3680
  s_waitcnt lgkmcnt(6)
  v_mfma_f32_32x32x16_f16 v[96:111], v[56:59], v[64:67], v[96:111]
  ds_read_b64 v[40:41], v130 offset:2880
  ds_read_b64 v[42:43], v130 offset:2888
  v_mfma_f32_32x32x16_f16 v[112:127], v[56:59], v[68:71], v[112:127]
  ds_read_b64 v[44:45], v130 offset:832
  ds_read_b64 v[46:47], v130 offset:840
  v_mfma_f32_32x32x16_f16 v[112:127], v[60:63], v[64:67], v[112:127]
  ds_read_b128 v[48:51], v131 offset:1040
  ds_read_b128 v[52:55], v131 offset:3600
  s_waitcnt lgkmcnt(6)
  v_mfma_f32_32x32x16_f16 v[96:111], v[72:75], v[80:83], v[96:111]
  ds_read_b64 v[56:57], v130 offset:2816
  ds_read_b64 v[58:59], v130 offset:2824
  v_mfma_f32_32x32x16_f16 v[112:127], v[72:75], v[84:87], v[112:127]
  ds_read_b64 v[60:61], v130 offset:768
  ds_read_b64 v[62:63], v130 offset:776
  v_mfma_f32_32x32x16_f16 v[112:127], v[76:79], v[80:83], v[112:127]
  ds_read_b128 v[64:67], v131 offset:960
  ds_read_b128 v[68:71], v131 offset:3520
  s_waitcnt lgkmcnt(6)
  v_mfma_f32_32x32x16_f16 v[96:111], v[40:43], v[48:51], v[96:111]
  ds_read_b64 v[72:73], v130 offset:2752
  ds_read_b64 v[74:75], v130 offset:2760
  v_mfma_f32_32x32x16_f16 v[112:127], v[40:43], v[52:55], v[112:127]
  ds_read_b64 v[76:77], v130 offset:704
  ds_read_b64 v[78:79], v130 offset:712
  v_mfma_f32_32x32x16_f16 v[112:127], v[44:47], v[48:51], v[112:127]
  ds_read_b128 v[80:83], v131 offset:880
  ds_read_b128 v[84:87], v131 offset:3440
  s_waitcnt lgkmcnt(6)
  v_mfma_f32_32x32x16_f16 v[96:111], v[56:59], v[64:67], v[96:111]
  ds_read_b64 v[40:41], v130 offset:2688
  ds_read_b64 v[42:43], v130 offset:2696
  v_mfma_f32_32x32x16_f16 v[112:127], v[56:59], v[68:71], v[112:127]
  ds_read_b64 v[44:45], v130 offset:640
  ds_read_b64 v[46:47], v130 offset:648
  v_mfma_f32_32x32x16_f16 v[112:127], v[60:63], v[64:67], v[112:127]
  ds_read_b128 v[48:51], v131 offset:800
  ds_read_b128 v[52:55], v131 offset:3360
  s_waitcnt lgkmcnt(6)
  v_mfma_f32_32x32x16_f16 v[96:111], v[72:75], v[80:83], v[96:111]
  ds_read_b64 v[56:57], v130 offset:2624
  ds_read_b64 v[58:59], v130 offset:2632
  v_mfma_f32_32x32x16_f16 v[112:127], v[72:75], v[84:87], v[112:127]
  ds_read_b64 v[60:61], v130 offset:576
  ds_read_b64 v[62:63], v130 offset:584
  v_mfma_f32_32x32x16_f16 v[112:127], v[76:79], v[80:83], v[112:127]
  ds_read_b128 v[64:67], v131 offset:720
  ds_read_b128 v[68:71], v131 offset:3280
  s_waitcnt lgkmcnt(6)
  v_mfma_f32_32x32x16_f16 v[96:111], v[40:43], v[48:51], v[96:111]
  ds_read_b64 v[72:73], v130 offset:2560
  ds_read_b64 v[74:75], v130 offset:2568
  v_mfma_f32_32x32x16_f16 v[112:127], v[40:43], v[52:55], v[112:127]
  ds_read_b64 v[76:77], v130 offset:512
  ds_read_b64 v[78:79], v130 offset:520
  v_mfma_f32_32x32x16_f16 v[112:127], v[44:47], v[48:51], v[112:127]
  ds_read_b128 v[80:83], v131 offset:640
  ds_read_b128 v[84:87], v131 offset:3200
  s_waitcnt lgkmcnt(6)
  v_mfma_f32_32x32x16_f16 v[96:111], v[56:59], v[64:67], v[96:111]
  ds_read_b64 v[40:41], v130 offset:2496
  ds_read_b64 v[42:43], v130 offset:2504
  v_mfma_f32_32x32x16_f16 v[112:127], v[56:59], v[68:71], v[112:127]
  ds_read_b64 v[44:45], v130 offset:448
  ds_read_b64 v[46:47], v130 offset:456
  v_mfma_f32_32x32x16_f16 v[112:127], v[60:63], v[64:67], v[112:127]
  ds_read_b128 v[48:51], v131 offset:560
  ds_read_b128 v[52:55], v131 offset:3120
  s_waitcnt lgkmcnt(6)
  v_mfma_f32_32x32x16_f16 v[96:111], v[72:75], v[80:83], v[96:111]
  ds_read_b64 v[56:57], v130 offset:2432
  ds_read_b64 v[58:59], v130 offset:2440
  v_mfma_f32_32x32x16_f16 v[112:127], v[72:75], v[84:87], v[112:127]
  ds_read_b64 v[60:61], v130 offset:384
  ds_read_b64 v[62:63], v130 offset:392
  v_mfma_f32_32x32x16_f16 v[112:127], v[76:79], v[80:83], v[112:127]
  ds_read_b128 v[64:67], v131 offset:480
  ds_read_b128 v[68:71], v131 offset:3040
  s_waitcnt lgkmcnt(6)
  v_mfma_f32_32x32x16_f16 v[96:111], v[40:43], v[48:51], v[96:111]
  ds_read_b64 v[72:73], v130 offset:2368
  ds_read_b64 v[74:75], v130 offset:2376
  v_mfma_f32_32x32x16_f16 v[112:127], v[40:43], v[52:55], v[112:127]
  ds_read_b64 v[76:77], v130 offset:320
  ds_read_b64 v[78:79], v130 offset:328
  v_mfma_f32_32x32x16_f16 v[112:127], v[44:47], v[48:51], v[112:127]
  ds_read_b128 v[80:83], v131 offset:400
  ds_read_b128 v[84:87], v131 offset:2960
  s_waitcnt lgkmcnt(6)
  v_mfma_f32_32x32x16_f16 v[96:111], v[56:59], v[64:67], v[96:111]
  ds_read_b64 v[40:41], v130 offset:2304
  ds_read_b64 v[42:43], v130 offset:2312
  v_mfma_f32_32x32x16_f16 v[112:127], v[56:59], v[68:71], v[112:127]
  ds_read_b64 v[44:45], v130 offset:256
  ds_read_b64 v[46:47], v130 offset:264
  v_mfma_f32_32x32x16_f16 v[112:127], v[60:63], v[64:67], v[112:127]
  ds_read_b128 v[48:51], v131 offset:320
  ds_read_b128 v[52:55], v131 offset:2880
  s_waitcnt lgkmcnt(6)
  v_mfma_f32_32x32x16_f16 v[96:111], v[72:75], v[80:83], v[96:111]
  ds_read_b64 v[56:57], v130 offset:2240
  ds_read_b64 v[58:59], v130 offset:2248
  v_mfma_f32_32x32x16_f16 v[112:127], v[72:75], v[84:87], v[112:127]
  ds_read_b64 v[60:61], v130 offset:192
  ds_read_b64 v[62:63], v130 offset:200
  v_mfma_f32_32x32x16_f16 v[112:127], v[76:79], v[80:83], v[112:127]
  ds_read_b128 v[64:67], v131 offset:240
  ds_read_b128 v[68:71], v131 offset:2800
  s_waitcnt lgkmcnt(6)
  v_mfma_f32_32x32x16_f16 v[96:111], v[40:43], v[48:51], v[96:111]
  ds_read_b64 v[72:73], v130 offset:2176
  ds_read_b64 v[74:75], v130 offset:2184
  v_mfma_f32_32x32x16_f16 v[112:127], v[40:43], v[52:55], v[112:127]
  ds_read_b64 v[76:77], v130 offset:128
  ds_read_b64 v[78:79], v130 offset:136
  v_mfma_f32_32x32x16_f16 v[112:127], v[44:47], v[48:51], v[112:127]
  ds_read_b128 v[80:83], v131 offset:160
  ds_read_b128 v[84:87], v131 offset:2720
  s_waitcnt lgkmcnt(6)
  v_mfma_f32_32x32x16_f16 v[96:111], v[56:59], v[64:67], v[96:111]
  ds_read_b64 v[40:41], v130 offset:2112
  ds_read_b64 v[42:43], v130 offset:2120
  v_mfma_f32_32x32x16_f16 v[112:127], v[56:59], v[68:71], v[112:127]
  ds_read_b64 v[44:45], v130 offset:64
  ds_read_b64 v[46:47], v130 offset:72
  v_mfma_f32_32x32x16_f16 v[112:127], v[60:63], v[64:67], v[112:127]
  ds_read_b128 v[48:51], v131 offset:80
  ds_read_b128 v[52:55], v131 offset:2640
  s_waitcnt lgkmcnt(6)
  v_mfma_f32_32x32x16_f16 v[96:111], v[72:75], v[80:83], v[96:111]
  ds_read_b64 v[56:57], v130 offset:2048
  ds_read_b64 v[58:59], v130 offset:2056
  v_mfma_f32_32x32x16_f16 v[112:127], v[72:75], v[84:87], v[112:127]
  ds_read_b64 v[60:61], v130 offset:0
  ds_read_b64 v[62:63], v130 offset:8
  v_mfma_f32_32x32x16_f16 v[112:127], v[76:79], v[80:83], v[112:127]
  ds_read_b128 v[64:67], v131 offset:0
  ds_read_b128 v[68:71], v131 offset:2560
  s_waitcnt lgkmcnt(6)
  v_mfma_f32_32x32x16_f16 v[96:111], v[40:43], v[48:51], v[96:111]
  v_mfma_f32_32x32x16_f16 v[112:127], v[40:43], v[52:55], v[112:127]
  v_mfma_f32_32x32x16_f16 v[112:127], v[44:47], v[48:51], v[112:127]
  ds_read_b64 v[32:33], v132 offset:0
  ds_read_b64 v[34:35], v132 offset:16
  ds_read_b64 v[36:37], v132 offset:32
  ds_read_b64 v[38:39], v132 offset:48
  s_waitcnt lgkmcnt(4)
  v_mfma_f32_32x32x16_f16 v[96:111], v[56:59], v[64:67], v[96:111]
  v_mfma_f32_32x32x16_f16 v[112:127], v[56:59], v[68:71], v[112:127]
  v_mfma_f32_32x32x16_f16 v[112:127], v[60:63], v[64:67], v[112:127]
  s_lshl_b32 s16, s20, 12
  v_add_u32 v24, s16, v139
  v_xor_b32 v25, 4096, v24
  v_lshrrev_b32 v7, 3, v1
  v_lshlrev_b32 v7, 16, v7
  v_and_b32 v26, 7, v1
  v_lshl_add_u32 v7, v26, 4, v7
  s_lshl_b32 s17, s20, 11
  s_add_u32 s17, s17, 16384
  v_lshlrev_b32 v26, 6, v128
  v_lshl_add_u32 v26, v129, 5, v26
  v_add_u32 v26, s17, v26
  v_add_u32 v27, s17, v139
  s_lshl_b32 s15, s23, 20
  s_lshl_b32 s16, s22, 7
  s_add_u32 s15, s15, s16
  s_add_u32 s15, s15, 10485760
  s_waitcnt lgkmcnt(0)
  s_barrier
  s_cmp_eq_u32 s23, 0
  s_cbranch_scc0 CV_H1
  ds_write_b128 v24, v[112:115] offset:0
  ds_write_b128 v24, v[116:119] offset:1024
  ds_write_b128 v24, v[120:123] offset:2048
  ds_write_b128 v24, v[124:127] offset:3072
  v_cvt_f32_f16 v60, v32
  v_cvt_f32_f16_sdwa v61, v32 dst_sel:DWORD dst_unused:UNUSED_PAD src0_sel:WORD_1
  v_pk_mul_f32 v[60:61], v[60:61], s[26:27] op_sel_hi:[1,0]
  v_cvt_pk_bf16_f32 v60, v60, v61
  v_and_b32 v61, 0xffff0000, v60
  v_lshlrev_b32 v60, 16, v60
  v_cvt_f32_f16 v62, v33
  v_cvt_f32_f16_sdwa v63, v33 dst_sel:DWORD dst_unused:UNUSED_PAD src0_sel:WORD_1
  v_pk_mul_f32 v[62:63], v[62:63], s[26:27] op_sel_hi:[1,0]
  v_cvt_pk_bf16_f32 v62, v62, v63
  v_and_b32 v63, 0xffff0000, v62
  v_lshlrev_b32 v62, 16, v62
  v_cvt_f32_f16 v64, v34
  v_cvt_f32_f16_sdwa v65, v34 dst_sel:DWORD dst_unused:UNUSED_PAD src0_sel:WORD_1
  v_pk_mul_f32 v[64:65], v[64:65], s[26:27] op_sel_hi:[1,0]
  v_cvt_pk_bf16_f32 v64, v64, v65
  v_and_b32 v65, 0xffff0000, v64
  v_lshlrev_b32 v64, 16, v64
  v_cvt_f32_f16 v66, v35
  v_cvt_f32_f16_sdwa v67, v35 dst_sel:DWORD dst_unused:UNUSED_PAD src0_sel:WORD_1
  v_pk_mul_f32 v[66:67], v[66:67], s[26:27] op_sel_hi:[1,0]
  v_cvt_pk_bf16_f32 v66, v66, v67
  v_and_b32 v67, 0xffff0000, v66
  v_lshlrev_b32 v66, 16, v66
  v_cvt_f32_f16 v68, v36
  v_cvt_f32_f16_sdwa v69, v36 dst_sel:DWORD dst_unused:UNUSED_PAD src0_sel:WORD_1
  v_pk_mul_f32 v[68:69], v[68:69], s[26:27] op_sel_hi:[1,0]
  v_cvt_pk_bf16_f32 v68, v68, v69
  v_and_b32 v69, 0xffff0000, v68
  v_lshlrev_b32 v68, 16, v68
  v_cvt_f32_f16 v70, v37
  v_cvt_f32_f16_sdwa v71, v37 dst_sel:DWORD dst_unused:UNUSED_PAD src0_sel:WORD_1
  v_pk_mul_f32 v[70:71], v[70:71], s[26:27] op_sel_hi:[1,0]
  v_cvt_pk_bf16_f32 v70, v70, v71
  v_and_b32 v71, 0xffff0000, v70
  v_lshlrev_b32 v70, 16, v70
  v_cvt_f32_f16 v72, v38
  v_cvt_f32_f16_sdwa v73, v38 dst_sel:DWORD dst_unused:UNUSED_PAD src0_sel:WORD_1
  v_pk_mul_f32 v[72:73], v[72:73], s[26:27] op_sel_hi:[1,0]
  v_cvt_pk_bf16_f32 v72, v72, v73
  v_and_b32 v73, 0xffff0000, v72
  v_lshlrev_b32 v72, 16, v72
  v_cvt_f32_f16 v74, v39
  v_cvt_f32_f16_sdwa v75, v39 dst_sel:DWORD dst_unused:UNUSED_PAD src0_sel:WORD_1
  v_pk_mul_f32 v[74:75], v[74:75], s[26:27] op_sel_hi:[1,0]
  v_cvt_pk_bf16_f32 v74, v74, v75
  v_and_b32 v75, 0xffff0000, v74
  v_lshlrev_b32 v74, 16, v74
  s_waitcnt lgkmcnt(0)
  s_barrier
  ds_read_b128 v[40:43], v25 offset:0
  ds_read_b128 v[44:47], v25 offset:1024
  ds_read_b128 v[48:51], v25 offset:2048
  ds_read_b128 v[52:55], v25 offset:3072
  s_waitcnt vmcnt(1)
  v_lshlrev_b32 v112, 16, v16
  v_and_b32 v113, 0xffff0000, v16
  v_lshlrev_b32 v114, 16, v17
  v_and_b32 v115, 0xffff0000, v17
  v_lshlrev_b32 v116, 16, v18
  v_and_b32 v117, 0xffff0000, v18
  v_lshlrev_b32 v118, 16, v19
  v_and_b32 v119, 0xffff0000, v19
  v_lshlrev_b32 v120, 16, v20
  v_and_b32 v121, 0xffff0000, v20
  v_lshlrev_b32 v122, 16, v21
  v_and_b32 v123, 0xffff0000, v21
  v_lshlrev_b32 v124, 16, v22
  v_and_b32 v125, 0xffff0000, v22
  v_lshlrev_b32 v126, 16, v23
  v_and_b32 v127, 0xffff0000, v23
  v_mov_b64 v[8:9], v[112:113]
  v_mov_b64 v[10:11], v[114:115]
  v_mov_b64 v[12:13], v[116:117]
  v_mov_b64 v[14:15], v[118:119]
  v_mov_b64 v[16:17], v[120:121]
  v_mov_b64 v[18:19], v[122:123]
  v_mov_b64 v[20:21], v[124:125]
  v_mov_b64 v[22:23], v[126:127]
  s_waitcnt lgkmcnt(0)
  v_pk_add_f32 v[40:41], v[40:41], v[96:97]
  v_pk_add_f32 v[42:43], v[42:43], v[98:99]
  v_pk_add_f32 v[44:45], v[44:45], v[100:101]
  v_pk_add_f32 v[46:47], v[46:47], v[102:103]
  v_pk_add_f32 v[48:49], v[48:49], v[104:105]
  v_pk_add_f32 v[50:51], v[50:51], v[106:107]
  v_pk_add_f32 v[52:53], v[52:53], v[108:109]
  v_pk_add_f32 v[54:55], v[54:55], v[110:111]
  s_branch CV_EP
CV_H1:
  ds_write_b128 v24, v[96:99] offset:0
  ds_write_b128 v24, v[100:103] offset:1024
  ds_write_b128 v24, v[104:107] offset:2048
  ds_write_b128 v24, v[108:111] offset:3072
  v_cvt_f32_f16 v60, v32
  v_cvt_f32_f16_sdwa v61, v32 dst_sel:DWORD dst_unused:UNUSED_PAD src0_sel:WORD_1
  v_pk_mul_f32 v[60:61], v[60:61], s[26:27] op_sel_hi:[1,0]
  v_cvt_pk_bf16_f32 v60, v60, v61
  v_and_b32 v61, 0xffff0000, v60
  v_lshlrev_b32 v60, 16, v60
  v_cvt_f32_f16 v62, v33
  v_cvt_f32_f16_sdwa v63, v33 dst_sel:DWORD dst_unused:UNUSED_PAD src0_sel:WORD_1
  v_pk_mul_f32 v[62:63], v[62:63], s[26:27] op_sel_hi:[1,0]
  v_cvt_pk_bf16_f32 v62, v62, v63
  v_and_b32 v63, 0xffff0000, v62
  v_lshlrev_b32 v62, 16, v62
  v_cvt_f32_f16 v64, v34
  v_cvt_f32_f16_sdwa v65, v34 dst_sel:DWORD dst_unused:UNUSED_PAD src0_sel:WORD_1
  v_pk_mul_f32 v[64:65], v[64:65], s[26:27] op_sel_hi:[1,0]
  v_cvt_pk_bf16_f32 v64, v64, v65
  v_and_b32 v65, 0xffff0000, v64
  v_lshlrev_b32 v64, 16, v64
  v_cvt_f32_f16 v66, v35
  v_cvt_f32_f16_sdwa v67, v35 dst_sel:DWORD dst_unused:UNUSED_PAD src0_sel:WORD_1
  v_pk_mul_f32 v[66:67], v[66:67], s[26:27] op_sel_hi:[1,0]
  v_cvt_pk_bf16_f32 v66, v66, v67
  v_and_b32 v67, 0xffff0000, v66
  v_lshlrev_b32 v66, 16, v66
  v_cvt_f32_f16 v68, v36
  v_cvt_f32_f16_sdwa v69, v36 dst_sel:DWORD dst_unused:UNUSED_PAD src0_sel:WORD_1
  v_pk_mul_f32 v[68:69], v[68:69], s[26:27] op_sel_hi:[1,0]
  v_cvt_pk_bf16_f32 v68, v68, v69
  v_and_b32 v69, 0xffff0000, v68
  v_lshlrev_b32 v68, 16, v68
  v_cvt_f32_f16 v70, v37
  v_cvt_f32_f16_sdwa v71, v37 dst_sel:DWORD dst_unused:UNUSED_PAD src0_sel:WORD_1
  v_pk_mul_f32 v[70:71], v[70:71], s[26:27] op_sel_hi:[1,0]
  v_cvt_pk_bf16_f32 v70, v70, v71
  v_and_b32 v71, 0xffff0000, v70
  v_lshlrev_b32 v70, 16, v70
  v_cvt_f32_f16 v72, v38
  v_cvt_f32_f16_sdwa v73, v38 dst_sel:DWORD dst_unused:UNUSED_PAD src0_sel:WORD_1
  v_pk_mul_f32 v[72:73], v[72:73], s[26:27] op_sel_hi:[1,0]
  v_cvt_pk_bf16_f32 v72, v72, v73
  v_and_b32 v73, 0xffff0000, v72
  v_lshlrev_b32 v72, 16, v72
  v_cvt_f32_f16 v74, v39
  v_cvt_f32_f16_sdwa v75, v39 dst_sel:DWORD dst_unused:UNUSED_PAD src0_sel:WORD_1
  v_pk_mul_f32 v[74:75], v[74:75], s[26:27] op_sel_hi:[1,0]
  v_cvt_pk_bf16_f32 v74, v74, v75
  v_and_b32 v75, 0xffff0000, v74
  v_lshlrev_b32 v74, 16, v74
  s_waitcnt lgkmcnt(0)
  s_barrier
  ds_read_b128 v[40:43], v25 offset:0
  ds_read_b128 v[44:47], v25 offset:1024
  ds_read_b128 v[48:51], v25 offset:2048
  ds_read_b128 v[52:55], v25 offset:3072
  s_waitcnt vmcnt(1)
  v_lshlrev_b32 v96, 16, v16
  v_and_b32 v97, 0xffff0000, v16
  v_lshlrev_b32 v98, 16, v17
  v_and_b32 v99, 0xffff0000, v17
  v_lshlrev_b32 v100, 16, v18
  v_and_b32 v101, 0xffff0000, v18
  v_lshlrev_b32 v102, 16, v19
  v_and_b32 v103, 0xffff0000, v19
  v_lshlrev_b32 v104, 16, v20
  v_and_b32 v105, 0xffff0000, v20
  v_lshlrev_b32 v106, 16, v21
  v_and_b32 v107, 0xffff0000, v21
  v_lshlrev_b32 v108, 16, v22
  v_and_b32 v109, 0xffff0000, v22
  v_lshlrev_b32 v110, 16, v23
  v_and_b32 v111, 0xffff0000, v23
  v_mov_b64 v[8:9], v[96:97]
  v_mov_b64 v[10:11], v[98:99]
  v_mov_b64 v[12:13], v[100:101]
  v_mov_b64 v[14:15], v[102:103]
  v_mov_b64 v[16:17], v[104:105]
  v_mov_b64 v[18:19], v[106:107]
  v_mov_b64 v[20:21], v[108:109]
  v_mov_b64 v[22:23], v[110:111]
  s_waitcnt lgkmcnt(0)
  v_pk_add_f32 v[40:41], v[40:41], v[112:113]
  v_pk_add_f32 v[42:43], v[42:43], v[114:115]
  v_pk_add_f32 v[44:45], v[44:45], v[116:117]
  v_pk_add_f32 v[46:47], v[46:47], v[118:119]
  v_pk_add_f32 v[48:49], v[48:49], v[120:121]
  v_pk_add_f32 v[50:51], v[50:51], v[122:123]
  v_pk_add_f32 v[52:53], v[52:53], v[124:125]
  v_pk_add_f32 v[54:55], v[54:55], v[126:127]
CV_EP:
  v_pk_mul_f32 v[40:41], v[40:41], s[24:25] op_sel_hi:[1,0]
  v_cvt_pk_bf16_f32 v40, v40, v41
  v_and_b32 v41, 0xffff0000, v40
  v_lshlrev_b32 v40, 16, v40
  v_pk_add_f32 v[40:41], v[40:41], v[60:61]
  v_cvt_pk_bf16_f32 v40, v40, v41
  v_and_b32 v41, 0xffff0000, v40
  v_lshlrev_b32 v40, 16, v40
  v_pk_mul_f32 v[40:41], v[40:41], s[28:29] op_sel_hi:[1,0]
  v_cvt_pk_bf16_f32 v40, v40, v41
  v_and_b32 v41, 0xffff0000, v40
  v_lshlrev_b32 v40, 16, v40
  v_pk_add_f32 v[40:41], v[40:41], v[8:9]
  v_cvt_pk_bf16_f32 v80, v40, v41
  v_pk_mul_f32 v[42:43], v[42:43], s[24:25] op_sel_hi:[1,0]
  v_cvt_pk_bf16_f32 v42, v42, v43
  v_and_b32 v43, 0xffff0000, v42
  v_lshlrev_b32 v42, 16, v42
  v_pk_add_f32 v[42:43], v[42:43], v[62:63]
  v_cvt_pk_bf16_f32 v42, v42, v43
  v_and_b32 v43, 0xffff0000, v42
  v_lshlrev_b32 v42, 16, v42
  v_pk_mul_f32 v[42:43], v[42:43], s[28:29] op_sel_hi:[1,0]
  v_cvt_pk_bf16_f32 v42, v42, v43
  v_and_b32 v43, 0xffff0000, v42
  v_lshlrev_b32 v42, 16, v42
  v_pk_add_f32 v[42:43], v[42:43], v[10:11]
  v_cvt_pk_bf16_f32 v81, v42, v43
  v_pk_mul_f32 v[44:45], v[44:45], s[24:25] op_sel_hi:[1,0]
  v_cvt_pk_bf16_f32 v44, v44, v45
  v_and_b32 v45, 0xffff0000, v44
  v_lshlrev_b32 v44, 16, v44
  v_pk_add_f32 v[44:45], v[44:45], v[64:65]
  v_cvt_pk_bf16_f32 v44, v44, v45
  v_and_b32 v45, 0xffff0000, v44
  v_lshlrev_b32 v44, 16, v44
  v_pk_mul_f32 v[44:45], v[44:45], s[28:29] op_sel_hi:[1,0]
  v_cvt_pk_bf16_f32 v44, v44, v45
  v_and_b32 v45, 0xffff0000, v44
  v_lshlrev_b32 v44, 16, v44
  v_pk_add_f32 v[44:45], v[44:45], v[12:13]
  v_cvt_pk_bf16_f32 v82, v44, v45
  v_pk_mul_f32 v[46:47], v[46:47], s[24:25] op_sel_hi:[1,0]
  v_cvt_pk_bf16_f32 v46, v46, v47
  v_and_b32 v47, 0xffff0000, v46
  v_lshlrev_b32 v46, 16, v46
  v_pk_add_f32 v[46:47], v[46:47], v[66:67]
  v_cvt_pk_bf16_f32 v46, v46, v47
  v_and_b32 v47, 0xffff0000, v46
  v_lshlrev_b32 v46, 16, v46
  v_pk_mul_f32 v[46:47], v[46:47], s[28:29] op_sel_hi:[1,0]
  v_cvt_pk_bf16_f32 v46, v46, v47
  v_and_b32 v47, 0xffff0000, v46
  v_lshlrev_b32 v46, 16, v46
  v_pk_add_f32 v[46:47], v[46:47], v[14:15]
  v_cvt_pk_bf16_f32 v83, v46, v47
  ds_write_b128 v26, v[80:83]
  v_pk_mul_f32 v[48:49], v[48:49], s[24:25] op_sel_hi:[1,0]
  v_cvt_pk_bf16_f32 v48, v48, v49
  v_and_b32 v49, 0xffff0000, v48
  v_lshlrev_b32 v48, 16, v48
  v_pk_add_f32 v[48:49], v[48:49], v[68:69]
  v_cvt_pk_bf16_f32 v48, v48, v49
  v_and_b32 v49, 0xffff0000, v48
  v_lshlrev_b32 v48, 16, v48
  v_pk_mul_f32 v[48:49], v[48:49], s[28:29] op_sel_hi:[1,0]
  v_cvt_pk_bf16_f32 v48, v48, v49
  v_and_b32 v49, 0xffff0000, v48
  v_lshlrev_b32 v48, 16, v48
  v_pk_add_f32 v[48:49], v[48:49], v[16:17]
  v_cvt_pk_bf16_f32 v84, v48, v49
  v_pk_mul_f32 v[50:51], v[50:51], s[24:25] op_sel_hi:[1,0]
  v_cvt_pk_bf16_f32 v50, v50, v51
  v_and_b32 v51, 0xffff0000, v50
  v_lshlrev_b32 v50, 16, v50
  v_pk_add_f32 v[50:51], v[50:51], v[70:71]
  v_cvt_pk_bf16_f32 v50, v50, v51
  v_and_b32 v51, 0xffff0000, v50
  v_lshlrev_b32 v50, 16, v50
  v_pk_mul_f32 v[50:51], v[50:51], s[28:29] op_sel_hi:[1,0]
  v_cvt_pk_bf16_f32 v50, v50, v51
  v_and_b32 v51, 0xffff0000, v50
  v_lshlrev_b32 v50, 16, v50
  v_pk_add_f32 v[50:51], v[50:51], v[18:19]
  v_cvt_pk_bf16_f32 v85, v50, v51
  v_pk_mul_f32 v[52:53], v[52:53], s[24:25] op_sel_hi:[1,0]
  v_cvt_pk_bf16_f32 v52, v52, v53
  v_and_b32 v53, 0xffff0000, v52
  v_lshlrev_b32 v52, 16, v52
  v_pk_add_f32 v[52:53], v[52:53], v[72:73]
  v_cvt_pk_bf16_f32 v52, v52, v53
  v_and_b32 v53, 0xffff0000, v52
  v_lshlrev_b32 v52, 16, v52
  v_pk_mul_f32 v[52:53], v[52:53], s[28:29] op_sel_hi:[1,0]
  v_cvt_pk_bf16_f32 v52, v52, v53
  v_and_b32 v53, 0xffff0000, v52
  v_lshlrev_b32 v52, 16, v52
  v_pk_add_f32 v[52:53], v[52:53], v[20:21]
  v_cvt_pk_bf16_f32 v86, v52, v53
  v_pk_mul_f32 v[54:55], v[54:55], s[24:25] op_sel_hi:[1,0]
  v_cvt_pk_bf16_f32 v54, v54, v55
  v_and_b32 v55, 0xffff0000, v54
  v_lshlrev_b32 v54, 16, v54
  v_pk_add_f32 v[54:55], v[54:55], v[74:75]
  v_cvt_pk_bf16_f32 v54, v54, v55
  v_and_b32 v55, 0xffff0000, v54
  v_lshlrev_b32 v54, 16, v54
  v_pk_mul_f32 v[54:55], v[54:55], s[28:29] op_sel_hi:[1,0]
  v_cvt_pk_bf16_f32 v54, v54, v55
  v_and_b32 v55, 0xffff0000, v54
  v_lshlrev_b32 v54, 16, v54
  v_pk_add_f32 v[54:55], v[54:55], v[22:23]
  v_cvt_pk_bf16_f32 v87, v54, v55
  ds_write_b128 v26, v[84:87] offset:16
  ds_read_b128 v[80:83], v27
  ds_read_b128 v[84:87], v27 offset:1024
  s_add_u32 s16, s15, 524288
  s_waitcnt lgkmcnt(1)
  buffer_store_dwordx4 v[80:83], v7, s[44:47], s15 offen sc1
  s_waitcnt lgkmcnt(0)
  buffer_store_dwordx4 v[84:87], v7, s[44:47], s16 offen sc1
  s_endpgm
F_MOD:
  s_setprio 2
  s_load_dwordx2 s[24:25], s[0:1], 104
  s_load_dwordx2 s[28:29], s[0:1], 96
  s_load_dwordx2 s[32:33], s[0:1], 128
  s_load_dwordx2 s[36:37], s[0:1], 120
  s_load_dwordx2 s[40:41], s[0:1], 72
  s_sub_u32 s3, s2, 384
  s_lshr_b32 s4, s3, 1
  s_and_b32 s5, s3, 1
  v_lshrrev_b32 v2, 3, v1
  s_lshl_b32 s6, s5, 8
  s_lshl_b32 s7, s20, 6
  s_add_u32 s6, s6, s7
  v_add_u32 v2, s6, v2
  v_mul_u32_u24 v3, 6144, v2
  v_and_b32 v4, 7, v1
  v_lshl_add_u32 v3, v4, 4, v3
  s_lshl_b32 s7, s4, 7
  v_lshlrev_b32 v5, 1, v2
  s_waitcnt lgkmcnt(0)
  s_mov_b32 s26, 0x300000
  s_mov_b32 s27, 0x20000
  s_mov_b32 s30, 0x400
  s_mov_b32 s31, 0x20000
  s_mov_b32 s34, 0x2000000
  s_mov_b32 s35, 0x20000
  s_mov_b32 s38, 0x100
  s_mov_b32 s39, 0x20000
  s_mov_b32 s42, 0x800000
  s_mov_b32 s43, 0x20000
  buffer_load_dwordx4 v[40:43], v3, s[24:27], s7 offen nt
  s_add_u32 s7, s7, 49152
  buffer_load_dwordx4 v[44:47], v3, s[24:27], s7 offen nt
  s_add_u32 s7, s7, 49152
  buffer_load_dwordx4 v[48:51], v3, s[24:27], s7 offen nt
  s_add_u32 s7, s7, 49152
  buffer_load_dwordx4 v[52:55], v3, s[24:27], s7 offen nt
  s_add_u32 s7, s7, 49152
  buffer_load_dwordx4 v[56:59], v3, s[24:27], s7 offen nt
  s_add_u32 s7, s7, 49152
  buffer_load_dwordx4 v[60:63], v3, s[24:27], s7 offen nt
  s_add_u32 s7, s7, 49152
  buffer_load_dwordx4 v[64:67], v3, s[24:27], s7 offen nt
  s_add_u32 s7, s7, 49152
  buffer_load_dwordx4 v[68:71], v3, s[24:27], s7 offen nt
  buffer_load_ushort v30, v5, s[28:31], 0 offen offset:0
  buffer_load_ushort v31, v5, s[28:31], 0 offen offset:16
  buffer_load_ushort v32, v5, s[28:31], 0 offen offset:32
  buffer_load_ushort v33, v5, s[28:31], 0 offen offset:48
  buffer_load_ushort v34, v5, s[28:31], 0 offen offset:64
  buffer_load_ushort v35, v5, s[28:31], 0 offen offset:80
  buffer_load_ushort v36, v5, s[28:31], 0 offen offset:96
  buffer_load_ushort v37, v5, s[28:31], 0 offen offset:112
  v_lshrrev_b32 v8, 4, v1
  s_lshl_b32 s8, s20, 2
  v_add_u32 v8, s8, v8
  v_lshlrev_b32 v8, 8, v8
  v_lshl_add_u32 v8, v4, 5, v8
  v_lshlrev_b32 v9, 2, v1
  s_waitcnt vmcnt(0)
  v_lshlrev_b32 v30, 16, v30
  v_mul_f32 v10, 0xbfb8aa3b, v30
  v_exp_f32 v10, v10
  s_nop 0
  v_add_f32 v10, 1.0, v10
  v_rcp_f32 v10, v10
  s_nop 0
  v_mul_f32 v30, v30, v10
  v_cvt_pk_bf16_f32 v30, v30, v30
  v_and_b32 v30, 0xffff0000, v30
  v_lshlrev_b32 v31, 16, v31
  v_mul_f32 v10, 0xbfb8aa3b, v31
  v_exp_f32 v10, v10
  s_nop 0
  v_add_f32 v10, 1.0, v10
  v_rcp_f32 v10, v10
  s_nop 0
  v_mul_f32 v31, v31, v10
  v_cvt_pk_bf16_f32 v31, v31, v31
  v_and_b32 v31, 0xffff0000, v31
  v_lshlrev_b32 v32, 16, v32
  v_mul_f32 v10, 0xbfb8aa3b, v32
  v_exp_f32 v10, v10
  s_nop 0
  v_add_f32 v10, 1.0, v10
  v_rcp_f32 v10, v10
  s_nop 0
  v_mul_f32 v32, v32, v10
  v_cvt_pk_bf16_f32 v32, v32, v32
  v_and_b32 v32, 0xffff0000, v32
  v_lshlrev_b32 v33, 16, v33
  v_mul_f32 v10, 0xbfb8aa3b, v33
  v_exp_f32 v10, v10
  s_nop 0
  v_add_f32 v10, 1.0, v10
  v_rcp_f32 v10, v10
  s_nop 0
  v_mul_f32 v33, v33, v10
  v_cvt_pk_bf16_f32 v33, v33, v33
  v_and_b32 v33, 0xffff0000, v33
  v_lshlrev_b32 v34, 16, v34
  v_mul_f32 v10, 0xbfb8aa3b, v34
  v_exp_f32 v10, v10
  s_nop 0
  v_add_f32 v10, 1.0, v10
  v_rcp_f32 v10, v10
  s_nop 0
  v_mul_f32 v34, v34, v10
  v_cvt_pk_bf16_f32 v34, v34, v34
  v_and_b32 v34, 0xffff0000, v34
  v_lshlrev_b32 v35, 16, v35
  v_mul_f32 v10, 0xbfb8aa3b, v35
  v_exp_f32 v10, v10
  s_nop 0
  v_add_f32 v10, 1.0, v10
  v_rcp_f32 v10, v10
  s_nop 0
  v_mul_f32 v35, v35, v10
  v_cvt_pk_bf16_f32 v35, v35, v35
  v_and_b32 v35, 0xffff0000, v35
  v_lshlrev_b32 v36, 16, v36
  v_mul_f32 v10, 0xbfb8aa3b, v36
  v_exp_f32 v10, v10
  s_nop 0
  v_add_f32 v10, 1.0, v10
  v_rcp_f32 v10, v10
  s_nop 0
  v_mul_f32 v36, v36, v10
  v_cvt_pk_bf16_f32 v36, v36, v36
  v_and_b32 v36, 0xffff0000, v36
  v_lshlrev_b32 v37, 16, v37
  v_mul_f32 v10, 0xbfb8aa3b, v37
  v_exp_f32 v10, v10
  s_nop 0
  v_add_f32 v10, 1.0, v10
  v_rcp_f32 v10, v10
  s_nop 0
  v_mul_f32 v37, v37, v10
  v_cvt_pk_bf16_f32 v37, v37, v37
  v_and_b32 v37, 0xffff0000, v37
  v_lshlrev_b32 v10, 16, v40
  v_and_b32 v11, 0xffff0000, v40
  v_mul_f32 v80, v10, v30
  v_mul_f32 v81, v11, v30
  v_lshlrev_b32 v10, 16, v41
  v_and_b32 v11, 0xffff0000, v41
  v_mul_f32 v82, v10, v30
  v_mul_f32 v83, v11, v30
  v_lshlrev_b32 v10, 16, v42
  v_and_b32 v11, 0xffff0000, v42
  v_mul_f32 v84, v10, v30
  v_mul_f32 v85, v11, v30
  v_lshlrev_b32 v10, 16, v43
  v_and_b32 v11, 0xffff0000, v43
  v_mul_f32 v86, v10, v30
  v_mul_f32 v87, v11, v30
  v_lshlrev_b32 v10, 16, v44
  v_and_b32 v11, 0xffff0000, v44
  v_fmac_f32 v80, v10, v31
  v_fmac_f32 v81, v11, v31
  v_lshlrev_b32 v10, 16, v45
  v_and_b32 v11, 0xffff0000, v45
  v_fmac_f32 v82, v10, v31
  v_fmac_f32 v83, v11, v31
  v_lshlrev_b32 v10, 16, v46
  v_and_b32 v11, 0xffff0000, v46
  v_fmac_f32 v84, v10, v31
  v_fmac_f32 v85, v11, v31
  v_lshlrev_b32 v10, 16, v47
  v_and_b32 v11, 0xffff0000, v47
  v_fmac_f32 v86, v10, v31
  v_fmac_f32 v87, v11, v31
  v_lshlrev_b32 v10, 16, v48
  v_and_b32 v11, 0xffff0000, v48
  v_fmac_f32 v80, v10, v32
  v_fmac_f32 v81, v11, v32
  v_lshlrev_b32 v10, 16, v49
  v_and_b32 v11, 0xffff0000, v49
  v_fmac_f32 v82, v10, v32
  v_fmac_f32 v83, v11, v32
  v_lshlrev_b32 v10, 16, v50
  v_and_b32 v11, 0xffff0000, v50
  v_fmac_f32 v84, v10, v32
  v_fmac_f32 v85, v11, v32
  v_lshlrev_b32 v10, 16, v51
  v_and_b32 v11, 0xffff0000, v51
  v_fmac_f32 v86, v10, v32
  v_fmac_f32 v87, v11, v32
  v_lshlrev_b32 v10, 16, v52
  v_and_b32 v11, 0xffff0000, v52
  v_fmac_f32 v80, v10, v33
  v_fmac_f32 v81, v11, v33
  v_lshlrev_b32 v10, 16, v53
  v_and_b32 v11, 0xffff0000, v53
  v_fmac_f32 v82, v10, v33
  v_fmac_f32 v83, v11, v33
  v_lshlrev_b32 v10, 16, v54
  v_and_b32 v11, 0xffff0000, v54
  v_fmac_f32 v84, v10, v33
  v_fmac_f32 v85, v11, v33
  v_lshlrev_b32 v10, 16, v55
  v_and_b32 v11, 0xffff0000, v55
  v_fmac_f32 v86, v10, v33
  v_fmac_f32 v87, v11, v33
  v_lshlrev_b32 v10, 16, v56
  v_and_b32 v11, 0xffff0000, v56
  v_fmac_f32 v80, v10, v34
  v_fmac_f32 v81, v11, v34
  v_lshlrev_b32 v10, 16, v57
  v_and_b32 v11, 0xffff0000, v57
  v_fmac_f32 v82, v10, v34
  v_fmac_f32 v83, v11, v34
  v_lshlrev_b32 v10, 16, v58
  v_and_b32 v11, 0xffff0000, v58
  v_fmac_f32 v84, v10, v34
  v_fmac_f32 v85, v11, v34
  v_lshlrev_b32 v10, 16, v59
  v_and_b32 v11, 0xffff0000, v59
  v_fmac_f32 v86, v10, v34
  v_fmac_f32 v87, v11, v34
  v_lshlrev_b32 v10, 16, v60
  v_and_b32 v11, 0xffff0000, v60
  v_fmac_f32 v80, v10, v35
  v_fmac_f32 v81, v11, v35
  v_lshlrev_b32 v10, 16, v61
  v_and_b32 v11, 0xffff0000, v61
  v_fmac_f32 v82, v10, v35
  v_fmac_f32 v83, v11, v35
  v_lshlrev_b32 v10, 16, v62
  v_and_b32 v11, 0xffff0000, v62
  v_fmac_f32 v84, v10, v35
  v_fmac_f32 v85, v11, v35
  v_lshlrev_b32 v10, 16, v63
  v_and_b32 v11, 0xffff0000, v63
  v_fmac_f32 v86, v10, v35
  v_fmac_f32 v87, v11, v35
  v_lshlrev_b32 v10, 16, v64
  v_and_b32 v11, 0xffff0000, v64
  v_fmac_f32 v80, v10, v36
  v_fmac_f32 v81, v11, v36
  v_lshlrev_b32 v10, 16, v65
  v_and_b32 v11, 0xffff0000, v65
  v_fmac_f32 v82, v10, v36
  v_fmac_f32 v83, v11, v36
  v_lshlrev_b32 v10, 16, v66
  v_and_b32 v11, 0xffff0000, v66
  v_fmac_f32 v84, v10, v36
  v_fmac_f32 v85, v11, v36
  v_lshlrev_b32 v10, 16, v67
  v_and_b32 v11, 0xffff0000, v67
  v_fmac_f32 v86, v10, v36
  v_fmac_f32 v87, v11, v36
  v_lshlrev_b32 v10, 16, v68
  v_and_b32 v11, 0xffff0000, v68
  v_fmac_f32 v80, v10, v37
  v_fmac_f32 v81, v11, v37
  v_lshlrev_b32 v10, 16, v69
  v_and_b32 v11, 0xffff0000, v69
  v_fmac_f32 v82, v10, v37
  v_fmac_f32 v83, v11, v37
  v_lshlrev_b32 v10, 16, v70
  v_and_b32 v11, 0xffff0000, v70
  v_fmac_f32 v84, v10, v37
  v_fmac_f32 v85, v11, v37
  v_lshlrev_b32 v10, 16, v71
  v_and_b32 v11, 0xffff0000, v71
  v_fmac_f32 v86, v10, v37
  v_fmac_f32 v87, v11, v37
  v_add_f32_dpp v80, v80, v80 row_shr:8 row_mask:0xf bank_mask:0xf
  v_add_f32_dpp v81, v81, v81 row_shr:8 row_mask:0xf bank_mask:0xf
  v_add_f32_dpp v82, v82, v82 row_shr:8 row_mask:0xf bank_mask:0xf
  v_add_f32_dpp v83, v83, v83 row_shr:8 row_mask:0xf bank_mask:0xf
  v_add_f32_dpp v84, v84, v84 row_shr:8 row_mask:0xf bank_mask:0xf
  v_add_f32_dpp v85, v85, v85 row_shr:8 row_mask:0xf bank_mask:0xf
  v_add_f32_dpp v86, v86, v86 row_shr:8 row_mask:0xf bank_mask:0xf
  v_add_f32_dpp v87, v87, v87 row_shr:8 row_mask:0xf bank_mask:0xf
  s_mov_b32 exec_lo, 0xff00ff00
  s_mov_b32 exec_hi, 0xff00ff00
  ds_write_b128 v8, v[80:83]
  ds_write_b128 v8, v[84:87] offset:16
  s_mov_b64 exec, -1
  s_waitcnt lgkmcnt(0)
  s_barrier
  s_cmp_eq_u32 s20, 0
  s_cbranch_scc1 MD_W0
  s_branch F_END
MD_W0:
  ds_read_b32 v12, v9 offset:0
  ds_read_b32 v13, v9 offset:256
  ds_read_b32 v14, v9 offset:512
  ds_read_b32 v15, v9 offset:768
  ds_read_b32 v16, v9 offset:1024
  ds_read_b32 v17, v9 offset:1280
  ds_read_b32 v18, v9 offset:1536
  ds_read_b32 v19, v9 offset:1792
  ds_read_b32 v20, v9 offset:2048
  ds_read_b32 v21, v9 offset:2304
  ds_read_b32 v22, v9 offset:2560
  ds_read_b32 v23, v9 offset:2816
  ds_read_b32 v24, v9 offset:3072
  ds_read_b32 v25, v9 offset:3328
  ds_read_b32 v26, v9 offset:3584
  ds_read_b32 v27, v9 offset:3840
  s_mul_i32 s9, s5, 24576
  s_lshl_b32 s10, s4, 8
  s_add_u32 s9, s9, s10
  s_add_u32 s9, s9, 262144
  s_add_u32 s10, s9, 12288
  s_waitcnt lgkmcnt(0)
  v_add_f32 v12, v12, v16
  v_add_f32 v13, v13, v17
  v_add_f32 v14, v14, v18
  v_add_f32 v15, v15, v19
  v_add_f32 v12, v12, v14
  v_add_f32 v13, v13, v15
  v_add_f32 v12, v12, v13
  v_add_f32 v20, v20, v24
  v_add_f32 v21, v21, v25
  v_add_f32 v22, v22, v26
  v_add_f32 v23, v23, v27
  v_add_f32 v20, v20, v22
  v_add_f32 v21, v21, v23
  v_add_f32 v20, v20, v21
  buffer_store_dword v12, v9, s[32:35], s9 offen sc0 sc1
  buffer_store_dword v20, v9, s[32:35], s10 offen sc0 sc1
  s_waitcnt vmcnt(0)
  v_mov_b32 v2, 1
  v_mov_b32 v3, 0
  s_mov_b64 exec, 1
  buffer_atomic_add v2, v3, s[36:39], 0 offen offset:64 sc0 sc1
  s_waitcnt vmcnt(0)
  v_cmp_eq_u32 vcc, 95, v2
  s_cbranch_vccz SG_M
  v_mov_b32 v2, 1
  buffer_store_dword v2, v3, s[36:39], 0 offen offset:132 sc0 sc1
SG_M:
  s_endpgm
F_X:
  s_setprio 2
  s_load_dwordx2 s[24:25], s[0:1], 0
  s_load_dwordx2 s[28:29], s[0:1], 128
  s_load_dwordx2 s[32:33], s[0:1], 120
  s_load_dwordx2 s[36:37], s[0:1], 72
  s_sub_u32 s3, s2, 256
  s_lshl_b32 s4, s3, 2
  s_add_u32 s4, s4, s20
  s_lshl_b32 s4, s4, 12
  v_lshlrev_b32 v2, 4, v1
  s_waitcnt lgkmcnt(0)
  s_mov_b32 s26, 0x200000
  s_mov_b32 s27, 0x20000
  s_mov_b32 s30, 0x2000000
  s_mov_b32 s31, 0x20000
  s_mov_b32 s34, 0x100
  s_mov_b32 s35, 0x20000
  s_mov_b32 s38, 0x800000
  s_mov_b32 s39, 0x20000
  buffer_load_dwordx4 v[32:35], v2, s[24:27], s4 offen offset:0 nt
  buffer_load_dwordx4 v[36:39], v2, s[24:27], s4 offen offset:1024 nt
  buffer_load_dwordx4 v[40:43], v2, s[24:27], s4 offen offset:2048 nt
  buffer_load_dwordx4 v[44:47], v2, s[24:27], s4 offen offset:3072 nt
  s_mul_i32 s5, s20, 4224
  v_add_u32 v3, s5, v2
  v_mov_b32 v4, 0x3f803f80
  v_lshrrev_b32 v5, 4, v1
  v_bfe_u32 v6, v1, 2, 2
  v_and_b32 v7, 3, v1
  v_and_b32 v8, 1, v5
  v_lshl_add_u32 v8, v8, 3, v6
  v_mul_u32_u24 v8, 1056, v8
  v_lshl_add_u32 v8, v7, 3, v8
  v_lshrrev_b32 v9, 1, v5
  v_lshl_add_u32 v8, v9, 5, v8
  s_lshl_b32 s6, s20, 8
  v_add_u32 v26, s6, v8
  v_and_b32 v10, 15, v1
  v_lshl_add_u32 v10, v9, 4, v10
  v_lshrrev_b32 v11, 2, v10
  v_lshlrev_b32 v11, 14, v11
  v_and_b32 v10, 3, v10
  v_lshl_add_u32 v11, v10, 4, v11
  v_and_b32 v10, 1, v5
  v_lshl_add_u32 v27, v10, 6, v11
  s_lshl_b32 s7, s20, 19
  s_lshl_b32 s8, s3, 7
  s_add_u32 s7, s7, s8
  s_waitcnt vmcnt(3)
  ds_write_b128 v3, v[32:35] offset:0
  s_waitcnt vmcnt(2)
  ds_write_b128 v3, v[36:39] offset:1056
  s_waitcnt vmcnt(1)
  ds_write_b128 v3, v[40:43] offset:2112
  s_waitcnt vmcnt(0)
  ds_write_b128 v3, v[44:47] offset:3168
  v_dot2_f32_bf16 v8, v32, v4, 0
  v_dot2_f32_bf16 v8, v33, v4, v8
  v_dot2_f32_bf16 v8, v34, v4, v8
  v_dot2_f32_bf16 v8, v35, v4, v8
  v_dot2_f32_bf16 v9, v36, v4, 0
  v_dot2_f32_bf16 v9, v37, v4, v9
  v_dot2_f32_bf16 v9, v38, v4, v9
  v_dot2_f32_bf16 v9, v39, v4, v9
  v_dot2_f32_bf16 v10, v40, v4, 0
  v_dot2_f32_bf16 v10, v41, v4, v10
  v_dot2_f32_bf16 v10, v42, v4, v10
  v_dot2_f32_bf16 v10, v43, v4, v10
  v_dot2_f32_bf16 v11, v44, v4, 0
  v_dot2_f32_bf16 v11, v45, v4, v11
  v_dot2_f32_bf16 v11, v46, v4, v11
  v_dot2_f32_bf16 v11, v47, v4, v11
  s_waitcnt lgkmcnt(0)
  s_barrier
  ds_read_b64_tr_b16 v[96:97], v26 offset:0
  ds_read_b64_tr_b16 v[98:99], v26 offset:4224
  ds_read_b64_tr_b16 v[100:101], v26 offset:64
  ds_read_b64_tr_b16 v[102:103], v26 offset:4288
  ds_read_b64_tr_b16 v[104:105], v26 offset:128
  ds_read_b64_tr_b16 v[106:107], v26 offset:4352
  ds_read_b64_tr_b16 v[108:109], v26 offset:192
  ds_read_b64_tr_b16 v[110:111], v26 offset:4416
  v_permlane32_swap_b32 v8, v10
  v_permlane32_swap_b32 v9, v11
  v_add_f32 v8, v8, v10
  v_add_f32 v9, v9, v11
  s_nop 1
  v_permlane16_swap_b32 v8, v9
  v_add_f32 v8, v8, v9
  s_nop 1
  v_add_f32_dpp v8, v8, v8 row_shr:1 row_mask:0xf bank_mask:0xf
  s_nop 1
  v_add_f32_dpp v8, v8, v8 row_shr:2 row_mask:0xf bank_mask:0xf
  s_nop 1
  v_add_f32_dpp v8, v8, v8 row_shr:4 row_mask:0xf bank_mask:0xf
  s_nop 1
  v_add_f32_dpp v8, v8, v8 row_shr:8 row_mask:0xf bank_mask:0xf
  s_add_u32 s9, s7, 1048576
  s_waitcnt lgkmcnt(6)
  buffer_store_dwordx4 v[96:99], v27, s[28:31], s9 offen sc0 sc1
  s_add_u32 s9, s7, 1179648
  s_waitcnt lgkmcnt(4)
  buffer_store_dwordx4 v[100:103], v27, s[28:31], s9 offen sc0 sc1
  s_add_u32 s9, s7, 1310720
  s_waitcnt lgkmcnt(2)
  buffer_store_dwordx4 v[104:107], v27, s[28:31], s9 offen sc0 sc1
  s_add_u32 s9, s7, 1441792
  s_waitcnt lgkmcnt(0)
  buffer_store_dwordx4 v[108:111], v27, s[28:31], s9 offen sc0 sc1
  v_mul_f32 v16, 0x3b000000, v8
  s_nop 0
  v_readlane_b32 s40, v16, 15
  v_readlane_b32 s42, v16, 31
  v_readlane_b32 s44, v16, 47
  v_readlane_b32 s46, v16, 63
  v_lshlrev_b32 v20, 16, v32
  v_and_b32 v21, 0xffff0000, v32
  v_pk_add_f32 v[20:21], v[20:21], s[40:41] op_sel_hi:[1,0] neg_lo:[0,1] neg_hi:[0,1]
  v_pk_mul_f32 v[22:23], v[20:21], v[20:21]
  v_lshlrev_b32 v20, 16, v33
  v_and_b32 v21, 0xffff0000, v33
  v_pk_add_f32 v[20:21], v[20:21], s[40:41] op_sel_hi:[1,0] neg_lo:[0,1] neg_hi:[0,1]
  v_pk_fma_f32 v[22:23], v[20:21], v[20:21], v[22:23]
  v_lshlrev_b32 v20, 16, v34
  v_and_b32 v21, 0xffff0000, v34
  v_pk_add_f32 v[20:21], v[20:21], s[40:41] op_sel_hi:[1,0] neg_lo:[0,1] neg_hi:[0,1]
  v_pk_fma_f32 v[22:23], v[20:21], v[20:21], v[22:23]
  v_lshlrev_b32 v20, 16, v35
  v_and_b32 v21, 0xffff0000, v35
  v_pk_add_f32 v[20:21], v[20:21], s[40:41] op_sel_hi:[1,0] neg_lo:[0,1] neg_hi:[0,1]
  v_pk_fma_f32 v[22:23], v[20:21], v[20:21], v[22:23]
  v_add_f32 v8, v22, v23
  v_lshlrev_b32 v20, 16, v36
  v_and_b32 v21, 0xffff0000, v36
  v_pk_add_f32 v[20:21], v[20:21], s[42:43] op_sel_hi:[1,0] neg_lo:[0,1] neg_hi:[0,1]
  v_pk_mul_f32 v[22:23], v[20:21], v[20:21]
  v_lshlrev_b32 v20, 16, v37
  v_and_b32 v21, 0xffff0000, v37
  v_pk_add_f32 v[20:21], v[20:21], s[42:43] op_sel_hi:[1,0] neg_lo:[0,1] neg_hi:[0,1]
  v_pk_fma_f32 v[22:23], v[20:21], v[20:21], v[22:23]
  v_lshlrev_b32 v20, 16, v38
  v_and_b32 v21, 0xffff0000, v38
  v_pk_add_f32 v[20:21], v[20:21], s[42:43] op_sel_hi:[1,0] neg_lo:[0,1] neg_hi:[0,1]
  v_pk_fma_f32 v[22:23], v[20:21], v[20:21], v[22:23]
  v_lshlrev_b32 v20, 16, v39
  v_and_b32 v21, 0xffff0000, v39
  v_pk_add_f32 v[20:21], v[20:21], s[42:43] op_sel_hi:[1,0] neg_lo:[0,1] neg_hi:[0,1]
  v_pk_fma_f32 v[22:23], v[20:21], v[20:21], v[22:23]
  v_add_f32 v9, v22, v23
  v_lshlrev_b32 v20, 16, v40
  v_and_b32 v21, 0xffff0000, v40
  v_pk_add_f32 v[20:21], v[20:21], s[44:45] op_sel_hi:[1,0] neg_lo:[0,1] neg_hi:[0,1]
  v_pk_mul_f32 v[22:23], v[20:21], v[20:21]
  v_lshlrev_b32 v20, 16, v41
  v_and_b32 v21, 0xffff0000, v41
  v_pk_add_f32 v[20:21], v[20:21], s[44:45] op_sel_hi:[1,0] neg_lo:[0,1] neg_hi:[0,1]
  v_pk_fma_f32 v[22:23], v[20:21], v[20:21], v[22:23]
  v_lshlrev_b32 v20, 16, v42
  v_and_b32 v21, 0xffff0000, v42
  v_pk_add_f32 v[20:21], v[20:21], s[44:45] op_sel_hi:[1,0] neg_lo:[0,1] neg_hi:[0,1]
  v_pk_fma_f32 v[22:23], v[20:21], v[20:21], v[22:23]
  v_lshlrev_b32 v20, 16, v43
  v_and_b32 v21, 0xffff0000, v43
  v_pk_add_f32 v[20:21], v[20:21], s[44:45] op_sel_hi:[1,0] neg_lo:[0,1] neg_hi:[0,1]
  v_pk_fma_f32 v[22:23], v[20:21], v[20:21], v[22:23]
  v_add_f32 v10, v22, v23
  v_lshlrev_b32 v20, 16, v44
  v_and_b32 v21, 0xffff0000, v44
  v_pk_add_f32 v[20:21], v[20:21], s[46:47] op_sel_hi:[1,0] neg_lo:[0,1] neg_hi:[0,1]
  v_pk_mul_f32 v[22:23], v[20:21], v[20:21]
  v_lshlrev_b32 v20, 16, v45
  v_and_b32 v21, 0xffff0000, v45
  v_pk_add_f32 v[20:21], v[20:21], s[46:47] op_sel_hi:[1,0] neg_lo:[0,1] neg_hi:[0,1]
  v_pk_fma_f32 v[22:23], v[20:21], v[20:21], v[22:23]
  v_lshlrev_b32 v20, 16, v46
  v_and_b32 v21, 0xffff0000, v46
  v_pk_add_f32 v[20:21], v[20:21], s[46:47] op_sel_hi:[1,0] neg_lo:[0,1] neg_hi:[0,1]
  v_pk_fma_f32 v[22:23], v[20:21], v[20:21], v[22:23]
  v_lshlrev_b32 v20, 16, v47
  v_and_b32 v21, 0xffff0000, v47
  v_pk_add_f32 v[20:21], v[20:21], s[46:47] op_sel_hi:[1,0] neg_lo:[0,1] neg_hi:[0,1]
  v_pk_fma_f32 v[22:23], v[20:21], v[20:21], v[22:23]
  v_add_f32 v11, v22, v23
  v_permlane32_swap_b32 v8, v10
  s_nop 0
  v_permlane32_swap_b32 v9, v11
  v_add_f32 v8, v8, v10
  v_add_f32 v9, v9, v11
  s_nop 1
  v_permlane16_swap_b32 v8, v9
  v_add_f32 v8, v8, v9
  s_nop 1
  v_add_f32_dpp v8, v8, v8 row_shr:1 row_mask:0xf bank_mask:0xf
  s_nop 1
  v_add_f32_dpp v8, v8, v8 row_shr:2 row_mask:0xf bank_mask:0xf
  s_nop 1
  v_add_f32_dpp v8, v8, v8 row_shr:4 row_mask:0xf bank_mask:0xf
  s_nop 1
  v_add_f32_dpp v8, v8, v8 row_shr:8 row_mask:0xf bank_mask:0xf
  v_mul_f32 v8, 0x3b000000, v8
  v_cvt_pk_bf16_f32 v8, v8, v8
  v_and_b32 v8, 0xffff0000, v8
  v_add_f32 v8, 0x3727c5ac, v8
  v_cvt_pk_bf16_f32 v8, v8, v8
  v_and_b32 v8, 0xffff0000, v8
  v_sqrt_f32 v8, v8
  s_nop 0
  v_cvt_pk_bf16_f32 v8, v16, v8
  v_lshlrev_b32 v9, 2, v5
  s_lshl_b32 s9, s3, 6
  s_lshl_b32 s10, s20, 4
  s_add_u32 s9, s9, s10
  s_add_u32 s9, s9, 3145728
  s_mov_b32 exec_lo, 0x80008000
  s_mov_b32 exec_hi, 0x80008000
  buffer_store_dword v8, v9, s[28:31], s9 offen sc0 sc1
  s_mov_b64 exec, -1
  s_waitcnt vmcnt(0)
  s_barrier
  s_cmp_lg_u32 s20, 0
  s_cbranch_scc1 SG_X
  s_waitcnt vmcnt(0)
  v_mov_b32 v2, 1
  v_mov_b32 v3, 0
  s_mov_b64 exec, 1
  buffer_atomic_add v2, v3, s[32:35], 0 offen offset:0 sc0 sc1
  s_waitcnt vmcnt(0)
  v_cmp_eq_u32 vcc, 127, v2
  s_cbranch_vccz SG_X
  v_mov_b32 v2, 1
  buffer_store_dword v2, v3, s[32:35], 0 offen offset:128 sc0 sc1
SG_X:
  s_mov_b64 exec, -1
  s_endpgm
F_PACK:
  s_load_dwordx2 s[24:25], s[0:1], 64
  s_load_dwordx2 s[28:29], s[0:1], 128
  s_load_dwordx2 s[32:33], s[0:1], 120
  s_load_dwordx2 s[36:37], s[0:1], 72
  s_sub_u32 s3, s2, 480
  s_and_b32 s11, s3, 1
  s_lshr_b32 s3, s3, 1
  s_cmp_ge_u32 s3, 22
  s_cselect_b32 s4, 22, 0
  s_cselect_b32 s5, 1376, 0
  s_sub_u32 s4, s3, s4
  s_lshl_b32 s6, s4, 6
  s_add_u32 s5, s5, s6
  s_mul_i32 s6, s11, 704512
  s_add_u32 s5, s5, s6
  v_lshrrev_b32 v2, 2, v1
  s_lshl_b32 s6, s20, 4
  v_add_u32 v2, s6, v2
  v_mul_u32_u24 v3, 2752, v2
  v_and_b32 v4, 3, v1
  v_lshl_add_u32 v3, v4, 4, v3
  s_cmp_eq_u32 s4, 21
  s_cselect_b32 s7, 2, 4
  v_cmp_gt_u32 vcc, s7, v4
  v_mov_b32 v5, 0x7f000000
  s_nop 0
  v_cndmask_b32 v3, v5, v3, vcc
  s_lshl_b32 s8, s3, 15
  s_lshl_b32 s6, s11, 13
  s_add_u32 s8, s8, s6
  s_add_u32 s8, s8, 12582912
  s_waitcnt lgkmcnt(0)
  s_mov_b32 s26, 0x158000
  s_mov_b32 s27, 0x20000
  s_mov_b32 s30, 0x2000000
  s_mov_b32 s31, 0x20000
  s_mov_b32 s34, 0x100
  s_mov_b32 s35, 0x20000
  s_mov_b32 s38, 0x800000
  s_mov_b32 s39, 0x20000
  buffer_load_dwordx4 v[32:35], v3, s[24:27], s5 offen nt
  s_add_u32 s5, s5, 176128
  buffer_load_dwordx4 v[36:39], v3, s[24:27], s5 offen nt
  s_add_u32 s5, s5, 176128
  buffer_load_dwordx4 v[40:43], v3, s[24:27], s5 offen nt
  s_add_u32 s5, s5, 176128
  buffer_load_dwordx4 v[44:47], v3, s[24:27], s5 offen nt
  v_lshlrev_b32 v4, 4, v0
  v_lshrrev_b32 v5, 4, v1
  v_bfe_u32 v6, v1, 2, 2
  v_and_b32 v7, 3, v1
  v_lshl_add_u32 v8, v5, 3, v6
  v_lshlrev_b32 v8, 6, v8
  v_lshl_add_u32 v8, v7, 4, v8
  s_lshr_b32 s6, s20, 1
  s_and_b32 s7, s20, 1
  s_lshl_b32 s9, s6, 11
  s_lshl_b32 s10, s7, 3
  s_add_u32 s9, s9, s10
  v_add_u32 v8, s9, v8
  v_lshlrev_b32 v9, 4, v1
  s_lshl_b32 s9, s6, 10
  s_mul_i32 s10, s7, 16384
  s_add_u32 s9, s9, s10
  s_add_u32 s8, s8, s9
  v_lshlrev_b32 v10, 2, v0
  v_lshlrev_b32 v11, 2, v2
  s_cmp_lg_u32 s20, 0
  s_cbranch_scc1 PK_W
  v_lshlrev_b32 v12, 2, v1
  s_mov_b32 s71, 0
  s_mov_b64 exec, 3
PK_POLL:
  buffer_load_dword v13, v12, s[32:35], 0 offen offset:128 sc1
  s_add_u32 s71, s71, 1
  s_waitcnt vmcnt(0)
  v_cmp_ne_u32 vcc, 1, v13
  s_cmp_gt_u32 s71, 400000
  s_cbranch_scc1 PK_POLL_X
  s_cbranch_vccz PK_POLL_X
  s_sleep 4
  s_branch PK_POLL
PK_POLL_X:
  s_mov_b64 exec, -1
PK_W:
  s_barrier
  s_lshl_b32 s12, s11, 10
  s_add_u32 s12, s12, 268288
  buffer_load_dword v60, v10, s[28:31], s12 offen offset:0 sc0 sc1
  buffer_load_dword v64, v10, s[28:31], s12 offen offset:2048 sc0 sc1
  s_add_u32 s13, s12, 4096
  buffer_load_dword v68, v10, s[28:31], s13 offen offset:0 sc0 sc1
  s_add_u32 s12, s12, 12288
  buffer_load_dword v61, v10, s[28:31], s12 offen offset:0 sc0 sc1
  buffer_load_dword v65, v10, s[28:31], s12 offen offset:2048 sc0 sc1
  s_add_u32 s13, s12, 4096
  buffer_load_dword v69, v10, s[28:31], s13 offen offset:0 sc0 sc1
  s_add_u32 s12, s12, 12288
  buffer_load_dword v62, v10, s[28:31], s12 offen offset:0 sc0 sc1
  buffer_load_dword v66, v10, s[28:31], s12 offen offset:2048 sc0 sc1
  s_add_u32 s13, s12, 4096
  buffer_load_dword v70, v10, s[28:31], s13 offen offset:0 sc0 sc1
  s_add_u32 s12, s12, 12288
  buffer_load_dword v63, v10, s[28:31], s12 offen offset:0 sc0 sc1
  buffer_load_dword v67, v10, s[28:31], s12 offen offset:2048 sc0 sc1
  s_add_u32 s13, s12, 4096
  buffer_load_dword v71, v10, s[28:31], s13 offen offset:0 sc0 sc1
  s_waitcnt vmcnt(0)
  v_add_f32 v60, v60, v61
  v_add_f32 v62, v62, v63
  v_add_f32 v60, v60, v62
  v_cvt_pk_bf16_f32 v60, v60, v60
  v_and_b32 v60, 0xffff0000, v60
  v_add_f32 v64, v64, v65
  v_add_f32 v66, v66, v67
  v_add_f32 v64, v64, v66
  v_cvt_pk_bf16_f32 v64, v64, v64
  v_and_b32 v64, 0xffff0000, v64
  v_add_f32 v68, v68, v69
  v_add_f32 v70, v70, v71
  v_add_f32 v68, v68, v70
  v_cvt_pk_bf16_f32 v68, v68, v68
  v_and_b32 v68, 0xffff0000, v68
  v_add_f32 v64, 1.0, v64
  v_cvt_pk_bf16_f32 v64, v64, v64
  v_and_b32 v64, 0xffff0000, v64
  ds_write_b32 v10, v60 offset:16384
  ds_write_b32 v10, v64 offset:17408
  s_cmp_lg_u32 s3, 0
  s_cbranch_scc1 PK_NG
  s_lshl_b32 s12, s11, 10
  s_add_u32 s12, s12, 10240
  buffer_store_dword v68, v10, s[28:31], s12 offen sc1
PK_NG:
  s_waitcnt lgkmcnt(0)
  s_barrier
  ds_read_b32 v60, v11 offset:16384
  ds_read_b32 v64, v11 offset:17408
  ds_read_b32 v61, v11 offset:16640
  ds_read_b32 v65, v11 offset:17664
  ds_read_b32 v62, v11 offset:16896
  ds_read_b32 v66, v11 offset:17920
  ds_read_b32 v63, v11 offset:17152
  ds_read_b32 v67, v11 offset:18176
  v_mov_b32 v80, 0
  v_mov_b32 v81, 0
  v_mov_b32 v82, 0
  v_mov_b32 v83, 0
  v_mov_b32 v84, 0
  v_mov_b32 v85, 0
  v_mov_b32 v86, 0
  v_mov_b32 v87, 0
  v_mov_b32 v88, 0
  v_mov_b32 v89, 0
  v_mov_b32 v90, 0
  v_mov_b32 v91, 0
  v_mov_b32 v92, 0
  v_mov_b32 v93, 0
  v_mov_b32 v94, 0
  v_mov_b32 v95, 0
  s_waitcnt lgkmcnt(0)
  v_lshlrev_b32 v12, 16, v32
  v_and_b32 v13, 0xffff0000, v32
  v_fmac_f32 v88, v12, v60
  v_fmac_f32 v89, v13, v60
  v_mul_f32 v12, v12, v64
  v_mul_f32 v13, v13, v64
  v_cvt_pk_bf16_f32 v32, v12, v13
  v_lshlrev_b32 v12, 16, v32
  v_and_b32 v13, 0xffff0000, v32
  v_add_f32 v80, v80, v12
  v_add_f32 v81, v81, v13
  v_lshlrev_b32 v12, 16, v33
  v_and_b32 v13, 0xffff0000, v33
  v_fmac_f32 v90, v12, v60
  v_fmac_f32 v91, v13, v60
  v_mul_f32 v12, v12, v64
  v_mul_f32 v13, v13, v64
  v_cvt_pk_bf16_f32 v33, v12, v13
  v_lshlrev_b32 v12, 16, v33
  v_and_b32 v13, 0xffff0000, v33
  v_add_f32 v82, v82, v12
  v_add_f32 v83, v83, v13
  v_lshlrev_b32 v12, 16, v34
  v_and_b32 v13, 0xffff0000, v34
  v_fmac_f32 v92, v12, v60
  v_fmac_f32 v93, v13, v60
  v_mul_f32 v12, v12, v64
  v_mul_f32 v13, v13, v64
  v_cvt_pk_bf16_f32 v34, v12, v13
  v_lshlrev_b32 v12, 16, v34
  v_and_b32 v13, 0xffff0000, v34
  v_add_f32 v84, v84, v12
  v_add_f32 v85, v85, v13
  v_lshlrev_b32 v12, 16, v35
  v_and_b32 v13, 0xffff0000, v35
  v_fmac_f32 v94, v12, v60
  v_fmac_f32 v95, v13, v60
  v_mul_f32 v12, v12, v64
  v_mul_f32 v13, v13, v64
  v_cvt_pk_bf16_f32 v35, v12, v13
  v_lshlrev_b32 v12, 16, v35
  v_and_b32 v13, 0xffff0000, v35
  v_add_f32 v86, v86, v12
  v_add_f32 v87, v87, v13
  ds_write_b128 v4, v[32:35] offset:0
  v_lshlrev_b32 v12, 16, v36
  v_and_b32 v13, 0xffff0000, v36
  v_fmac_f32 v88, v12, v61
  v_fmac_f32 v89, v13, v61
  v_mul_f32 v12, v12, v65
  v_mul_f32 v13, v13, v65
  v_cvt_pk_bf16_f32 v36, v12, v13
  v_lshlrev_b32 v12, 16, v36
  v_and_b32 v13, 0xffff0000, v36
  v_add_f32 v80, v80, v12
  v_add_f32 v81, v81, v13
  v_lshlrev_b32 v12, 16, v37
  v_and_b32 v13, 0xffff0000, v37
  v_fmac_f32 v90, v12, v61
  v_fmac_f32 v91, v13, v61
  v_mul_f32 v12, v12, v65
  v_mul_f32 v13, v13, v65
  v_cvt_pk_bf16_f32 v37, v12, v13
  v_lshlrev_b32 v12, 16, v37
  v_and_b32 v13, 0xffff0000, v37
  v_add_f32 v82, v82, v12
  v_add_f32 v83, v83, v13
  v_lshlrev_b32 v12, 16, v38
  v_and_b32 v13, 0xffff0000, v38
  v_fmac_f32 v92, v12, v61
  v_fmac_f32 v93, v13, v61
  v_mul_f32 v12, v12, v65
  v_mul_f32 v13, v13, v65
  v_cvt_pk_bf16_f32 v38, v12, v13
  v_lshlrev_b32 v12, 16, v38
  v_and_b32 v13, 0xffff0000, v38
  v_add_f32 v84, v84, v12
  v_add_f32 v85, v85, v13
  v_lshlrev_b32 v12, 16, v39
  v_and_b32 v13, 0xffff0000, v39
  v_fmac_f32 v94, v12, v61
  v_fmac_f32 v95, v13, v61
  v_mul_f32 v12, v12, v65
  v_mul_f32 v13, v13, v65
  v_cvt_pk_bf16_f32 v39, v12, v13
  v_lshlrev_b32 v12, 16, v39
  v_and_b32 v13, 0xffff0000, v39
  v_add_f32 v86, v86, v12
  v_add_f32 v87, v87, v13
  ds_write_b128 v4, v[36:39] offset:4096
  v_lshlrev_b32 v12, 16, v40
  v_and_b32 v13, 0xffff0000, v40
  v_fmac_f32 v88, v12, v62
  v_fmac_f32 v89, v13, v62
  v_mul_f32 v12, v12, v66
  v_mul_f32 v13, v13, v66
  v_cvt_pk_bf16_f32 v40, v12, v13
  v_lshlrev_b32 v12, 16, v40
  v_and_b32 v13, 0xffff0000, v40
  v_add_f32 v80, v80, v12
  v_add_f32 v81, v81, v13
  v_lshlrev_b32 v12, 16, v41
  v_and_b32 v13, 0xffff0000, v41
  v_fmac_f32 v90, v12, v62
  v_fmac_f32 v91, v13, v62
  v_mul_f32 v12, v12, v66
  v_mul_f32 v13, v13, v66
  v_cvt_pk_bf16_f32 v41, v12, v13
  v_lshlrev_b32 v12, 16, v41
  v_and_b32 v13, 0xffff0000, v41
  v_add_f32 v82, v82, v12
  v_add_f32 v83, v83, v13
  v_lshlrev_b32 v12, 16, v42
  v_and_b32 v13, 0xffff0000, v42
  v_fmac_f32 v92, v12, v62
  v_fmac_f32 v93, v13, v62
  v_mul_f32 v12, v12, v66
  v_mul_f32 v13, v13, v66
  v_cvt_pk_bf16_f32 v42, v12, v13
  v_lshlrev_b32 v12, 16, v42
  v_and_b32 v13, 0xffff0000, v42
  v_add_f32 v84, v84, v12
  v_add_f32 v85, v85, v13
  v_lshlrev_b32 v12, 16, v43
  v_and_b32 v13, 0xffff0000, v43
  v_fmac_f32 v94, v12, v62
  v_fmac_f32 v95, v13, v62
  v_mul_f32 v12, v12, v66
  v_mul_f32 v13, v13, v66
  v_cvt_pk_bf16_f32 v43, v12, v13
  v_lshlrev_b32 v12, 16, v43
  v_and_b32 v13, 0xffff0000, v43
  v_add_f32 v86, v86, v12
  v_add_f32 v87, v87, v13
  ds_write_b128 v4, v[40:43] offset:8192
  v_lshlrev_b32 v12, 16, v44
  v_and_b32 v13, 0xffff0000, v44
  v_fmac_f32 v88, v12, v63
  v_fmac_f32 v89, v13, v63
  v_mul_f32 v12, v12, v67
  v_mul_f32 v13, v13, v67
  v_cvt_pk_bf16_f32 v44, v12, v13
  v_lshlrev_b32 v12, 16, v44
  v_and_b32 v13, 0xffff0000, v44
  v_add_f32 v80, v80, v12
  v_add_f32 v81, v81, v13
  v_lshlrev_b32 v12, 16, v45
  v_and_b32 v13, 0xffff0000, v45
  v_fmac_f32 v90, v12, v63
  v_fmac_f32 v91, v13, v63
  v_mul_f32 v12, v12, v67
  v_mul_f32 v13, v13, v67
  v_cvt_pk_bf16_f32 v45, v12, v13
  v_lshlrev_b32 v12, 16, v45
  v_and_b32 v13, 0xffff0000, v45
  v_add_f32 v82, v82, v12
  v_add_f32 v83, v83, v13
  v_lshlrev_b32 v12, 16, v46
  v_and_b32 v13, 0xffff0000, v46
  v_fmac_f32 v92, v12, v63
  v_fmac_f32 v93, v13, v63
  v_mul_f32 v12, v12, v67
  v_mul_f32 v13, v13, v67
  v_cvt_pk_bf16_f32 v46, v12, v13
  v_lshlrev_b32 v12, 16, v46
  v_and_b32 v13, 0xffff0000, v46
  v_add_f32 v84, v84, v12
  v_add_f32 v85, v85, v13
  v_lshlrev_b32 v12, 16, v47
  v_and_b32 v13, 0xffff0000, v47
  v_fmac_f32 v94, v12, v63
  v_fmac_f32 v95, v13, v63
  v_mul_f32 v12, v12, v67
  v_mul_f32 v13, v13, v67
  v_cvt_pk_bf16_f32 v47, v12, v13
  v_lshlrev_b32 v12, 16, v47
  v_and_b32 v13, 0xffff0000, v47
  v_add_f32 v86, v86, v12
  v_add_f32 v87, v87, v13
  ds_write_b128 v4, v[44:47] offset:12288
  v_add_f32_dpp v80, v80, v80 row_shr:4 row_mask:0xf bank_mask:0xf
  v_add_f32_dpp v81, v81, v81 row_shr:4 row_mask:0xf bank_mask:0xf
  v_add_f32_dpp v82, v82, v82 row_shr:4 row_mask:0xf bank_mask:0xf
  v_add_f32_dpp v83, v83, v83 row_shr:4 row_mask:0xf bank_mask:0xf
  v_add_f32_dpp v84, v84, v84 row_shr:4 row_mask:0xf bank_mask:0xf
  v_add_f32_dpp v85, v85, v85 row_shr:4 row_mask:0xf bank_mask:0xf
  v_add_f32_dpp v86, v86, v86 row_shr:4 row_mask:0xf bank_mask:0xf
  v_add_f32_dpp v87, v87, v87 row_shr:4 row_mask:0xf bank_mask:0xf
  v_add_f32_dpp v88, v88, v88 row_shr:4 row_mask:0xf bank_mask:0xf
  v_add_f32_dpp v89, v89, v89 row_shr:4 row_mask:0xf bank_mask:0xf
  v_add_f32_dpp v90, v90, v90 row_shr:4 row_mask:0xf bank_mask:0xf
  v_add_f32_dpp v91, v91, v91 row_shr:4 row_mask:0xf bank_mask:0xf
  v_add_f32_dpp v92, v92, v92 row_shr:4 row_mask:0xf bank_mask:0xf
  v_add_f32_dpp v93, v93, v93 row_shr:4 row_mask:0xf bank_mask:0xf
  v_add_f32_dpp v94, v94, v94 row_shr:4 row_mask:0xf bank_mask:0xf
  v_add_f32_dpp v95, v95, v95 row_shr:4 row_mask:0xf bank_mask:0xf
  v_add_f32_dpp v80, v80, v80 row_shr:8 row_mask:0xf bank_mask:0xf
  v_add_f32_dpp v81, v81, v81 row_shr:8 row_mask:0xf bank_mask:0xf
  v_add_f32_dpp v82, v82, v82 row_shr:8 row_mask:0xf bank_mask:0xf
  v_add_f32_dpp v83, v83, v83 row_shr:8 row_mask:0xf bank_mask:0xf
  v_add_f32_dpp v84, v84, v84 row_shr:8 row_mask:0xf bank_mask:0xf
  v_add_f32_dpp v85, v85, v85 row_shr:8 row_mask:0xf bank_mask:0xf
  v_add_f32_dpp v86, v86, v86 row_shr:8 row_mask:0xf bank_mask:0xf
  v_add_f32_dpp v87, v87, v87 row_shr:8 row_mask:0xf bank_mask:0xf
  v_add_f32_dpp v88, v88, v88 row_shr:8 row_mask:0xf bank_mask:0xf
  v_add_f32_dpp v89, v89, v89 row_shr:8 row_mask:0xf bank_mask:0xf
  v_add_f32_dpp v90, v90, v90 row_shr:8 row_mask:0xf bank_mask:0xf
  v_add_f32_dpp v91, v91, v91 row_shr:8 row_mask:0xf bank_mask:0xf
  v_add_f32_dpp v92, v92, v92 row_shr:8 row_mask:0xf bank_mask:0xf
  v_add_f32_dpp v93, v93, v93 row_shr:8 row_mask:0xf bank_mask:0xf
  v_add_f32_dpp v94, v94, v94 row_shr:8 row_mask:0xf bank_mask:0xf
  v_add_f32_dpp v95, v95, v95 row_shr:8 row_mask:0xf bank_mask:0xf
  s_lshl_b32 s13, s20, 2
  v_add_u32 v12, s13, v5
  v_lshlrev_b32 v12, 7, v12
  v_lshl_add_u32 v12, v7, 5, v12
  s_mov_b32 exec_lo, 0xf000f000
  s_mov_b32 exec_hi, 0xf000f000
  ds_write_b128 v12, v[80:83] offset:20480
  ds_write_b128 v12, v[84:87] offset:20496
  ds_write_b128 v12, v[88:91] offset:22528
  ds_write_b128 v12, v[92:95] offset:22544
  s_mov_b64 exec, -1
  s_waitcnt lgkmcnt(0)
  s_barrier
  ds_read_b64_tr_b16 v[32:33], v8 offset:0
  ds_read_b64_tr_b16 v[34:35], v8 offset:256
  ds_read_b64_tr_b16 v[36:37], v8 offset:4096
  ds_read_b64_tr_b16 v[38:39], v8 offset:4352
  ds_read_b64_tr_b16 v[40:41], v8 offset:8192
  ds_read_b64_tr_b16 v[42:43], v8 offset:8448
  ds_read_b64_tr_b16 v[44:45], v8 offset:12288
  ds_read_b64_tr_b16 v[46:47], v8 offset:12544
  s_waitcnt lgkmcnt(6)
  buffer_store_dwordx4 v[32:35], v9, s[28:31], s8 offen offset:0 sc1
  s_waitcnt lgkmcnt(4)
  buffer_store_dwordx4 v[36:39], v9, s[28:31], s8 offen offset:2048 sc1
  s_add_u32 s8, s8, 4096
  s_waitcnt lgkmcnt(2)
  buffer_store_dwordx4 v[40:43], v9, s[28:31], s8 offen offset:0 sc1
  s_waitcnt lgkmcnt(0)
  buffer_store_dwordx4 v[44:47], v9, s[28:31], s8 offen offset:2048 sc1
  s_cmp_lg_u32 s20, 0
  s_cbranch_scc1 F_END
  v_and_b32 v12, 31, v1
  v_lshlrev_b32 v12, 2, v12
  v_lshrrev_b32 v13, 5, v1
  v_lshl_add_u32 v12, v13, 11, v12
  ds_read_b32 v60, v12 offset:20480
  ds_read_b32 v61, v12 offset:20608
  ds_read_b32 v62, v12 offset:20736
  ds_read_b32 v63, v12 offset:20864
  ds_read_b32 v64, v12 offset:20992
  ds_read_b32 v65, v12 offset:21120
  ds_read_b32 v66, v12 offset:21248
  ds_read_b32 v67, v12 offset:21376
  ds_read_b32 v68, v12 offset:21504
  ds_read_b32 v69, v12 offset:21632
  ds_read_b32 v70, v12 offset:21760
  ds_read_b32 v71, v12 offset:21888
  ds_read_b32 v72, v12 offset:22016
  ds_read_b32 v73, v12 offset:22144
  ds_read_b32 v74, v12 offset:22272
  ds_read_b32 v75, v12 offset:22400
  v_bfe_u32 v14, v1, 2, 1
  v_lshlrev_b32 v14, 6, v14
  v_bfe_u32 v15, v1, 3, 2
  v_lshl_add_u32 v14, v15, 4, v14
  v_and_b32 v15, 3, v1
  v_lshl_add_u32 v14, v15, 2, v14
  v_mul_u32_u24 v13, 6144, v13
  v_add_u32 v14, v14, v13
  s_lshl_b32 s12, s3, 7
  s_mul_i32 s13, s11, 12288
  s_add_u32 s12, s12, s13
  s_add_u32 s12, s12, 20480
  s_waitcnt lgkmcnt(0)
  v_add_f32 v60, v60, v68
  v_add_f32 v61, v61, v69
  v_add_f32 v62, v62, v70
  v_add_f32 v63, v63, v71
  v_add_f32 v64, v64, v72
  v_add_f32 v65, v65, v73
  v_add_f32 v66, v66, v74
  v_add_f32 v67, v67, v75
  v_add_f32 v60, v60, v64
  v_add_f32 v61, v61, v65
  v_add_f32 v62, v62, v66
  v_add_f32 v63, v63, v67
  v_add_f32 v60, v60, v62
  v_add_f32 v61, v61, v63
  v_add_f32 v60, v60, v61
  buffer_store_dword v60, v14, s[28:31], s12 offen sc1
  s_endpgm
F_WOUT:
  s_load_dwordx2 s[24:25], s[0:1], 88
  s_load_dwordx2 s[28:29], s[0:1], 128
  s_sub_u32 s3, s2, 568
  s_and_b32 s4, s3, 15
  s_lshr_b32 s11, s3, 4
  s_lshl_b32 s5, s4, 6
  s_lshl_b32 s6, s11, 18
  s_add_u32 s5, s5, s6
  v_lshrrev_b32 v2, 2, v1
  s_lshl_b32 s6, s20, 4
  v_add_u32 v2, s6, v2
  v_lshlrev_b32 v3, 10, v2
  v_and_b32 v4, 3, v1
  v_lshl_add_u32 v3, v4, 4, v3
  s_mul_i32 s8, s4, 49152
  s_lshl_b32 s6, s11, 13
  s_add_u32 s8, s8, s6
  s_add_u32 s8, s8, 14680064
  s_waitcnt lgkmcnt(0)
  s_mov_b32 s26, 0xac000
  s_mov_b32 s27, 0x20000
  s_mov_b32 s30, 0x2000000
  s_mov_b32 s31, 0x20000
  buffer_load_dwordx4 v[32:35], v3, s[24:27], s5 offen nt
  s_add_u32 s5, s5, 65536
  buffer_load_dwordx4 v[36:39], v3, s[24:27], s5 offen nt
  s_add_u32 s5, s5, 65536
  buffer_load_dwordx4 v[40:43], v3, s[24:27], s5 offen nt
  s_add_u32 s5, s5, 65536
  buffer_load_dwordx4 v[44:47], v3, s[24:27], s5 offen nt
  v_lshlrev_b32 v4, 4, v0
  v_lshrrev_b32 v5, 4, v1
  v_bfe_u32 v6, v1, 2, 2
  v_and_b32 v7, 3, v1
  v_lshl_add_u32 v8, v5, 3, v6
  v_lshlrev_b32 v8, 6, v8
  v_lshl_add_u32 v8, v7, 4, v8
  s_lshr_b32 s6, s20, 1
  s_and_b32 s7, s20, 1
  s_lshl_b32 s9, s6, 11
  s_lshl_b32 s10, s7, 3
  s_add_u32 s9, s9, s10
  v_add_u32 v8, s9, v8
  v_lshlrev_b32 v9, 4, v1
  s_lshl_b32 s9, s6, 10
  s_mul_i32 s10, s7, 24576
  s_add_u32 s9, s9, s10
  s_add_u32 s8, s8, s9
  s_cmp_lg_u32 s3, 0
  s_cbranch_scc1 WO_NF
  v_mov_b32 v60, 0
  v_mov_b32 v61, 0
  v_mov_b32 v62, 0
  v_mov_b32 v63, 0
  s_mov_b32 s12, 49152
  buffer_store_dwordx4 v[60:63], v4, s[28:31], s12 offen sc1
  s_add_u32 s12, s12, 4096
  buffer_store_dwordx4 v[60:63], v4, s[28:31], s12 offen sc1
  s_waitcnt vmcnt(0)
WO_NF:
  s_waitcnt vmcnt(3)
  ds_write_b128 v4, v[32:35] offset:0
  s_waitcnt vmcnt(2)
  ds_write_b128 v4, v[36:39] offset:4096
  s_waitcnt vmcnt(1)
  ds_write_b128 v4, v[40:43] offset:8192
  s_waitcnt vmcnt(0)
  ds_write_b128 v4, v[44:47] offset:12288
  s_waitcnt lgkmcnt(0)
  s_barrier
  ds_read_b64_tr_b16 v[32:33], v8 offset:0
  ds_read_b64_tr_b16 v[34:35], v8 offset:256
  ds_read_b64_tr_b16 v[36:37], v8 offset:4096
  ds_read_b64_tr_b16 v[38:39], v8 offset:4352
  ds_read_b64_tr_b16 v[40:41], v8 offset:8192
  ds_read_b64_tr_b16 v[42:43], v8 offset:8448
  ds_read_b64_tr_b16 v[44:45], v8 offset:12288
  ds_read_b64_tr_b16 v[46:47], v8 offset:12544
  s_waitcnt lgkmcnt(6)
  buffer_store_dwordx4 v[32:35], v9, s[28:31], s8 offen offset:0 sc1
  s_waitcnt lgkmcnt(4)
  buffer_store_dwordx4 v[36:39], v9, s[28:31], s8 offen offset:2048 sc1
  s_add_u32 s8, s8, 4096
  s_waitcnt lgkmcnt(2)
  buffer_store_dwordx4 v[40:43], v9, s[28:31], s8 offen offset:0 sc1
  s_waitcnt lgkmcnt(0)
  buffer_store_dwordx4 v[44:47], v9, s[28:31], s8 offen offset:2048 sc1
  s_endpgm
F_END:
  s_endpgm
.text
.globl g123_kernel
.p2align 8
.type g123_kernel,@function
g123_kernel:
  v_and_b32 v1, 63, v0
  v_lshrrev_b32 v2, 6, v0
  s_nop 0
  v_readfirstlane_b32 s20, v2
  s_cmp_ge_u32 s2, 256
  s_cbranch_scc1 G_END
  s_load_dwordx2 s[24:25], s[0:1], 128
  s_load_dwordx2 s[56:57], s[0:1], 72
  s_load_dwordx2 s[60:61], s[0:1], 80
  s_load_dwordx2 s[64:65], s[0:1], 112
  s_bfe_u32 s3, s2, 0x20001
  s_lshl_b32 s3, s3, 3
  s_bfe_u32 s4, s2, 0x30003
  s_add_u32 s3, s3, s4
  s_and_b32 s4, s2, 1
  s_lshr_b32 s5, s2, 6
  v_lshrrev_b32 v2, 3, v1
  v_bfe_u32 v4, v1, 4, 1
  v_lshlrev_b32 v4, 5, v4
  v_and_b32 v5, 7, v1
  v_lshlrev_b32 v5, 4, v5
  v_xor_b32 v5, v5, v4
  v_lshl_add_u32 v6, v2, 7, v5
  v_xor_b32 v7, 64, v6
  v_lshlrev_b32 v8, 4, v1
  s_lshl_b32 s7, s20, 12
  s_lshl_b32 s6, s3, 16
  s_add_u32 s6, s6, s7
  s_add_u32 s6, s6, 10485760
  s_mul_i32 s11, s4, 22
  s_mul_i32 s8, s5, 5
  s_add_u32 s8, s8, s11
  s_add_u32 s8, s8, 44
  s_mul_i32 s9, s5, 6
  s_add_u32 s9, s9, s11
  s_cmp_eq_u32 s5, 3
  s_cselect_b32 s10, 3, 1
  s_add_u32 s30, s8, s20
  s_add_u32 s11, s30, 4
  s_sub_u32 s47, s20, s10
  s_add_u32 s12, s9, s47
  s_cmp_lt_u32 s20, s10
  s_cselect_b32 s31, s11, s12
  s_cselect_b32 s33, 1, 0
  s_add_u32 s32, s12, 4
  s_cmp_eq_u32 s20, 3
  s_cselect_b32 s13, 0x7f000000, 0
  v_add_u32 v9, s13, v8
  s_lshl_b32 s34, s30, 14
  s_add_u32 s34, s34, 12582912
  s_lshl_b32 s35, s31, 14
  s_add_u32 s35, s35, 12582912
  s_lshl_b32 s36, s32, 14
  s_add_u32 s36, s36, 12582912
  v_lshrrev_b32 v10, 4, v1
  v_mov_b32 v11, s30
  v_mov_b32 v12, s31
  v_cmp_eq_u32 vcc, 1, v10
  s_nop 1
  v_cndmask_b32 v11, v11, v12, vcc
  v_mov_b32 v12, s32
  v_cmp_eq_u32 vcc, 2, v10
  s_nop 1
  v_cndmask_b32 v11, v11, v12, vcc
  v_and_b32 v17, 15, v1
  v_lshlrev_b32 v11, 6, v11
  v_lshl_add_u32 v11, v17, 2, v11
  s_lshl_b32 s46, s20, 10
  s_add_u32 s46, s46, 131072
  s_waitcnt lgkmcnt(0)
  s_mov_b32 s26, 0x2000000
  s_mov_b32 s27, 0x20000
  s_mov_b32 s58, 0x800000
  s_mov_b32 s59, 0x20000
  s_mov_b32 s62, 0x1000
  s_mov_b32 s63, 0x20000
  s_mov_b32 s66, 0x200000
  s_mov_b32 s67, 0x20000
  s_add_u32 m0, s7, 0
  s_add_u32 s14, s6, 0
  buffer_load_dwordx4 v6, s[24:27], s14 offen offset:0 lds
  buffer_load_dwordx4 v7, s[24:27], s14 offen offset:1024 lds
  buffer_load_dwordx4 v6, s[24:27], s14 offen offset:2048 lds
  buffer_load_dwordx4 v7, s[24:27], s14 offen offset:3072 lds
  s_add_u32 s38, s34, 0
  buffer_load_dwordx4 a[0:3], v8, s[24:27], s38 offen offset:0
  s_add_u32 s39, s35, 0
  buffer_load_dwordx4 a[64:67], v8, s[24:27], s39 offen offset:0
  buffer_load_dwordx4 a[4:7], v8, s[24:27], s38 offen offset:1024
  buffer_load_dwordx4 a[68:71], v8, s[24:27], s39 offen offset:1024
  buffer_load_dwordx4 a[8:11], v8, s[24:27], s38 offen offset:2048
  buffer_load_dwordx4 a[72:75], v8, s[24:27], s39 offen offset:2048
  buffer_load_dwordx4 a[12:15], v8, s[24:27], s38 offen offset:3072
  buffer_load_dwordx4 a[76:79], v8, s[24:27], s39 offen offset:3072
  s_add_u32 m0, s7, 16384
  s_add_u32 s14, s6, 16384
  buffer_load_dwordx4 v6, s[24:27], s14 offen offset:0 lds
  buffer_load_dwordx4 v7, s[24:27], s14 offen offset:1024 lds
  buffer_load_dwordx4 v6, s[24:27], s14 offen offset:2048 lds
  buffer_load_dwordx4 v7, s[24:27], s14 offen offset:3072 lds
  s_add_u32 s38, s34, 4096
  buffer_load_dwordx4 a[16:19], v8, s[24:27], s38 offen offset:0
  s_add_u32 s39, s35, 4096
  buffer_load_dwordx4 a[80:83], v8, s[24:27], s39 offen offset:0
  buffer_load_dwordx4 a[20:23], v8, s[24:27], s38 offen offset:1024
  buffer_load_dwordx4 a[84:87], v8, s[24:27], s39 offen offset:1024
  buffer_load_dwordx4 a[24:27], v8, s[24:27], s38 offen offset:2048
  buffer_load_dwordx4 a[88:91], v8, s[24:27], s39 offen offset:2048
  buffer_load_dwordx4 a[28:31], v8, s[24:27], s38 offen offset:3072
  buffer_load_dwordx4 a[92:95], v8, s[24:27], s39 offen offset:3072
  s_sub_u32 s56, s56, 4096
  s_subb_u32 s57, s57, 0
  s_add_u32 s58, s58, 4096
  v_lshrrev_b32 v2, 3, v1
  v_lshrrev_b32 v3, 2, v2
  v_lshlrev_b32 v3, 3, v3
  v_and_b32 v4, 3, v2
  v_add_u32 v3, v3, v4
  v_lshlrev_b32 v3, 12, v3
  v_and_b32 v4, 7, v1
  v_lshrrev_b32 v5, 1, v2
  v_xor_b32 v4, v4, v5
  v_lshl_add_u32 v24, v4, 4, v3
  v_xor_b32 v25, 64, v24
  v_add_u32 v25, 0x10000, v25
  v_add_u32 v168, 4096, v24
  v_add_u32 v169, 3072, v25
  v_add_u32 v170, 18432, v24
  v_add_u32 v171, 17408, v25
  v_add_u32 v172, 135168, v24
  v_add_u32 v173, 134144, v25
  v_add_u32 v174, 149504, v24
  v_add_u32 v175, 148480, v25
  s_lshl_b32 s73, s3, 18
  s_lshl_b32 s74, s20, 10
  s_add_u32 s73, s73, s74
  s_lshl_b32 s19, s20, 14
  v_lshrrev_b32 v2, 1, v17
  v_xor_b32 v2, v2, v10
  v_lshlrev_b32 v2, 4, v2
  v_lshl_add_u32 v2, v17, 7, v2
  s_lshl_b32 s16, s20, 11
  v_add_u32 v2, s16, v2
  s_add_u32 s16, s19, 65536
  v_xor_b32 v176, 0, v2
  v_add_u32 v176, s16, v176
  v_xor_b32 v180, 64, v176
  v_xor_b32 v177, 2048, v2
  v_add_u32 v177, s16, v177
  v_xor_b32 v181, 64, v177
  v_xor_b32 v178, 4096, v2
  v_add_u32 v178, s16, v178
  v_xor_b32 v182, 64, v178
  v_xor_b32 v179, 6144, v2
  v_add_u32 v179, s16, v179
  v_xor_b32 v183, 64, v179
  v_bfe_u32 v13, v1, 2, 2
  v_lshl_add_u32 v14, v10, 3, v13
  v_lshlrev_b32 v14, 7, v14
  v_and_b32 v15, 3, v1
  v_lshl_add_u32 v14, v15, 3, v14
  v_bfe_u32 v15, v1, 3, 2
  v_lshl_add_u32 v16, v15, 5, v14
  v_xor_b32 v15, s20, v15
  v_lshl_add_u32 v20, v15, 5, v14
  v_xor_b32 v21, 32, v20
  v_xor_b32 v22, 64, v20
  v_xor_b32 v23, 96, v20
  v_mov_b32 v64, 0
  v_mov_b32 v65, 0
  v_mov_b32 v66, 0
  v_mov_b32 v67, 0
  v_mov_b32 v68, 0
  v_mov_b32 v69, 0
  v_mov_b32 v70, 0
  v_mov_b32 v71, 0
  v_mov_b32 v72, 0
  v_mov_b32 v73, 0
  v_mov_b32 v74, 0
  v_mov_b32 v75, 0
  v_mov_b32 v76, 0
  v_mov_b32 v77, 0
  v_mov_b32 v78, 0
  v_mov_b32 v79, 0
  v_mov_b32 v80, 0
  v_mov_b32 v81, 0
  v_mov_b32 v82, 0
  v_mov_b32 v83, 0
  v_mov_b32 v84, 0
  v_mov_b32 v85, 0
  v_mov_b32 v86, 0
  v_mov_b32 v87, 0
  v_mov_b32 v88, 0
  v_mov_b32 v89, 0
  v_mov_b32 v90, 0
  v_mov_b32 v91, 0
  v_mov_b32 v92, 0
  v_mov_b32 v93, 0
  v_mov_b32 v94, 0
  v_mov_b32 v95, 0
  v_mov_b32 v96, 0
  v_mov_b32 v97, 0
  v_mov_b32 v98, 0
  v_mov_b32 v99, 0
  v_mov_b32 v100, 0
  v_mov_b32 v101, 0
  v_mov_b32 v102, 0
  v_mov_b32 v103, 0
  v_mov_b32 v104, 0
  v_mov_b32 v105, 0
  v_mov_b32 v106, 0
  v_mov_b32 v107, 0
  v_mov_b32 v108, 0
  v_mov_b32 v109, 0
  v_mov_b32 v110, 0
  v_mov_b32 v111, 0
  v_mov_b32 v26, 0x3f803f80
  v_mov_b32 v156, 0
  v_mov_b32 v157, 0
  v_mov_b32 v158, 0
  v_mov_b32 v159, 0
  v_mov_b32 v160, 0
  v_mov_b32 v161, 0
  v_mov_b32 v162, 0
  v_mov_b32 v163, 0
  v_mov_b32 v164, 0x3f803f80
  v_mov_b32 v165, 0x3f803f80
  v_mov_b32 v166, 0x3f803f80
  v_mov_b32 v167, 0x3f803f80
  v_lshlrev_b32 v18, 3, v17
  v_mov_b32 v30, 0xc0135761
  v_mov_b32 v31, 0xc0135761
  s_mov_b32 s18, 0xbdd2d3e8
  s_waitcnt vmcnt(20)
  s_barrier
  ds_read_b64_tr_b16 v[32:33], v20 offset:0
  ds_read_b64_tr_b16 v[34:35], v20 offset:512
  ds_read_b64_tr_b16 v[36:37], v21 offset:0
  ds_read_b64_tr_b16 v[38:39], v21 offset:512
  ds_read_b64_tr_b16 v[40:41], v22 offset:0
  ds_read_b64_tr_b16 v[42:43], v22 offset:512
  ds_read_b64_tr_b16 v[44:45], v23 offset:0
  ds_read_b64_tr_b16 v[46:47], v23 offset:512
  s_waitcnt lgkmcnt(0)
  s_waitcnt vmcnt(18)
  v_mfma_f32_16x16x32_bf16 v[64:67], a[0:3], v[32:35], v[64:67]
  ds_read_b64_tr_b16 v[48:49], v20 offset:4096
  v_mfma_f32_16x16x32_bf16 v[68:71], a[0:3], v[36:39], v[68:71]
  ds_read_b64_tr_b16 v[50:51], v20 offset:4608
  s_add_u32 m0, s7, 32768
  s_add_u32 s14, s6, 32768
  buffer_load_dwordx4 v6, s[24:27], s14 offen offset:0 lds
  v_mfma_f32_16x16x32_bf16 v[72:75], a[0:3], v[40:43], v[72:75]
  ds_read_b64_tr_b16 v[52:53], v21 offset:4096
  v_mfma_f32_16x16x32_bf16 v[76:79], a[0:3], v[44:47], v[76:79]
  ds_read_b64_tr_b16 v[54:55], v21 offset:4608
  v_mfma_f32_16x16x32_bf16 v[80:83], a[64:67], v[32:35], v[80:83]
  ds_read_b64_tr_b16 v[56:57], v22 offset:4096
  buffer_load_dwordx4 v7, s[24:27], s14 offen offset:1024 lds
  v_mfma_f32_16x16x32_bf16 v[84:87], a[64:67], v[36:39], v[84:87]
  ds_read_b64_tr_b16 v[58:59], v22 offset:4608
  v_mfma_f32_16x16x32_bf16 v[88:91], a[64:67], v[40:43], v[88:91]
  ds_read_b64_tr_b16 v[60:61], v23 offset:4096
  v_mfma_f32_16x16x32_bf16 v[92:95], a[64:67], v[44:47], v[92:95]
  ds_read_b64_tr_b16 v[62:63], v23 offset:4608
  buffer_load_dwordx4 v6, s[24:27], s14 offen offset:2048 lds
  v_mfma_f32_16x16x32_bf16 v[156:159], v[164:167], v[32:35], v[156:159]
  v_mfma_f32_16x16x32_bf16 v[160:163], v[32:35], v[32:35], v[160:163]
  buffer_load_dwordx4 v7, s[24:27], s14 offen offset:3072 lds
  s_waitcnt lgkmcnt(0)
  s_waitcnt vmcnt(20)
  v_mfma_f32_16x16x32_bf16 v[64:67], a[4:7], v[48:51], v[64:67]
  ds_read_b64_tr_b16 v[32:33], v20 offset:8192
  v_mfma_f32_16x16x32_bf16 v[68:71], a[4:7], v[52:55], v[68:71]
  ds_read_b64_tr_b16 v[34:35], v20 offset:8704
  s_add_u32 s38, s34, 8192
  buffer_load_dwordx4 a[32:35], v8, s[24:27], s38 offen offset:0
  v_mfma_f32_16x16x32_bf16 v[72:75], a[4:7], v[56:59], v[72:75]
  ds_read_b64_tr_b16 v[36:37], v21 offset:8192
  v_mfma_f32_16x16x32_bf16 v[76:79], a[4:7], v[60:63], v[76:79]
  ds_read_b64_tr_b16 v[38:39], v21 offset:8704
  v_mfma_f32_16x16x32_bf16 v[80:83], a[68:71], v[48:51], v[80:83]
  ds_read_b64_tr_b16 v[40:41], v22 offset:8192
  s_add_u32 s39, s35, 8192
  buffer_load_dwordx4 a[96:99], v8, s[24:27], s39 offen offset:0
  v_mfma_f32_16x16x32_bf16 v[84:87], a[68:71], v[52:55], v[84:87]
  ds_read_b64_tr_b16 v[42:43], v22 offset:8704
  v_mfma_f32_16x16x32_bf16 v[88:91], a[68:71], v[56:59], v[88:91]
  ds_read_b64_tr_b16 v[44:45], v23 offset:8192
  v_mfma_f32_16x16x32_bf16 v[92:95], a[68:71], v[60:63], v[92:95]
  ds_read_b64_tr_b16 v[46:47], v23 offset:8704
  buffer_load_dwordx4 a[36:39], v8, s[24:27], s38 offen offset:1024
  v_mfma_f32_16x16x32_bf16 v[156:159], v[164:167], v[48:51], v[156:159]
  v_mfma_f32_16x16x32_bf16 v[160:163], v[48:51], v[48:51], v[160:163]
  buffer_load_dwordx4 a[100:103], v8, s[24:27], s39 offen offset:1024
  s_waitcnt lgkmcnt(0)
  s_waitcnt vmcnt(22)
  v_mfma_f32_16x16x32_bf16 v[64:67], a[8:11], v[32:35], v[64:67]
  ds_read_b64_tr_b16 v[48:49], v20 offset:12288
  v_mfma_f32_16x16x32_bf16 v[68:71], a[8:11], v[36:39], v[68:71]
  ds_read_b64_tr_b16 v[50:51], v20 offset:12800
  buffer_load_dwordx4 a[40:43], v8, s[24:27], s38 offen offset:2048
  v_mfma_f32_16x16x32_bf16 v[72:75], a[8:11], v[40:43], v[72:75]
  ds_read_b64_tr_b16 v[52:53], v21 offset:12288
  v_mfma_f32_16x16x32_bf16 v[76:79], a[8:11], v[44:47], v[76:79]
  ds_read_b64_tr_b16 v[54:55], v21 offset:12800
  v_mfma_f32_16x16x32_bf16 v[80:83], a[72:75], v[32:35], v[80:83]
  ds_read_b64_tr_b16 v[56:57], v22 offset:12288
  buffer_load_dwordx4 a[104:107], v8, s[24:27], s39 offen offset:2048
  v_mfma_f32_16x16x32_bf16 v[84:87], a[72:75], v[36:39], v[84:87]
  ds_read_b64_tr_b16 v[58:59], v22 offset:12800
  v_mfma_f32_16x16x32_bf16 v[88:91], a[72:75], v[40:43], v[88:91]
  ds_read_b64_tr_b16 v[60:61], v23 offset:12288
  v_mfma_f32_16x16x32_bf16 v[92:95], a[72:75], v[44:47], v[92:95]
  ds_read_b64_tr_b16 v[62:63], v23 offset:12800
  buffer_load_dwordx4 a[44:47], v8, s[24:27], s38 offen offset:3072
  v_mfma_f32_16x16x32_bf16 v[156:159], v[164:167], v[32:35], v[156:159]
  v_mfma_f32_16x16x32_bf16 v[160:163], v[32:35], v[32:35], v[160:163]
  buffer_load_dwordx4 a[108:111], v8, s[24:27], s39 offen offset:3072
  s_waitcnt vmcnt(20)
  s_barrier
  s_waitcnt lgkmcnt(0)
  v_mfma_f32_16x16x32_bf16 v[64:67], a[12:15], v[48:51], v[64:67]
  ds_read_b64_tr_b16 v[32:33], v20 offset:16384
  v_mfma_f32_16x16x32_bf16 v[68:71], a[12:15], v[52:55], v[68:71]
  ds_read_b64_tr_b16 v[34:35], v20 offset:16896
  s_add_u32 m0, s7, 49152
  s_add_u32 s14, s6, 49152
  buffer_load_dwordx4 v6, s[24:27], s14 offen offset:0 lds
  v_mfma_f32_16x16x32_bf16 v[72:75], a[12:15], v[56:59], v[72:75]
  ds_read_b64_tr_b16 v[36:37], v21 offset:16384
  v_mfma_f32_16x16x32_bf16 v[76:79], a[12:15], v[60:63], v[76:79]
  ds_read_b64_tr_b16 v[38:39], v21 offset:16896
  v_mfma_f32_16x16x32_bf16 v[80:83], a[76:79], v[48:51], v[80:83]
  ds_read_b64_tr_b16 v[40:41], v22 offset:16384
  buffer_load_dwordx4 v7, s[24:27], s14 offen offset:1024 lds
  v_mfma_f32_16x16x32_bf16 v[84:87], a[76:79], v[52:55], v[84:87]
  ds_read_b64_tr_b16 v[42:43], v22 offset:16896
  v_mfma_f32_16x16x32_bf16 v[88:91], a[76:79], v[56:59], v[88:91]
  ds_read_b64_tr_b16 v[44:45], v23 offset:16384
  v_mfma_f32_16x16x32_bf16 v[92:95], a[76:79], v[60:63], v[92:95]
  ds_read_b64_tr_b16 v[46:47], v23 offset:16896
  buffer_load_dwordx4 v6, s[24:27], s14 offen offset:2048 lds
  v_mfma_f32_16x16x32_bf16 v[156:159], v[164:167], v[48:51], v[156:159]
  v_mfma_f32_16x16x32_bf16 v[160:163], v[48:51], v[48:51], v[160:163]
  buffer_load_dwordx4 v7, s[24:27], s14 offen offset:3072 lds
  s_waitcnt lgkmcnt(0)
  s_waitcnt vmcnt(22)
  v_mfma_f32_16x16x32_bf16 v[64:67], a[16:19], v[32:35], v[64:67]
  ds_read_b64_tr_b16 v[48:49], v20 offset:20480
  v_mfma_f32_16x16x32_bf16 v[68:71], a[16:19], v[36:39], v[68:71]
  ds_read_b64_tr_b16 v[50:51], v20 offset:20992
  s_add_u32 s38, s34, 12288
  buffer_load_dwordx4 a[48:51], v8, s[24:27], s38 offen offset:0
  v_mfma_f32_16x16x32_bf16 v[72:75], a[16:19], v[40:43], v[72:75]
  ds_read_b64_tr_b16 v[52:53], v21 offset:20480
  v_mfma_f32_16x16x32_bf16 v[76:79], a[16:19], v[44:47], v[76:79]
  ds_read_b64_tr_b16 v[54:55], v21 offset:20992
  v_mfma_f32_16x16x32_bf16 v[80:83], a[80:83], v[32:35], v[80:83]
  ds_read_b64_tr_b16 v[56:57], v22 offset:20480
  s_add_u32 s39, s35, 12288
  buffer_load_dwordx4 a[112:115], v8, s[24:27], s39 offen offset:0
  v_mfma_f32_16x16x32_bf16 v[84:87], a[80:83], v[36:39], v[84:87]
  ds_read_b64_tr_b16 v[58:59], v22 offset:20992
  v_mfma_f32_16x16x32_bf16 v[88:91], a[80:83], v[40:43], v[88:91]
  ds_read_b64_tr_b16 v[60:61], v23 offset:20480
  v_mfma_f32_16x16x32_bf16 v[92:95], a[80:83], v[44:47], v[92:95]
  ds_read_b64_tr_b16 v[62:63], v23 offset:20992
  buffer_load_dwordx4 a[52:55], v8, s[24:27], s38 offen offset:1024
  v_mfma_f32_16x16x32_bf16 v[156:159], v[164:167], v[32:35], v[156:159]
  v_mfma_f32_16x16x32_bf16 v[160:163], v[32:35], v[32:35], v[160:163]
  buffer_load_dwordx4 a[116:119], v8, s[24:27], s39 offen offset:1024
  s_waitcnt lgkmcnt(0)
  s_waitcnt vmcnt(24)
  v_mfma_f32_16x16x32_bf16 v[64:67], a[20:23], v[48:51], v[64:67]
  ds_read_b64_tr_b16 v[32:33], v20 offset:24576
  v_mfma_f32_16x16x32_bf16 v[68:71], a[20:23], v[52:55], v[68:71]
  ds_read_b64_tr_b16 v[34:35], v20 offset:25088
  buffer_load_dwordx4 a[56:59], v8, s[24:27], s38 offen offset:2048
  v_mfma_f32_16x16x32_bf16 v[72:75], a[20:23], v[56:59], v[72:75]
  ds_read_b64_tr_b16 v[36:37], v21 offset:24576
  v_mfma_f32_16x16x32_bf16 v[76:79], a[20:23], v[60:63], v[76:79]
  ds_read_b64_tr_b16 v[38:39], v21 offset:25088
  v_mfma_f32_16x16x32_bf16 v[80:83], a[84:87], v[48:51], v[80:83]
  ds_read_b64_tr_b16 v[40:41], v22 offset:24576
  buffer_load_dwordx4 a[120:123], v8, s[24:27], s39 offen offset:2048
  v_mfma_f32_16x16x32_bf16 v[84:87], a[84:87], v[52:55], v[84:87]
  ds_read_b64_tr_b16 v[42:43], v22 offset:25088
  v_mfma_f32_16x16x32_bf16 v[88:91], a[84:87], v[56:59], v[88:91]
  ds_read_b64_tr_b16 v[44:45], v23 offset:24576
  v_mfma_f32_16x16x32_bf16 v[92:95], a[84:87], v[60:63], v[92:95]
  ds_read_b64_tr_b16 v[46:47], v23 offset:25088
  buffer_load_dwordx4 a[60:63], v8, s[24:27], s38 offen offset:3072
  v_mfma_f32_16x16x32_bf16 v[156:159], v[164:167], v[48:51], v[156:159]
  v_mfma_f32_16x16x32_bf16 v[160:163], v[48:51], v[48:51], v[160:163]
  buffer_load_dwordx4 a[124:127], v8, s[24:27], s39 offen offset:3072
  s_waitcnt lgkmcnt(0)
  s_waitcnt vmcnt(26)
  v_mfma_f32_16x16x32_bf16 v[64:67], a[24:27], v[32:35], v[64:67]
  ds_read_b64_tr_b16 v[48:49], v20 offset:28672
  v_mfma_f32_16x16x32_bf16 v[68:71], a[24:27], v[36:39], v[68:71]
  ds_read_b64_tr_b16 v[50:51], v20 offset:29184
  s_add_u32 m0, s46, 4096
  s_mov_b32 s15, 20480
  buffer_load_dword v11, s[24:27], s15 offen lds
  v_mfma_f32_16x16x32_bf16 v[72:75], a[24:27], v[40:43], v[72:75]
  ds_read_b64_tr_b16 v[52:53], v21 offset:28672
  v_mfma_f32_16x16x32_bf16 v[76:79], a[24:27], v[44:47], v[76:79]
  ds_read_b64_tr_b16 v[54:55], v21 offset:29184
  v_mfma_f32_16x16x32_bf16 v[80:83], a[88:91], v[32:35], v[80:83]
  ds_read_b64_tr_b16 v[56:57], v22 offset:28672
  s_add_u32 m0, s46, 4352
  s_mov_b32 s15, 26624
  buffer_load_dword v11, s[24:27], s15 offen lds
  v_mfma_f32_16x16x32_bf16 v[84:87], a[88:91], v[36:39], v[84:87]
  ds_read_b64_tr_b16 v[58:59], v22 offset:29184
  v_mfma_f32_16x16x32_bf16 v[88:91], a[88:91], v[40:43], v[88:91]
  ds_read_b64_tr_b16 v[60:61], v23 offset:28672
  v_mfma_f32_16x16x32_bf16 v[92:95], a[88:91], v[44:47], v[92:95]
  ds_read_b64_tr_b16 v[62:63], v23 offset:29184
  s_add_u32 m0, s46, 4608
  s_mov_b32 s15, 32768
  buffer_load_dword v11, s[24:27], s15 offen lds
  v_mfma_f32_16x16x32_bf16 v[156:159], v[164:167], v[32:35], v[156:159]
  v_mfma_f32_16x16x32_bf16 v[160:163], v[32:35], v[32:35], v[160:163]
  s_add_u32 m0, s46, 4864
  s_mov_b32 s15, 38912
  buffer_load_dword v11, s[24:27], s15 offen lds
  s_waitcnt vmcnt(24)
  s_barrier
  s_waitcnt lgkmcnt(0)
  v_mfma_f32_16x16x32_bf16 v[64:67], a[28:31], v[48:51], v[64:67]
  ds_read_b64_tr_b16 v[32:33], v20 offset:32768
  v_mfma_f32_16x16x32_bf16 v[68:71], a[28:31], v[52:55], v[68:71]
  ds_read_b64_tr_b16 v[34:35], v20 offset:33280
  s_add_u32 s40, s36, 0
  buffer_load_dwordx4 v[192:195], v9, s[24:27], s40 offen offset:0
  v_mfma_f32_16x16x32_bf16 v[72:75], a[28:31], v[56:59], v[72:75]
  ds_read_b64_tr_b16 v[36:37], v21 offset:32768
  v_mfma_f32_16x16x32_bf16 v[76:79], a[28:31], v[60:63], v[76:79]
  ds_read_b64_tr_b16 v[38:39], v21 offset:33280
  v_mfma_f32_16x16x32_bf16 v[80:83], a[92:95], v[48:51], v[80:83]
  ds_read_b64_tr_b16 v[40:41], v22 offset:32768
  buffer_load_dwordx4 v[196:199], v9, s[24:27], s40 offen offset:1024
  v_mfma_f32_16x16x32_bf16 v[84:87], a[92:95], v[52:55], v[84:87]
  ds_read_b64_tr_b16 v[42:43], v22 offset:33280
  v_mfma_f32_16x16x32_bf16 v[88:91], a[92:95], v[56:59], v[88:91]
  ds_read_b64_tr_b16 v[44:45], v23 offset:32768
  v_mfma_f32_16x16x32_bf16 v[92:95], a[92:95], v[60:63], v[92:95]
  ds_read_b64_tr_b16 v[46:47], v23 offset:33280
  buffer_load_dwordx4 v[200:203], v9, s[24:27], s40 offen offset:2048
  v_mfma_f32_16x16x32_bf16 v[156:159], v[164:167], v[48:51], v[156:159]
  v_mfma_f32_16x16x32_bf16 v[160:163], v[48:51], v[48:51], v[160:163]
  buffer_load_dwordx4 v[204:207], v9, s[24:27], s40 offen offset:3072
  s_waitcnt lgkmcnt(0)
  s_waitcnt vmcnt(26)
  v_mfma_f32_16x16x32_bf16 v[64:67], a[32:35], v[32:35], v[64:67]
  ds_read_b64_tr_b16 v[48:49], v20 offset:36864
  v_mfma_f32_16x16x32_bf16 v[68:71], a[32:35], v[36:39], v[68:71]
  ds_read_b64_tr_b16 v[50:51], v20 offset:37376
  s_add_u32 s40, s36, 4096
  buffer_load_dwordx4 v[208:211], v9, s[24:27], s40 offen offset:0
  v_mfma_f32_16x16x32_bf16 v[72:75], a[32:35], v[40:43], v[72:75]
  ds_read_b64_tr_b16 v[52:53], v21 offset:36864
  v_mfma_f32_16x16x32_bf16 v[76:79], a[32:35], v[44:47], v[76:79]
  ds_read_b64_tr_b16 v[54:55], v21 offset:37376
  v_mfma_f32_16x16x32_bf16 v[80:83], a[96:99], v[32:35], v[80:83]
  ds_read_b64_tr_b16 v[56:57], v22 offset:36864
  buffer_load_dwordx4 v[212:215], v9, s[24:27], s40 offen offset:1024
  v_mfma_f32_16x16x32_bf16 v[84:87], a[96:99], v[36:39], v[84:87]
  ds_read_b64_tr_b16 v[58:59], v22 offset:37376
  v_mfma_f32_16x16x32_bf16 v[88:91], a[96:99], v[40:43], v[88:91]
  ds_read_b64_tr_b16 v[60:61], v23 offset:36864
  v_mfma_f32_16x16x32_bf16 v[92:95], a[96:99], v[44:47], v[92:95]
  ds_read_b64_tr_b16 v[62:63], v23 offset:37376
  buffer_load_dwordx4 v[216:219], v9, s[24:27], s40 offen offset:2048
  v_mfma_f32_16x16x32_bf16 v[156:159], v[164:167], v[32:35], v[156:159]
  v_mfma_f32_16x16x32_bf16 v[160:163], v[32:35], v[32:35], v[160:163]
  buffer_load_dwordx4 v[220:223], v9, s[24:27], s40 offen offset:3072
  s_waitcnt lgkmcnt(0)
  s_waitcnt vmcnt(28)
  v_mfma_f32_16x16x32_bf16 v[64:67], a[36:39], v[48:51], v[64:67]
  ds_read_b64_tr_b16 v[32:33], v20 offset:40960
  v_mfma_f32_16x16x32_bf16 v[68:71], a[36:39], v[52:55], v[68:71]
  ds_read_b64_tr_b16 v[34:35], v20 offset:41472
  v_mfma_f32_16x16x32_bf16 v[72:75], a[36:39], v[56:59], v[72:75]
  ds_read_b64_tr_b16 v[36:37], v21 offset:40960
  v_mfma_f32_16x16x32_bf16 v[76:79], a[36:39], v[60:63], v[76:79]
  ds_read_b64_tr_b16 v[38:39], v21 offset:41472
  v_mfma_f32_16x16x32_bf16 v[80:83], a[100:103], v[48:51], v[80:83]
  ds_read_b64_tr_b16 v[40:41], v22 offset:40960
  v_mfma_f32_16x16x32_bf16 v[84:87], a[100:103], v[52:55], v[84:87]
  ds_read_b64_tr_b16 v[42:43], v22 offset:41472
  v_mfma_f32_16x16x32_bf16 v[88:91], a[100:103], v[56:59], v[88:91]
  ds_read_b64_tr_b16 v[44:45], v23 offset:40960
  v_mfma_f32_16x16x32_bf16 v[92:95], a[100:103], v[60:63], v[92:95]
  ds_read_b64_tr_b16 v[46:47], v23 offset:41472
  v_mfma_f32_16x16x32_bf16 v[156:159], v[164:167], v[48:51], v[156:159]
  v_mfma_f32_16x16x32_bf16 v[160:163], v[48:51], v[48:51], v[160:163]
  s_waitcnt lgkmcnt(0)
  s_waitcnt vmcnt(26)
  v_mfma_f32_16x16x32_bf16 v[64:67], a[40:43], v[32:35], v[64:67]
  ds_read_b64_tr_b16 v[48:49], v20 offset:45056
  v_mfma_f32_16x16x32_bf16 v[68:71], a[40:43], v[36:39], v[68:71]
  ds_read_b64_tr_b16 v[50:51], v20 offset:45568
  v_mfma_f32_16x16x32_bf16 v[72:75], a[40:43], v[40:43], v[72:75]
  ds_read_b64_tr_b16 v[52:53], v21 offset:45056
  v_mfma_f32_16x16x32_bf16 v[76:79], a[40:43], v[44:47], v[76:79]
  ds_read_b64_tr_b16 v[54:55], v21 offset:45568
  v_mfma_f32_16x16x32_bf16 v[80:83], a[104:107], v[32:35], v[80:83]
  ds_read_b64_tr_b16 v[56:57], v22 offset:45056
  v_mfma_f32_16x16x32_bf16 v[84:87], a[104:107], v[36:39], v[84:87]
  ds_read_b64_tr_b16 v[58:59], v22 offset:45568
  v_mfma_f32_16x16x32_bf16 v[88:91], a[104:107], v[40:43], v[88:91]
  ds_read_b64_tr_b16 v[60:61], v23 offset:45056
  v_mfma_f32_16x16x32_bf16 v[92:95], a[104:107], v[44:47], v[92:95]
  ds_read_b64_tr_b16 v[62:63], v23 offset:45568
  v_mfma_f32_16x16x32_bf16 v[156:159], v[164:167], v[32:35], v[156:159]
  v_mfma_f32_16x16x32_bf16 v[160:163], v[32:35], v[32:35], v[160:163]
  s_waitcnt vmcnt(20)
  s_barrier
  s_waitcnt lgkmcnt(0)
  v_mfma_f32_16x16x32_bf16 v[64:67], a[44:47], v[48:51], v[64:67]
  ds_read_b64_tr_b16 v[32:33], v20 offset:49152
  v_mfma_f32_16x16x32_bf16 v[68:71], a[44:47], v[52:55], v[68:71]
  ds_read_b64_tr_b16 v[34:35], v20 offset:49664
  v_mfma_f32_16x16x32_bf16 v[72:75], a[44:47], v[56:59], v[72:75]
  ds_read_b64_tr_b16 v[36:37], v21 offset:49152
  v_mfma_f32_16x16x32_bf16 v[76:79], a[44:47], v[60:63], v[76:79]
  ds_read_b64_tr_b16 v[38:39], v21 offset:49664
  v_mfma_f32_16x16x32_bf16 v[80:83], a[108:111], v[48:51], v[80:83]
  ds_read_b64_tr_b16 v[40:41], v22 offset:49152
  v_mfma_f32_16x16x32_bf16 v[84:87], a[108:111], v[52:55], v[84:87]
  ds_read_b64_tr_b16 v[42:43], v22 offset:49664
  v_mfma_f32_16x16x32_bf16 v[88:91], a[108:111], v[56:59], v[88:91]
  ds_read_b64_tr_b16 v[44:45], v23 offset:49152
  v_mfma_f32_16x16x32_bf16 v[92:95], a[108:111], v[60:63], v[92:95]
  ds_read_b64_tr_b16 v[46:47], v23 offset:49664
  v_mfma_f32_16x16x32_bf16 v[156:159], v[164:167], v[48:51], v[156:159]
  v_mfma_f32_16x16x32_bf16 v[160:163], v[48:51], v[48:51], v[160:163]
  s_waitcnt lgkmcnt(0)
  s_waitcnt vmcnt(18)
  v_mfma_f32_16x16x32_bf16 v[64:67], a[48:51], v[32:35], v[64:67]
  ds_read_b64_tr_b16 v[48:49], v20 offset:53248
  v_mfma_f32_16x16x32_bf16 v[68:71], a[48:51], v[36:39], v[68:71]
  ds_read_b64_tr_b16 v[50:51], v20 offset:53760
  v_mfma_f32_16x16x32_bf16 v[72:75], a[48:51], v[40:43], v[72:75]
  ds_read_b64_tr_b16 v[52:53], v21 offset:53248
  v_mfma_f32_16x16x32_bf16 v[76:79], a[48:51], v[44:47], v[76:79]
  ds_read_b64_tr_b16 v[54:55], v21 offset:53760
  v_mfma_f32_16x16x32_bf16 v[80:83], a[112:115], v[32:35], v[80:83]
  ds_read_b64_tr_b16 v[56:57], v22 offset:53248
  v_mfma_f32_16x16x32_bf16 v[84:87], a[112:115], v[36:39], v[84:87]
  ds_read_b64_tr_b16 v[58:59], v22 offset:53760
  v_mfma_f32_16x16x32_bf16 v[88:91], a[112:115], v[40:43], v[88:91]
  ds_read_b64_tr_b16 v[60:61], v23 offset:53248
  v_mfma_f32_16x16x32_bf16 v[92:95], a[112:115], v[44:47], v[92:95]
  ds_read_b64_tr_b16 v[62:63], v23 offset:53760
  v_mfma_f32_16x16x32_bf16 v[156:159], v[164:167], v[32:35], v[156:159]
  v_mfma_f32_16x16x32_bf16 v[160:163], v[32:35], v[32:35], v[160:163]
  s_waitcnt lgkmcnt(0)
  s_waitcnt vmcnt(16)
  v_mfma_f32_16x16x32_bf16 v[64:67], a[52:55], v[48:51], v[64:67]
  ds_read_b64_tr_b16 v[32:33], v20 offset:57344
  v_mfma_f32_16x16x32_bf16 v[68:71], a[52:55], v[52:55], v[68:71]
  ds_read_b64_tr_b16 v[34:35], v20 offset:57856
  v_mfma_f32_16x16x32_bf16 v[72:75], a[52:55], v[56:59], v[72:75]
  ds_read_b64_tr_b16 v[36:37], v21 offset:57344
  v_mfma_f32_16x16x32_bf16 v[76:79], a[52:55], v[60:63], v[76:79]
  ds_read_b64_tr_b16 v[38:39], v21 offset:57856
  v_mfma_f32_16x16x32_bf16 v[80:83], a[116:119], v[48:51], v[80:83]
  ds_read_b64_tr_b16 v[40:41], v22 offset:57344
  v_mfma_f32_16x16x32_bf16 v[84:87], a[116:119], v[52:55], v[84:87]
  ds_read_b64_tr_b16 v[42:43], v22 offset:57856
  v_mfma_f32_16x16x32_bf16 v[88:91], a[116:119], v[56:59], v[88:91]
  ds_read_b64_tr_b16 v[44:45], v23 offset:57344
  v_mfma_f32_16x16x32_bf16 v[92:95], a[116:119], v[60:63], v[92:95]
  ds_read_b64_tr_b16 v[46:47], v23 offset:57856
  v_mfma_f32_16x16x32_bf16 v[156:159], v[164:167], v[48:51], v[156:159]
  v_mfma_f32_16x16x32_bf16 v[160:163], v[48:51], v[48:51], v[160:163]
  s_waitcnt lgkmcnt(0)
  s_waitcnt vmcnt(14)
  v_mfma_f32_16x16x32_bf16 v[64:67], a[56:59], v[32:35], v[64:67]
  ds_read_b64_tr_b16 v[48:49], v20 offset:61440
  v_mfma_f32_16x16x32_bf16 v[68:71], a[56:59], v[36:39], v[68:71]
  ds_read_b64_tr_b16 v[50:51], v20 offset:61952
  v_mfma_f32_16x16x32_bf16 v[72:75], a[56:59], v[40:43], v[72:75]
  ds_read_b64_tr_b16 v[52:53], v21 offset:61440
  v_mfma_f32_16x16x32_bf16 v[76:79], a[56:59], v[44:47], v[76:79]
  ds_read_b64_tr_b16 v[54:55], v21 offset:61952
  v_mfma_f32_16x16x32_bf16 v[80:83], a[120:123], v[32:35], v[80:83]
  ds_read_b64_tr_b16 v[56:57], v22 offset:61440
  v_mfma_f32_16x16x32_bf16 v[84:87], a[120:123], v[36:39], v[84:87]
  ds_read_b64_tr_b16 v[58:59], v22 offset:61952
  v_mfma_f32_16x16x32_bf16 v[88:91], a[120:123], v[40:43], v[88:91]
  ds_read_b64_tr_b16 v[60:61], v23 offset:61440
  v_mfma_f32_16x16x32_bf16 v[92:95], a[120:123], v[44:47], v[92:95]
  ds_read_b64_tr_b16 v[62:63], v23 offset:61952
  v_mfma_f32_16x16x32_bf16 v[156:159], v[164:167], v[32:35], v[156:159]
  v_mfma_f32_16x16x32_bf16 v[160:163], v[32:35], v[32:35], v[160:163]
  s_waitcnt lgkmcnt(0)
  s_waitcnt vmcnt(12)
  v_mfma_f32_16x16x32_bf16 v[64:67], a[60:63], v[48:51], v[64:67]
  ds_read_b64_tr_b16 v[32:33], v20 offset:0
  v_mfma_f32_16x16x32_bf16 v[68:71], a[60:63], v[52:55], v[68:71]
  ds_read_b64_tr_b16 v[34:35], v20 offset:512
  v_mfma_f32_16x16x32_bf16 v[72:75], a[60:63], v[56:59], v[72:75]
  ds_read_b64_tr_b16 v[36:37], v21 offset:0
  v_mfma_f32_16x16x32_bf16 v[76:79], a[60:63], v[60:63], v[76:79]
  ds_read_b64_tr_b16 v[38:39], v21 offset:512
  v_mfma_f32_16x16x32_bf16 v[80:83], a[124:127], v[48:51], v[80:83]
  ds_read_b64_tr_b16 v[40:41], v22 offset:0
  v_mfma_f32_16x16x32_bf16 v[84:87], a[124:127], v[52:55], v[84:87]
  ds_read_b64_tr_b16 v[42:43], v22 offset:512
  v_mfma_f32_16x16x32_bf16 v[88:91], a[124:127], v[56:59], v[88:91]
  ds_read_b64_tr_b16 v[44:45], v23 offset:0
  v_mfma_f32_16x16x32_bf16 v[92:95], a[124:127], v[60:63], v[92:95]
  ds_read_b64_tr_b16 v[46:47], v23 offset:512
  v_mfma_f32_16x16x32_bf16 v[156:159], v[164:167], v[48:51], v[156:159]
  v_mfma_f32_16x16x32_bf16 v[160:163], v[48:51], v[48:51], v[160:163]
  v_and_b32 v27, 3, v1
  v_cmp_eq_u32 vcc, 1, v27
  s_nop 5
  v_cndmask_b32 v25, v160, v161, vcc
  v_cmp_eq_u32 vcc, 2, v27
  s_nop 1
  v_cndmask_b32 v25, v25, v162, vcc
  v_cmp_eq_u32 vcc, 3, v27
  s_nop 1
  v_cndmask_b32 v25, v25, v163, vcc
  v_mul_f32 v24, 0x3b000000, v156
  v_mul_f32 v25, 0x3b000000, v25
  v_fma_f32 v25, -v24, v24, v25
  v_max_f32 v25, 0, v25
  v_cvt_pk_bf16_f32 v25, v25, v25
  v_and_b32 v25, 0xffff0000, v25
  v_add_f32 v25, 0x3727c5ac, v25
  v_cvt_pk_bf16_f32 v25, v25, v25
  v_and_b32 v25, 0xffff0000, v25
  v_sqrt_f32 v25, v25
  s_nop 0
  v_cvt_pk_bf16_f32 v25, v25, v25
  v_and_b32 v25, 0xffff0000, v25
  v_rcp_f32 v28, v25
  v_cvt_pk_bf16_f32 v24, v24, v24
  v_and_b32 v24, 0xffff0000, v24
  v_mul_f32 v29, v24, v28
  s_lshl_b32 s16, s20, 7
  s_add_u32 s16, s16, 131072
  v_add_u32 v19, s16, v18
  v_cmp_eq_u32 vcc, v13, v10
  s_nop 0
  s_and_saveexec_b64 s[44:45], vcc
  ds_write_b64 v19, v[28:29] offset:0
  s_mov_b64 exec, s[44:45]
  v_lshlrev_b32 v11, 4, v10
  v_add_u32 v11, s46, v11
  s_waitcnt vmcnt(8)
  ds_read_b128 v[112:115], v11 offset:4096
  ds_read_b128 v[116:119], v11 offset:4352
  ds_read_b128 v[144:147], v11 offset:4608
  ds_read_b128 v[148:151], v11 offset:4864
  ds_read_b128 v[120:123], v11 offset:4160
  ds_read_b128 v[124:127], v11 offset:4416
  ds_read_b128 v[152:155], v11 offset:4672
  ds_read_b128 v[156:159], v11 offset:4928
  ds_read_b128 v[128:131], v11 offset:4224
  ds_read_b128 v[132:135], v11 offset:4480
  ds_read_b128 v[160:163], v11 offset:4736
  ds_read_b128 v[164:167], v11 offset:4992
  s_waitcnt lgkmcnt(0)
  s_barrier
  ds_read_b64 v[136:137], v19 offset:0
  v_xor_b32 v27, 128, v19
  ds_read_b64 v[138:139], v27 offset:0
  v_xor_b32 v27, 256, v19
  ds_read_b64 v[140:141], v27 offset:0
  v_xor_b32 v27, 384, v19
  ds_read_b64 v[142:143], v27 offset:0
  v_pk_add_f32 v[112:113], v[112:113], v[144:145]
  v_pk_add_f32 v[114:115], v[114:115], v[146:147]
  v_pk_add_f32 v[116:117], v[116:117], v[148:149]
  v_pk_add_f32 v[118:119], v[118:119], v[150:151]
  v_pk_add_f32 v[120:121], v[120:121], v[152:153]
  v_pk_add_f32 v[122:123], v[122:123], v[154:155]
  v_pk_add_f32 v[124:125], v[124:125], v[156:157]
  v_pk_add_f32 v[126:127], v[126:127], v[158:159]
  v_pk_add_f32 v[128:129], v[128:129], v[160:161]
  v_pk_add_f32 v[130:131], v[130:131], v[162:163]
  v_pk_add_f32 v[132:133], v[132:133], v[164:165]
  v_pk_add_f32 v[134:135], v[134:135], v[166:167]
  v_lshlrev_b32 v29, 3, v1
  v_add_u32 v28, 131072, v29
  s_xor_b32 s16, s20, 0
  s_mul_i32 s16, s16, 6
  s_add_u32 s16, s16, s47
  s_lshl_b32 s16, s16, 9
  v_add_u32 v184, s16, v28
  s_xor_b32 s16, s20, 1
  s_mul_i32 s16, s16, 6
  s_add_u32 s16, s16, s47
  s_lshl_b32 s16, s16, 9
  v_add_u32 v185, s16, v28
  s_xor_b32 s16, s20, 2
  s_mul_i32 s16, s16, 6
  s_add_u32 s16, s16, s47
  s_lshl_b32 s16, s16, 9
  v_add_u32 v186, s16, v28
  s_xor_b32 s16, s20, 3
  s_mul_i32 s16, s16, 6
  s_add_u32 s16, s16, s47
  s_lshl_b32 s16, s16, 9
  v_add_u32 v187, s16, v28
  s_waitcnt lgkmcnt(0)
  v_pk_fma_f32 v[144:145], v[112:113], v[136:137], v[116:117] op_sel:[0,1,0] op_sel_hi:[1,1,1] neg_lo:[0,1,0] neg_hi:[0,1,0]
  v_pk_fma_f32 v[146:147], v[114:115], v[136:137], v[118:119] op_sel:[0,1,0] op_sel_hi:[1,1,1] neg_lo:[0,1,0] neg_hi:[0,1,0]
  v_pk_fma_f32 v[64:65], v[64:65], v[136:137], v[144:145] op_sel_hi:[1,0,1]
  v_pk_fma_f32 v[66:67], v[66:67], v[136:137], v[146:147] op_sel_hi:[1,0,1]
  s_add_u32 s40, s36, 8192
  buffer_load_dwordx4 v[224:227], v9, s[24:27], s40 offen offset:0
  v_pk_mul_f32 v[144:145], v[64:65], v[64:65]
  v_pk_mul_f32 v[146:147], v[66:67], v[66:67]
  v_pk_fma_f32 v[144:145], v[144:145], s[18:19], v[30:31] op_sel_hi:[1,0,1]
  v_pk_fma_f32 v[146:147], v[146:147], s[18:19], v[30:31] op_sel_hi:[1,0,1]
  v_pk_mul_f32 v[144:145], v[144:145], v[64:65]
  v_pk_mul_f32 v[146:147], v[146:147], v[66:67]
  buffer_load_dwordx4 v[228:231], v9, s[24:27], s40 offen offset:1024
  v_exp_f32 v144, v144
  v_exp_f32 v146, v146
  v_exp_f32 v145, v145
  v_exp_f32 v147, v147
  v_pk_add_f32 v[144:145], v[144:145], 1.0 op_sel_hi:[1,0]
  v_pk_add_f32 v[146:147], v[146:147], 1.0 op_sel_hi:[1,0]
  buffer_load_dwordx4 v[232:235], v9, s[24:27], s40 offen offset:2048
  v_rcp_f32 v144, v144
  v_rcp_f32 v146, v146
  v_rcp_f32 v145, v145
  v_rcp_f32 v147, v147
  v_pk_mul_f32 v[64:65], v[64:65], v[144:145]
  v_pk_mul_f32 v[66:67], v[66:67], v[146:147]
  buffer_load_dwordx4 v[236:239], v9, s[24:27], s40 offen offset:3072
  v_cvt_pk_bf16_f32 v64, v64, v65
  v_cvt_pk_bf16_f32 v65, v66, v67
  v_pk_fma_f32 v[144:145], v[112:113], v[138:139], v[116:117] op_sel:[0,1,0] op_sel_hi:[1,1,1] neg_lo:[0,1,0] neg_hi:[0,1,0]
  v_pk_fma_f32 v[146:147], v[114:115], v[138:139], v[118:119] op_sel:[0,1,0] op_sel_hi:[1,1,1] neg_lo:[0,1,0] neg_hi:[0,1,0]
  v_pk_fma_f32 v[68:69], v[68:69], v[138:139], v[144:145] op_sel_hi:[1,0,1]
  v_pk_fma_f32 v[70:71], v[70:71], v[138:139], v[146:147] op_sel_hi:[1,0,1]
  s_add_u32 s40, s36, 12288
  buffer_load_dwordx4 v[240:243], v9, s[24:27], s40 offen offset:0
  v_pk_mul_f32 v[144:145], v[68:69], v[68:69]
  v_pk_mul_f32 v[146:147], v[70:71], v[70:71]
  v_pk_fma_f32 v[144:145], v[144:145], s[18:19], v[30:31] op_sel_hi:[1,0,1]
  v_pk_fma_f32 v[146:147], v[146:147], s[18:19], v[30:31] op_sel_hi:[1,0,1]
  v_pk_mul_f32 v[144:145], v[144:145], v[68:69]
  v_pk_mul_f32 v[146:147], v[146:147], v[70:71]
  buffer_load_dwordx4 v[244:247], v9, s[24:27], s40 offen offset:1024
  v_exp_f32 v144, v144
  v_exp_f32 v146, v146
  v_exp_f32 v145, v145
  v_exp_f32 v147, v147
  v_pk_add_f32 v[144:145], v[144:145], 1.0 op_sel_hi:[1,0]
  v_pk_add_f32 v[146:147], v[146:147], 1.0 op_sel_hi:[1,0]
  buffer_load_dwordx4 v[248:251], v9, s[24:27], s40 offen offset:2048
  v_rcp_f32 v144, v144
  v_rcp_f32 v146, v146
  v_rcp_f32 v145, v145
  v_rcp_f32 v147, v147
  v_pk_mul_f32 v[68:69], v[68:69], v[144:145]
  v_pk_mul_f32 v[70:71], v[70:71], v[146:147]
  buffer_load_dwordx4 v[252:255], v9, s[24:27], s40 offen offset:3072
  v_cvt_pk_bf16_f32 v68, v68, v69
  v_cvt_pk_bf16_f32 v69, v70, v71
  v_pk_fma_f32 v[144:145], v[112:113], v[140:141], v[116:117] op_sel:[0,1,0] op_sel_hi:[1,1,1] neg_lo:[0,1,0] neg_hi:[0,1,0]
  v_pk_fma_f32 v[146:147], v[114:115], v[140:141], v[118:119] op_sel:[0,1,0] op_sel_hi:[1,1,1] neg_lo:[0,1,0] neg_hi:[0,1,0]
  v_pk_fma_f32 v[72:73], v[72:73], v[140:141], v[144:145] op_sel_hi:[1,0,1]
  v_pk_fma_f32 v[74:75], v[74:75], v[140:141], v[146:147] op_sel_hi:[1,0,1]
  s_add_u32 s13, s73, 0
  s_add_u32 m0, s19, 65536
  s_nop 0
  buffer_load_dwordx4 v168, s[56:59], s13 offen offset:0 lds
  v_pk_mul_f32 v[144:145], v[72:73], v[72:73]
  v_pk_mul_f32 v[146:147], v[74:75], v[74:75]
  v_pk_fma_f32 v[144:145], v[144:145], s[18:19], v[30:31] op_sel_hi:[1,0,1]
  v_pk_fma_f32 v[146:147], v[146:147], s[18:19], v[30:31] op_sel_hi:[1,0,1]
  v_pk_mul_f32 v[144:145], v[144:145], v[72:73]
  v_pk_mul_f32 v[146:147], v[146:147], v[74:75]
  buffer_load_dwordx4 v169, s[56:59], s13 offen offset:1024 lds
  v_exp_f32 v144, v144
  v_exp_f32 v146, v146
  v_exp_f32 v145, v145
  v_exp_f32 v147, v147
  v_pk_add_f32 v[144:145], v[144:145], 1.0 op_sel_hi:[1,0]
  v_pk_add_f32 v[146:147], v[146:147], 1.0 op_sel_hi:[1,0]
  buffer_load_dwordx4 v170, s[56:59], s13 offen offset:2048 lds
  v_rcp_f32 v144, v144
  v_rcp_f32 v146, v146
  v_rcp_f32 v145, v145
  v_rcp_f32 v147, v147
  v_pk_mul_f32 v[72:73], v[72:73], v[144:145]
  v_pk_mul_f32 v[74:75], v[74:75], v[146:147]
  buffer_load_dwordx4 v171, s[56:59], s13 offen offset:3072 lds
  v_cvt_pk_bf16_f32 v72, v72, v73
  v_cvt_pk_bf16_f32 v73, v74, v75
  v_pk_fma_f32 v[144:145], v[112:113], v[142:143], v[116:117] op_sel:[0,1,0] op_sel_hi:[1,1,1] neg_lo:[0,1,0] neg_hi:[0,1,0]
  v_pk_fma_f32 v[146:147], v[114:115], v[142:143], v[118:119] op_sel:[0,1,0] op_sel_hi:[1,1,1] neg_lo:[0,1,0] neg_hi:[0,1,0]
  v_pk_fma_f32 v[76:77], v[76:77], v[142:143], v[144:145] op_sel_hi:[1,0,1]
  v_pk_fma_f32 v[78:79], v[78:79], v[142:143], v[146:147] op_sel_hi:[1,0,1]
  s_add_u32 m0, s19, 69632
  s_nop 0
  buffer_load_dwordx4 v172, s[56:59], s13 offen offset:0 lds
  v_pk_mul_f32 v[144:145], v[76:77], v[76:77]
  v_pk_mul_f32 v[146:147], v[78:79], v[78:79]
  v_pk_fma_f32 v[144:145], v[144:145], s[18:19], v[30:31] op_sel_hi:[1,0,1]
  v_pk_fma_f32 v[146:147], v[146:147], s[18:19], v[30:31] op_sel_hi:[1,0,1]
  v_pk_mul_f32 v[144:145], v[144:145], v[76:77]
  v_pk_mul_f32 v[146:147], v[146:147], v[78:79]
  buffer_load_dwordx4 v173, s[56:59], s13 offen offset:1024 lds
  v_exp_f32 v144, v144
  v_exp_f32 v146, v146
  v_exp_f32 v145, v145
  v_exp_f32 v147, v147
  v_pk_add_f32 v[144:145], v[144:145], 1.0 op_sel_hi:[1,0]
  v_pk_add_f32 v[146:147], v[146:147], 1.0 op_sel_hi:[1,0]
  buffer_load_dwordx4 v174, s[56:59], s13 offen offset:2048 lds
  v_rcp_f32 v144, v144
  v_rcp_f32 v146, v146
  v_rcp_f32 v145, v145
  v_rcp_f32 v147, v147
  v_pk_mul_f32 v[76:77], v[76:77], v[144:145]
  v_pk_mul_f32 v[78:79], v[78:79], v[146:147]
  buffer_load_dwordx4 v175, s[56:59], s13 offen offset:3072 lds
  v_cvt_pk_bf16_f32 v76, v76, v77
  v_cvt_pk_bf16_f32 v77, v78, v79
  v_dot2_f32_bf16 v148, v64, v26, 0
  v_dot2_f32_bf16 v152, v64, v64, 0
  v_dot2_f32_bf16 v148, v65, v26, v148
  v_dot2_f32_bf16 v152, v65, v65, v152
  v_dot2_f32_bf16 v149, v68, v26, 0
  v_dot2_f32_bf16 v153, v68, v68, 0
  v_dot2_f32_bf16 v149, v69, v26, v149
  v_dot2_f32_bf16 v153, v69, v69, v153
  v_dot2_f32_bf16 v150, v72, v26, 0
  v_dot2_f32_bf16 v154, v72, v72, 0
  v_dot2_f32_bf16 v150, v73, v26, v150
  v_dot2_f32_bf16 v154, v73, v73, v154
  v_dot2_f32_bf16 v151, v76, v26, 0
  v_dot2_f32_bf16 v155, v76, v76, 0
  v_dot2_f32_bf16 v151, v77, v26, v151
  v_dot2_f32_bf16 v155, v77, v77, v155
  v_pk_fma_f32 v[144:145], v[120:121], v[136:137], v[124:125] op_sel:[0,1,0] op_sel_hi:[1,1,1] neg_lo:[0,1,0] neg_hi:[0,1,0]
  v_pk_fma_f32 v[146:147], v[122:123], v[136:137], v[126:127] op_sel:[0,1,0] op_sel_hi:[1,1,1] neg_lo:[0,1,0] neg_hi:[0,1,0]
  v_pk_fma_f32 v[80:81], v[80:81], v[136:137], v[144:145] op_sel_hi:[1,0,1]
  v_pk_fma_f32 v[82:83], v[82:83], v[136:137], v[146:147] op_sel_hi:[1,0,1]
  s_add_u32 s13, s73, 128
  s_add_u32 m0, s19, 73728
  s_nop 0
  buffer_load_dwordx4 v168, s[56:59], s13 offen offset:0 lds
  v_pk_mul_f32 v[144:145], v[80:81], v[80:81]
  v_pk_mul_f32 v[146:147], v[82:83], v[82:83]
  v_pk_fma_f32 v[144:145], v[144:145], s[18:19], v[30:31] op_sel_hi:[1,0,1]
  v_pk_fma_f32 v[146:147], v[146:147], s[18:19], v[30:31] op_sel_hi:[1,0,1]
  v_pk_mul_f32 v[144:145], v[144:145], v[80:81]
  v_pk_mul_f32 v[146:147], v[146:147], v[82:83]
  buffer_load_dwordx4 v169, s[56:59], s13 offen offset:1024 lds
  v_exp_f32 v144, v144
  v_exp_f32 v146, v146
  v_exp_f32 v145, v145
  v_exp_f32 v147, v147
  v_pk_add_f32 v[144:145], v[144:145], 1.0 op_sel_hi:[1,0]
  v_pk_add_f32 v[146:147], v[146:147], 1.0 op_sel_hi:[1,0]
  buffer_load_dwordx4 v170, s[56:59], s13 offen offset:2048 lds
  v_rcp_f32 v144, v144
  v_rcp_f32 v146, v146
  v_rcp_f32 v145, v145
  v_rcp_f32 v147, v147
  v_pk_mul_f32 v[80:81], v[80:81], v[144:145]
  v_pk_mul_f32 v[82:83], v[82:83], v[146:147]
  buffer_load_dwordx4 v171, s[56:59], s13 offen offset:3072 lds
  v_cvt_pk_bf16_f32 v80, v80, v81
  v_cvt_pk_bf16_f32 v81, v82, v83
  v_pk_fma_f32 v[144:145], v[120:121], v[138:139], v[124:125] op_sel:[0,1,0] op_sel_hi:[1,1,1] neg_lo:[0,1,0] neg_hi:[0,1,0]
  v_pk_fma_f32 v[146:147], v[122:123], v[138:139], v[126:127] op_sel:[0,1,0] op_sel_hi:[1,1,1] neg_lo:[0,1,0] neg_hi:[0,1,0]
  v_pk_fma_f32 v[84:85], v[84:85], v[138:139], v[144:145] op_sel_hi:[1,0,1]
  v_pk_fma_f32 v[86:87], v[86:87], v[138:139], v[146:147] op_sel_hi:[1,0,1]
  s_add_u32 m0, s19, 77824
  s_nop 0
  buffer_load_dwordx4 v172, s[56:59], s13 offen offset:0 lds
  v_pk_mul_f32 v[144:145], v[84:85], v[84:85]
  v_pk_mul_f32 v[146:147], v[86:87], v[86:87]
  v_pk_fma_f32 v[144:145], v[144:145], s[18:19], v[30:31] op_sel_hi:[1,0,1]
  v_pk_fma_f32 v[146:147], v[146:147], s[18:19], v[30:31] op_sel_hi:[1,0,1]
  v_pk_mul_f32 v[144:145], v[144:145], v[84:85]
  v_pk_mul_f32 v[146:147], v[146:147], v[86:87]
  buffer_load_dwordx4 v173, s[56:59], s13 offen offset:1024 lds
  v_exp_f32 v144, v144
  v_exp_f32 v146, v146
  v_exp_f32 v145, v145
  v_exp_f32 v147, v147
  v_pk_add_f32 v[144:145], v[144:145], 1.0 op_sel_hi:[1,0]
  v_pk_add_f32 v[146:147], v[146:147], 1.0 op_sel_hi:[1,0]
  buffer_load_dwordx4 v174, s[56:59], s13 offen offset:2048 lds
  v_rcp_f32 v144, v144
  v_rcp_f32 v146, v146
  v_rcp_f32 v145, v145
  v_rcp_f32 v147, v147
  v_pk_mul_f32 v[84:85], v[84:85], v[144:145]
  v_pk_mul_f32 v[86:87], v[86:87], v[146:147]
  buffer_load_dwordx4 v175, s[56:59], s13 offen offset:3072 lds
  v_cvt_pk_bf16_f32 v84, v84, v85
  v_cvt_pk_bf16_f32 v85, v86, v87
  v_pk_fma_f32 v[144:145], v[120:121], v[140:141], v[124:125] op_sel:[0,1,0] op_sel_hi:[1,1,1] neg_lo:[0,1,0] neg_hi:[0,1,0]
  v_pk_fma_f32 v[146:147], v[122:123], v[140:141], v[126:127] op_sel:[0,1,0] op_sel_hi:[1,1,1] neg_lo:[0,1,0] neg_hi:[0,1,0]
  v_pk_fma_f32 v[88:89], v[88:89], v[140:141], v[144:145] op_sel_hi:[1,0,1]
  v_pk_fma_f32 v[90:91], v[90:91], v[140:141], v[146:147] op_sel_hi:[1,0,1]
  v_pk_mul_f32 v[144:145], v[88:89], v[88:89]
  v_pk_mul_f32 v[146:147], v[90:91], v[90:91]
  v_pk_fma_f32 v[144:145], v[144:145], s[18:19], v[30:31] op_sel_hi:[1,0,1]
  v_pk_fma_f32 v[146:147], v[146:147], s[18:19], v[30:31] op_sel_hi:[1,0,1]
  v_pk_mul_f32 v[144:145], v[144:145], v[88:89]
  v_pk_mul_f32 v[146:147], v[146:147], v[90:91]
  v_exp_f32 v144, v144
  v_exp_f32 v146, v146
  v_exp_f32 v145, v145
  v_exp_f32 v147, v147
  v_pk_add_f32 v[144:145], v[144:145], 1.0 op_sel_hi:[1,0]
  v_pk_add_f32 v[146:147], v[146:147], 1.0 op_sel_hi:[1,0]
  v_rcp_f32 v144, v144
  v_rcp_f32 v146, v146
  v_rcp_f32 v145, v145
  v_rcp_f32 v147, v147
  v_pk_mul_f32 v[88:89], v[88:89], v[144:145]
  v_pk_mul_f32 v[90:91], v[90:91], v[146:147]
  v_cvt_pk_bf16_f32 v88, v88, v89
  v_cvt_pk_bf16_f32 v89, v90, v91
  v_pk_fma_f32 v[144:145], v[120:121], v[142:143], v[124:125] op_sel:[0,1,0] op_sel_hi:[1,1,1] neg_lo:[0,1,0] neg_hi:[0,1,0]
  v_pk_fma_f32 v[146:147], v[122:123], v[142:143], v[126:127] op_sel:[0,1,0] op_sel_hi:[1,1,1] neg_lo:[0,1,0] neg_hi:[0,1,0]
  v_pk_fma_f32 v[92:93], v[92:93], v[142:143], v[144:145] op_sel_hi:[1,0,1]
  v_pk_fma_f32 v[94:95], v[94:95], v[142:143], v[146:147] op_sel_hi:[1,0,1]
  v_pk_mul_f32 v[144:145], v[92:93], v[92:93]
  v_pk_mul_f32 v[146:147], v[94:95], v[94:95]
  v_pk_fma_f32 v[144:145], v[144:145], s[18:19], v[30:31] op_sel_hi:[1,0,1]
  v_pk_fma_f32 v[146:147], v[146:147], s[18:19], v[30:31] op_sel_hi:[1,0,1]
  v_pk_mul_f32 v[144:145], v[144:145], v[92:93]
  v_pk_mul_f32 v[146:147], v[146:147], v[94:95]
  v_exp_f32 v144, v144
  v_exp_f32 v146, v146
  v_exp_f32 v145, v145
  v_exp_f32 v147, v147
  v_pk_add_f32 v[144:145], v[144:145], 1.0 op_sel_hi:[1,0]
  v_pk_add_f32 v[146:147], v[146:147], 1.0 op_sel_hi:[1,0]
  v_rcp_f32 v144, v144
  v_rcp_f32 v146, v146
  v_rcp_f32 v145, v145
  v_rcp_f32 v147, v147
  v_pk_mul_f32 v[92:93], v[92:93], v[144:145]
  v_pk_mul_f32 v[94:95], v[94:95], v[146:147]
  v_cvt_pk_bf16_f32 v92, v92, v93
  v_cvt_pk_bf16_f32 v93, v94, v95
  s_cmp_eq_u32 s33, 0
  s_cbranch_scc1 G1_NOZ2B
  v_dot2_f32_bf16 v148, v80, v26, v148
  v_dot2_f32_bf16 v152, v80, v80, v152
  v_dot2_f32_bf16 v148, v81, v26, v148
  v_dot2_f32_bf16 v152, v81, v81, v152
  v_dot2_f32_bf16 v149, v84, v26, v149
  v_dot2_f32_bf16 v153, v84, v84, v153
  v_dot2_f32_bf16 v149, v85, v26, v149
  v_dot2_f32_bf16 v153, v85, v85, v153
  v_dot2_f32_bf16 v150, v88, v26, v150
  v_dot2_f32_bf16 v154, v88, v88, v154
  v_dot2_f32_bf16 v150, v89, v26, v150
  v_dot2_f32_bf16 v154, v89, v89, v154
  v_dot2_f32_bf16 v151, v92, v26, v151
  v_dot2_f32_bf16 v155, v92, v92, v155
  v_dot2_f32_bf16 v151, v93, v26, v151
  v_dot2_f32_bf16 v155, v93, v93, v155
  s_branch G1_J1
G1_NOZ2B:
  ds_write_b64 v184, v[80:81] offset:8192
  ds_write_b64 v185, v[84:85] offset:8192
  ds_write_b64 v186, v[88:89] offset:8192
  ds_write_b64 v187, v[92:93] offset:8192
G1_J1:
  v_permlane32_swap_b32 v148, v152
  v_permlane32_swap_b32 v149, v153
  v_permlane32_swap_b32 v150, v154
  v_permlane32_swap_b32 v151, v155
  v_add_f32 v148, v148, v152
  v_add_f32 v149, v149, v153
  v_add_f32 v150, v150, v154
  v_add_f32 v151, v151, v155
  s_nop 0
  v_permlane16_swap_b32 v148, v150
  v_permlane16_swap_b32 v149, v151
  v_add_f32 v148, v148, v150
  v_add_f32 v149, v149, v151
  v_and_b32 v27, 1, v10
  v_lshlrev_b32 v27, 1, v27
  v_xor_b32 v27, s20, v27
  v_lshl_add_u32 v27, v27, 7, v18
  v_lshrrev_b32 v24, 1, v10
  v_lshl_add_u32 v27, v24, 2, v27
  s_lshl_b32 s16, s20, 9
  s_add_u32 s16, s16, 131072
  v_add_u32 v27, s16, v27
  v_xor_b32 v24, 128, v27
  ds_write_b32 v27, v148 offset:512
  ds_write_b32 v24, v149 offset:512
  s_lshl_b32 s21, s3, 12
  s_add_u32 s21, s21, 65536
  s_lshl_b32 s40, s4, 2
  s_add_u32 s40, s40, s5
  s_lshl_b32 s22, s40, 9
  s_add_u32 s22, s22, s21
  s_waitcnt lgkmcnt(0)
  s_barrier
  s_cmp_lg_u32 s20, 3
  s_cbranch_scc1 G1_PB
  ds_read_b64 v[148:149], v28 offset:512
  ds_read_b64 v[150:151], v28 offset:1024
  ds_read_b64 v[152:153], v28 offset:1536
  ds_read_b64 v[154:155], v28 offset:2048
  s_waitcnt lgkmcnt(0)
  v_pk_add_f32 v[148:149], v[148:149], v[150:151]
  v_pk_add_f32 v[152:153], v[152:153], v[154:155]
  v_pk_add_f32 v[148:149], v[148:149], v[152:153]
  v_max_f32 v149, 0, v149
  buffer_store_dwordx2 v[148:149], v29, s[24:27], s22 offen sc0 sc1
  s_waitcnt vmcnt(9)
  ds_read_b128 a[128:131], v176 offset:0
  ds_read_b128 a[132:135], v177 offset:0
  ds_read_b128 a[136:139], v178 offset:0
  ds_read_b128 a[140:143], v179 offset:0
  ds_read_b128 a[144:147], v180 offset:0
  ds_read_b128 a[148:151], v181 offset:0
  ds_read_b128 a[152:155], v182 offset:0
  ds_read_b128 a[156:159], v183 offset:0
  s_waitcnt lgkmcnt(0)
  s_add_u32 s13, s73, 256
  s_add_u32 m0, s19, 65536
  s_nop 0
  buffer_load_dwordx4 v168, s[56:59], s13 offen offset:0 lds
  buffer_load_dwordx4 v169, s[56:59], s13 offen offset:1024 lds
  buffer_load_dwordx4 v170, s[56:59], s13 offen offset:2048 lds
  buffer_load_dwordx4 v171, s[56:59], s13 offen offset:3072 lds
  s_add_u32 m0, s19, 69632
  s_nop 0
  buffer_load_dwordx4 v172, s[56:59], s13 offen offset:0 lds
  buffer_load_dwordx4 v173, s[56:59], s13 offen offset:1024 lds
  buffer_load_dwordx4 v174, s[56:59], s13 offen offset:2048 lds
  buffer_load_dwordx4 v175, s[56:59], s13 offen offset:3072 lds
  s_waitcnt vmcnt(9)
  ds_read_b128 a[160:163], v176 offset:8192
  ds_read_b128 a[164:167], v177 offset:8192
  ds_read_b128 a[168:171], v178 offset:8192
  ds_read_b128 a[172:175], v179 offset:8192
  ds_read_b128 a[176:179], v180 offset:8192
  ds_read_b128 a[180:183], v181 offset:8192
  ds_read_b128 a[184:187], v182 offset:8192
  ds_read_b128 a[188:191], v183 offset:8192
  s_waitcnt lgkmcnt(0)
  s_add_u32 s13, s73, 384
  s_add_u32 m0, s19, 73728
  s_nop 0
  buffer_load_dwordx4 v168, s[56:59], s13 offen offset:0 lds
  buffer_load_dwordx4 v169, s[56:59], s13 offen offset:1024 lds
  buffer_load_dwordx4 v170, s[56:59], s13 offen offset:2048 lds
  buffer_load_dwordx4 v171, s[56:59], s13 offen offset:3072 lds
  s_add_u32 m0, s19, 77824
  s_nop 0
  buffer_load_dwordx4 v172, s[56:59], s13 offen offset:0 lds
  buffer_load_dwordx4 v173, s[56:59], s13 offen offset:1024 lds
  buffer_load_dwordx4 v174, s[56:59], s13 offen offset:2048 lds
  buffer_load_dwordx4 v175, s[56:59], s13 offen offset:3072 lds
  s_mov_b32 s23, 0
G1_POLL:
  buffer_load_dwordx2 v[32:33], v29, s[24:27], s21 offen offset:0 sc0 sc1
  buffer_load_dwordx2 v[34:35], v29, s[24:27], s21 offen offset:512 sc0 sc1
  buffer_load_dwordx2 v[36:37], v29, s[24:27], s21 offen offset:1024 sc0 sc1
  buffer_load_dwordx2 v[38:39], v29, s[24:27], s21 offen offset:1536 sc0 sc1
  buffer_load_dwordx2 v[40:41], v29, s[24:27], s21 offen offset:2048 sc0 sc1
  buffer_load_dwordx2 v[42:43], v29, s[24:27], s21 offen offset:2560 sc0 sc1
  buffer_load_dwordx2 v[44:45], v29, s[24:27], s21 offen offset:3072 sc0 sc1
  buffer_load_dwordx2 v[46:47], v29, s[24:27], s21 offen offset:3584 sc0 sc1
  s_add_u32 s23, s23, 1
  s_waitcnt vmcnt(0)
  v_max3_u32 v48, v33, v35, v37
  v_max3_u32 v49, v39, v41, v43
  v_max3_u32 v48, v48, v45, v47
  v_max_u32 v48, v48, v49
  v_cmp_eq_u32 vcc, -1, v48
  s_cmp_gt_u32 s23, 100000
  s_cbranch_scc1 G1_GOT
  s_cbranch_vccz G1_GOT
  s_sleep 4
  s_branch G1_POLL
G1_GOT:
  v_pk_add_f32 v[32:33], v[32:33], v[40:41]
  v_pk_add_f32 v[34:35], v[34:35], v[42:43]
  v_pk_add_f32 v[36:37], v[36:37], v[44:45]
  v_pk_add_f32 v[38:39], v[38:39], v[46:47]
  v_pk_add_f32 v[32:33], v[32:33], v[36:37]
  v_pk_add_f32 v[34:35], v[34:35], v[38:39]
  v_pk_add_f32 v[32:33], v[32:33], v[34:35]
  v_mul_f32 v32, 0x3abe82fa, v32
  v_mul_f32 v33, 0x3abe82fa, v33
  v_fma_f32 v33, -v32, v32, v33
  v_max_f32 v33, 0, v33
  v_cvt_pk_bf16_f32 v33, v33, v33
  v_and_b32 v33, 0xffff0000, v33
  v_add_f32 v33, 0x3727c5ac, v33
  v_cvt_pk_bf16_f32 v33, v33, v33
  v_and_b32 v33, 0xffff0000, v33
  v_sqrt_f32 v33, v33
  s_nop 0
  v_cvt_pk_bf16_f32 v33, v33, v33
  v_and_b32 v33, 0xffff0000, v33
  v_rcp_f32 v34, v33
  v_cvt_pk_bf16_f32 v32, v32, v32
  v_and_b32 v32, 0xffff0000, v32
  v_mul_f32 v35, -v32, v34
  ds_write_b64 v28, v[34:35] offset:2560
  s_branch G1_FIN
G1_PB:
  s_waitcnt vmcnt(31)
  v_mfma_f32_16x16x32_bf16 v[96:99], v[192:195], v[32:35], v[96:99]
  ds_read_b64_tr_b16 v[48:49], v20 offset:4096
  ds_read_b64_tr_b16 v[50:51], v20 offset:4608
  v_mfma_f32_16x16x32_bf16 v[100:103], v[192:195], v[36:39], v[100:103]
  ds_read_b64_tr_b16 v[52:53], v21 offset:4096
  ds_read_b64_tr_b16 v[54:55], v21 offset:4608
  v_mfma_f32_16x16x32_bf16 v[104:107], v[192:195], v[40:43], v[104:107]
  ds_read_b64_tr_b16 v[56:57], v22 offset:4096
  ds_read_b64_tr_b16 v[58:59], v22 offset:4608
  v_mfma_f32_16x16x32_bf16 v[108:111], v[192:195], v[44:47], v[108:111]
  ds_read_b64_tr_b16 v[60:61], v23 offset:4096
  ds_read_b64_tr_b16 v[62:63], v23 offset:4608
  s_waitcnt lgkmcnt(0)
  s_waitcnt vmcnt(30)
  s_waitcnt vmcnt(8)
  ds_read_b128 a[128:131], v176 offset:0
  ds_read_b128 a[132:135], v177 offset:0
  ds_read_b128 a[136:139], v178 offset:0
  ds_read_b128 a[140:143], v179 offset:0
  ds_read_b128 a[144:147], v180 offset:0
  ds_read_b128 a[148:151], v181 offset:0
  ds_read_b128 a[152:155], v182 offset:0
  ds_read_b128 a[156:159], v183 offset:0
  v_mfma_f32_16x16x32_bf16 v[96:99], v[196:199], v[48:51], v[96:99]
  ds_read_b64_tr_b16 v[32:33], v20 offset:8192
  ds_read_b64_tr_b16 v[34:35], v20 offset:8704
  v_mfma_f32_16x16x32_bf16 v[100:103], v[196:199], v[52:55], v[100:103]
  ds_read_b64_tr_b16 v[36:37], v21 offset:8192
  ds_read_b64_tr_b16 v[38:39], v21 offset:8704
  v_mfma_f32_16x16x32_bf16 v[104:107], v[196:199], v[56:59], v[104:107]
  ds_read_b64_tr_b16 v[40:41], v22 offset:8192
  ds_read_b64_tr_b16 v[42:43], v22 offset:8704
  v_mfma_f32_16x16x32_bf16 v[108:111], v[196:199], v[60:63], v[108:111]
  ds_read_b64_tr_b16 v[44:45], v23 offset:8192
  ds_read_b64_tr_b16 v[46:47], v23 offset:8704
  s_waitcnt lgkmcnt(0)
  v_mfma_f32_16x16x32_bf16 v[96:99], v[200:203], v[32:35], v[96:99]
  ds_read_b64_tr_b16 v[48:49], v20 offset:12288
  ds_read_b64_tr_b16 v[50:51], v20 offset:12800
  v_mfma_f32_16x16x32_bf16 v[100:103], v[200:203], v[36:39], v[100:103]
  ds_read_b64_tr_b16 v[52:53], v21 offset:12288
  ds_read_b64_tr_b16 v[54:55], v21 offset:12800
  s_add_u32 s13, s73, 256
  s_add_u32 m0, s19, 65536
  s_nop 0
  buffer_load_dwordx4 v168, s[56:59], s13 offen offset:0 lds
  v_mfma_f32_16x16x32_bf16 v[104:107], v[200:203], v[40:43], v[104:107]
  ds_read_b64_tr_b16 v[56:57], v22 offset:12288
  ds_read_b64_tr_b16 v[58:59], v22 offset:12800
  v_mfma_f32_16x16x32_bf16 v[108:111], v[200:203], v[44:47], v[108:111]
  ds_read_b64_tr_b16 v[60:61], v23 offset:12288
  ds_read_b64_tr_b16 v[62:63], v23 offset:12800
  buffer_load_dwordx4 v169, s[56:59], s13 offen offset:1024 lds
  s_waitcnt lgkmcnt(0)
  s_waitcnt vmcnt(2)
  ds_read_b128 a[160:163], v176 offset:8192
  ds_read_b128 a[164:167], v177 offset:8192
  ds_read_b128 a[168:171], v178 offset:8192
  ds_read_b128 a[172:175], v179 offset:8192
  ds_read_b128 a[176:179], v180 offset:8192
  ds_read_b128 a[180:183], v181 offset:8192
  ds_read_b128 a[184:187], v182 offset:8192
  ds_read_b128 a[188:191], v183 offset:8192
  v_mfma_f32_16x16x32_bf16 v[96:99], v[204:207], v[48:51], v[96:99]
  ds_read_b64_tr_b16 v[32:33], v20 offset:16384
  ds_read_b64_tr_b16 v[34:35], v20 offset:16896
  v_mfma_f32_16x16x32_bf16 v[100:103], v[204:207], v[52:55], v[100:103]
  ds_read_b64_tr_b16 v[36:37], v21 offset:16384
  ds_read_b64_tr_b16 v[38:39], v21 offset:16896
  buffer_load_dwordx4 v170, s[56:59], s13 offen offset:2048 lds
  v_mfma_f32_16x16x32_bf16 v[104:107], v[204:207], v[56:59], v[104:107]
  ds_read_b64_tr_b16 v[40:41], v22 offset:16384
  ds_read_b64_tr_b16 v[42:43], v22 offset:16896
  v_mfma_f32_16x16x32_bf16 v[108:111], v[204:207], v[60:63], v[108:111]
  ds_read_b64_tr_b16 v[44:45], v23 offset:16384
  ds_read_b64_tr_b16 v[46:47], v23 offset:16896
  buffer_load_dwordx4 v171, s[56:59], s13 offen offset:3072 lds
  s_waitcnt lgkmcnt(0)
  v_mfma_f32_16x16x32_bf16 v[96:99], v[208:211], v[32:35], v[96:99]
  ds_read_b64_tr_b16 v[48:49], v20 offset:20480
  ds_read_b64_tr_b16 v[50:51], v20 offset:20992
  v_mfma_f32_16x16x32_bf16 v[100:103], v[208:211], v[36:39], v[100:103]
  ds_read_b64_tr_b16 v[52:53], v21 offset:20480
  ds_read_b64_tr_b16 v[54:55], v21 offset:20992
  s_add_u32 m0, s19, 69632
  s_nop 0
  buffer_load_dwordx4 v172, s[56:59], s13 offen offset:0 lds
  v_mfma_f32_16x16x32_bf16 v[104:107], v[208:211], v[40:43], v[104:107]
  ds_read_b64_tr_b16 v[56:57], v22 offset:20480
  ds_read_b64_tr_b16 v[58:59], v22 offset:20992
  v_mfma_f32_16x16x32_bf16 v[108:111], v[208:211], v[44:47], v[108:111]
  ds_read_b64_tr_b16 v[60:61], v23 offset:20480
  ds_read_b64_tr_b16 v[62:63], v23 offset:20992
  buffer_load_dwordx4 v173, s[56:59], s13 offen offset:1024 lds
  s_waitcnt lgkmcnt(0)
  v_mfma_f32_16x16x32_bf16 v[96:99], v[212:215], v[48:51], v[96:99]
  ds_read_b64_tr_b16 v[32:33], v20 offset:24576
  ds_read_b64_tr_b16 v[34:35], v20 offset:25088
  v_mfma_f32_16x16x32_bf16 v[100:103], v[212:215], v[52:55], v[100:103]
  ds_read_b64_tr_b16 v[36:37], v21 offset:24576
  ds_read_b64_tr_b16 v[38:39], v21 offset:25088
  buffer_load_dwordx4 v174, s[56:59], s13 offen offset:2048 lds
  v_mfma_f32_16x16x32_bf16 v[104:107], v[212:215], v[56:59], v[104:107]
  ds_read_b64_tr_b16 v[40:41], v22 offset:24576
  ds_read_b64_tr_b16 v[42:43], v22 offset:25088
  v_mfma_f32_16x16x32_bf16 v[108:111], v[212:215], v[60:63], v[108:111]
  ds_read_b64_tr_b16 v[44:45], v23 offset:24576
  ds_read_b64_tr_b16 v[46:47], v23 offset:25088
  buffer_load_dwordx4 v175, s[56:59], s13 offen offset:3072 lds
  s_add_u32 s13, s73, 384
  s_add_u32 m0, s19, 73728
  s_nop 0
  buffer_load_dwordx4 v168, s[56:59], s13 offen offset:0 lds
  buffer_load_dwordx4 v169, s[56:59], s13 offen offset:1024 lds
  buffer_load_dwordx4 v170, s[56:59], s13 offen offset:2048 lds
  buffer_load_dwordx4 v171, s[56:59], s13 offen offset:3072 lds
  s_add_u32 m0, s19, 77824
  s_nop 0
  buffer_load_dwordx4 v172, s[56:59], s13 offen offset:0 lds
  buffer_load_dwordx4 v173, s[56:59], s13 offen offset:1024 lds
  buffer_load_dwordx4 v174, s[56:59], s13 offen offset:2048 lds
  buffer_load_dwordx4 v175, s[56:59], s13 offen offset:3072 lds
G1_FIN:
  s_lshr_b32 s43, s20, 1
  s_lshl_b32 s43, s43, 5
  s_and_b32 s44, s20, 1
  s_lshl_b32 s44, s44, 2
  s_add_u32 s43, s43, s44
  s_lshl_b32 s44, s40, 6
  s_add_u32 s44, s44, s43
  s_lshl_b32 s45, s44, 7
  v_lshrrev_b32 v27, 2, v17
  v_lshlrev_b32 v27, 3, v27
  v_and_b32 v24, 3, v17
  v_add_u32 v12, v27, v24
  v_lshlrev_b32 v27, 5, v12
  v_lshl_add_u32 v27, v10, 3, v27
  s_lshl_b32 s17, s20, 11
  s_add_u32 s17, s17, 151552
  s_lshl_b32 s16, s43, 5
  v_add_u32 v27, s16, v27
  v_xor_b32 v188, 0, v27
  v_add_u32 v188, s17, v188
  v_xor_b32 v189, 128, v27
  v_add_u32 v189, s17, v189
  v_xor_b32 v190, 1024, v27
  v_add_u32 v190, s17, v190
  v_xor_b32 v191, 1152, v27
  v_add_u32 v191, s17, v191
  v_lshl_add_u32 v27, v10, 3, v13
  v_lshlrev_b32 v27, 5, v27
  v_and_b32 v24, 3, v1
  v_lshl_add_u32 v27, v24, 3, v27
  v_add_u32 v27, s17, v27
  s_waitcnt lgkmcnt(0)
  s_barrier
  ds_read_b64 v[148:149], v19 offset:2560
  v_xor_b32 v24, 128, v19
  ds_read_b64 v[150:151], v24 offset:2560
  v_xor_b32 v24, 256, v19
  ds_read_b64 v[152:153], v24 offset:2560
  v_xor_b32 v24, 384, v19
  ds_read_b64 v[154:155], v24 offset:2560
  s_waitcnt lgkmcnt(0)
  v_lshlrev_b32 v144, 16, v64
  v_and_b32 v145, 0xffff0000, v64
  v_lshlrev_b32 v146, 16, v65
  v_and_b32 v147, 0xffff0000, v65
  v_pk_fma_f32 v[144:145], v[144:145], v[148:149], v[148:149] op_sel:[0,0,1] op_sel_hi:[1,0,1]
  v_pk_fma_f32 v[146:147], v[146:147], v[148:149], v[148:149] op_sel:[0,0,1] op_sel_hi:[1,0,1]
  v_cvt_pk_bf16_f32 v64, v144, v145
  v_cvt_pk_bf16_f32 v65, v146, v147
  ds_write_b64 v188, v[64:65]
  v_lshlrev_b32 v144, 16, v68
  v_and_b32 v145, 0xffff0000, v68
  v_lshlrev_b32 v146, 16, v69
  v_and_b32 v147, 0xffff0000, v69
  v_pk_fma_f32 v[144:145], v[144:145], v[150:151], v[150:151] op_sel:[0,0,1] op_sel_hi:[1,0,1]
  v_pk_fma_f32 v[146:147], v[146:147], v[150:151], v[150:151] op_sel:[0,0,1] op_sel_hi:[1,0,1]
  v_cvt_pk_bf16_f32 v68, v144, v145
  v_cvt_pk_bf16_f32 v69, v146, v147
  ds_write_b64 v189, v[68:69]
  v_lshlrev_b32 v144, 16, v72
  v_and_b32 v145, 0xffff0000, v72
  v_lshlrev_b32 v146, 16, v73
  v_and_b32 v147, 0xffff0000, v73
  v_pk_fma_f32 v[144:145], v[144:145], v[152:153], v[152:153] op_sel:[0,0,1] op_sel_hi:[1,0,1]
  v_pk_fma_f32 v[146:147], v[146:147], v[152:153], v[152:153] op_sel:[0,0,1] op_sel_hi:[1,0,1]
  v_cvt_pk_bf16_f32 v72, v144, v145
  v_cvt_pk_bf16_f32 v73, v146, v147
  ds_write_b64 v190, v[72:73]
  v_lshlrev_b32 v144, 16, v76
  v_and_b32 v145, 0xffff0000, v76
  v_lshlrev_b32 v146, 16, v77
  v_and_b32 v147, 0xffff0000, v77
  v_pk_fma_f32 v[144:145], v[144:145], v[154:155], v[154:155] op_sel:[0,0,1] op_sel_hi:[1,0,1]
  v_pk_fma_f32 v[146:147], v[146:147], v[154:155], v[154:155] op_sel:[0,0,1] op_sel_hi:[1,0,1]
  v_cvt_pk_bf16_f32 v76, v144, v145
  v_cvt_pk_bf16_f32 v77, v146, v147
  ds_write_b64 v191, v[76:77]
  ds_read_b64_tr_b16 v[112:113], v27 offset:0
  ds_read_b64_tr_b16 v[114:115], v27 offset:128
  ds_read_b64_tr_b16 v[116:117], v27 offset:1024
  ds_read_b64_tr_b16 v[118:119], v27 offset:1152
  s_mul_i32 s16, s3, 88
  s_add_u32 s16, s16, s30
  s_lshl_b32 s16, s16, 10
  s_add_u32 s16, s16, 20926464
  s_add_u32 s23, s16, 45056
  s_waitcnt lgkmcnt(0)
  buffer_store_dwordx4 v[112:115], v8, s[24:27], s16 offen sc0 sc1
  buffer_store_dwordx4 v[116:119], v8, s[24:27], s23 offen sc0 sc1
  s_cmp_eq_u32 s33, 0
  s_cbranch_scc1 G1_ZD
  v_lshlrev_b32 v144, 16, v80
  v_and_b32 v145, 0xffff0000, v80
  v_lshlrev_b32 v146, 16, v81
  v_and_b32 v147, 0xffff0000, v81
  v_pk_fma_f32 v[144:145], v[144:145], v[148:149], v[148:149] op_sel:[0,0,1] op_sel_hi:[1,0,1]
  v_pk_fma_f32 v[146:147], v[146:147], v[148:149], v[148:149] op_sel:[0,0,1] op_sel_hi:[1,0,1]
  v_cvt_pk_bf16_f32 v80, v144, v145
  v_cvt_pk_bf16_f32 v81, v146, v147
  ds_write_b64 v188, v[80:81]
  v_lshlrev_b32 v144, 16, v84
  v_and_b32 v145, 0xffff0000, v84
  v_lshlrev_b32 v146, 16, v85
  v_and_b32 v147, 0xffff0000, v85
  v_pk_fma_f32 v[144:145], v[144:145], v[150:151], v[150:151] op_sel:[0,0,1] op_sel_hi:[1,0,1]
  v_pk_fma_f32 v[146:147], v[146:147], v[150:151], v[150:151] op_sel:[0,0,1] op_sel_hi:[1,0,1]
  v_cvt_pk_bf16_f32 v84, v144, v145
  v_cvt_pk_bf16_f32 v85, v146, v147
  ds_write_b64 v189, v[84:85]
  v_lshlrev_b32 v144, 16, v88
  v_and_b32 v145, 0xffff0000, v88
  v_lshlrev_b32 v146, 16, v89
  v_and_b32 v147, 0xffff0000, v89
  v_pk_fma_f32 v[144:145], v[144:145], v[152:153], v[152:153] op_sel:[0,0,1] op_sel_hi:[1,0,1]
  v_pk_fma_f32 v[146:147], v[146:147], v[152:153], v[152:153] op_sel:[0,0,1] op_sel_hi:[1,0,1]
  v_cvt_pk_bf16_f32 v88, v144, v145
  v_cvt_pk_bf16_f32 v89, v146, v147
  ds_write_b64 v190, v[88:89]
  v_lshlrev_b32 v144, 16, v92
  v_and_b32 v145, 0xffff0000, v92
  v_lshlrev_b32 v146, 16, v93
  v_and_b32 v147, 0xffff0000, v93
  v_pk_fma_f32 v[144:145], v[144:145], v[154:155], v[154:155] op_sel:[0,0,1] op_sel_hi:[1,0,1]
  v_pk_fma_f32 v[146:147], v[146:147], v[154:155], v[154:155] op_sel:[0,0,1] op_sel_hi:[1,0,1]
  v_cvt_pk_bf16_f32 v92, v144, v145
  v_cvt_pk_bf16_f32 v93, v146, v147
  ds_write_b64 v191, v[92:93]
  ds_read_b64_tr_b16 v[120:121], v27 offset:0
  ds_read_b64_tr_b16 v[122:123], v27 offset:128
  ds_read_b64_tr_b16 v[124:125], v27 offset:1024
  ds_read_b64_tr_b16 v[126:127], v27 offset:1152
  s_mul_i32 s16, s3, 88
  s_add_u32 s16, s16, s31
  s_lshl_b32 s16, s16, 10
  s_add_u32 s16, s16, 20926464
  s_add_u32 s23, s16, 45056
  s_waitcnt lgkmcnt(0)
  buffer_store_dwordx4 v[120:123], v8, s[24:27], s16 offen sc0 sc1
  buffer_store_dwordx4 v[124:127], v8, s[24:27], s23 offen sc0 sc1
G1_ZD:
  s_lshl_b32 s46, s3, 7
  s_lshl_b32 s47, s40, 2
  s_add_u32 s47, s47, s46
  s_add_u32 s47, s47, 49152
  s_add_u32 s46, s46, 49152
  s_lshr_b32 s48, s3, 3
  s_lshl_b32 s48, s48, 1
  s_add_u32 s48, s48, s4
  s_lshl_b32 s48, s48, 8
  s_add_u32 s48, s48, 53248
  v_mov_b32 v2, 1
  v_mov_b32 v3, 0
  s_cmp_eq_u32 s20, 3
  s_cbranch_scc1 G1_S3
  v_mfma_f32_16x16x32_bf16 v[96:99], v[216:219], v[32:35], v[96:99]
  ds_read_b64_tr_b16 v[48:49], v20 offset:28672
  ds_read_b64_tr_b16 v[50:51], v20 offset:29184
  v_mfma_f32_16x16x32_bf16 v[100:103], v[216:219], v[36:39], v[100:103]
  ds_read_b64_tr_b16 v[52:53], v21 offset:28672
  ds_read_b64_tr_b16 v[54:55], v21 offset:29184
  v_mfma_f32_16x16x32_bf16 v[104:107], v[216:219], v[40:43], v[104:107]
  ds_read_b64_tr_b16 v[56:57], v22 offset:28672
  ds_read_b64_tr_b16 v[58:59], v22 offset:29184
  v_mfma_f32_16x16x32_bf16 v[108:111], v[216:219], v[44:47], v[108:111]
  ds_read_b64_tr_b16 v[60:61], v23 offset:28672
  ds_read_b64_tr_b16 v[62:63], v23 offset:29184
  s_waitcnt lgkmcnt(0)
  v_mfma_f32_16x16x32_bf16 v[96:99], v[220:223], v[48:51], v[96:99]
  ds_read_b64_tr_b16 v[32:33], v20 offset:32768
  ds_read_b64_tr_b16 v[34:35], v20 offset:33280
  v_mfma_f32_16x16x32_bf16 v[100:103], v[220:223], v[52:55], v[100:103]
  ds_read_b64_tr_b16 v[36:37], v21 offset:32768
  ds_read_b64_tr_b16 v[38:39], v21 offset:33280
  v_mfma_f32_16x16x32_bf16 v[104:107], v[220:223], v[56:59], v[104:107]
  ds_read_b64_tr_b16 v[40:41], v22 offset:32768
  ds_read_b64_tr_b16 v[42:43], v22 offset:33280
  v_mfma_f32_16x16x32_bf16 v[108:111], v[220:223], v[60:63], v[108:111]
  ds_read_b64_tr_b16 v[44:45], v23 offset:32768
  ds_read_b64_tr_b16 v[46:47], v23 offset:33280
  s_waitcnt lgkmcnt(0)
  v_mfma_f32_16x16x32_bf16 v[96:99], v[224:227], v[32:35], v[96:99]
  ds_read_b64_tr_b16 v[48:49], v20 offset:36864
  ds_read_b64_tr_b16 v[50:51], v20 offset:37376
  v_mfma_f32_16x16x32_bf16 v[100:103], v[224:227], v[36:39], v[100:103]
  ds_read_b64_tr_b16 v[52:53], v21 offset:36864
  ds_read_b64_tr_b16 v[54:55], v21 offset:37376
  v_mfma_f32_16x16x32_bf16 v[104:107], v[224:227], v[40:43], v[104:107]
  ds_read_b64_tr_b16 v[56:57], v22 offset:36864
  ds_read_b64_tr_b16 v[58:59], v22 offset:37376
  v_mfma_f32_16x16x32_bf16 v[108:111], v[224:227], v[44:47], v[108:111]
  ds_read_b64_tr_b16 v[60:61], v23 offset:36864
  ds_read_b64_tr_b16 v[62:63], v23 offset:37376
  s_waitcnt lgkmcnt(0)
  v_mfma_f32_16x16x32_bf16 v[96:99], v[228:231], v[48:51], v[96:99]
  ds_read_b64_tr_b16 v[32:33], v20 offset:40960
  ds_read_b64_tr_b16 v[34:35], v20 offset:41472
  v_mfma_f32_16x16x32_bf16 v[100:103], v[228:231], v[52:55], v[100:103]
  ds_read_b64_tr_b16 v[36:37], v21 offset:40960
  ds_read_b64_tr_b16 v[38:39], v21 offset:41472
  v_mfma_f32_16x16x32_bf16 v[104:107], v[228:231], v[56:59], v[104:107]
  ds_read_b64_tr_b16 v[40:41], v22 offset:40960
  ds_read_b64_tr_b16 v[42:43], v22 offset:41472
  v_mfma_f32_16x16x32_bf16 v[108:111], v[228:231], v[60:63], v[108:111]
  ds_read_b64_tr_b16 v[44:45], v23 offset:40960
  ds_read_b64_tr_b16 v[46:47], v23 offset:41472
  s_waitcnt vmcnt(0) lgkmcnt(0)
  s_barrier
  ds_read_b128 a[192:195], v176 offset:0
  ds_read_b128 a[196:199], v177 offset:0
  ds_read_b128 a[200:203], v178 offset:0
  ds_read_b128 a[204:207], v179 offset:0
  ds_read_b128 a[208:211], v180 offset:0
  ds_read_b128 a[212:215], v181 offset:0
  ds_read_b128 a[216:219], v182 offset:0
  ds_read_b128 a[220:223], v183 offset:0
  v_mfma_f32_16x16x32_bf16 v[96:99], v[232:235], v[32:35], v[96:99]
  ds_read_b64_tr_b16 v[48:49], v20 offset:45056
  ds_read_b64_tr_b16 v[50:51], v20 offset:45568
  v_mfma_f32_16x16x32_bf16 v[100:103], v[232:235], v[36:39], v[100:103]
  ds_read_b64_tr_b16 v[52:53], v21 offset:45056
  ds_read_b64_tr_b16 v[54:55], v21 offset:45568
  v_mfma_f32_16x16x32_bf16 v[104:107], v[232:235], v[40:43], v[104:107]
  ds_read_b64_tr_b16 v[56:57], v22 offset:45056
  ds_read_b64_tr_b16 v[58:59], v22 offset:45568
  v_mfma_f32_16x16x32_bf16 v[108:111], v[232:235], v[44:47], v[108:111]
  ds_read_b64_tr_b16 v[60:61], v23 offset:45056
  ds_read_b64_tr_b16 v[62:63], v23 offset:45568
  s_waitcnt lgkmcnt(0)
  ds_read_b128 a[224:227], v176 offset:8192
  ds_read_b128 a[228:231], v177 offset:8192
  ds_read_b128 a[232:235], v178 offset:8192
  ds_read_b128 a[236:239], v179 offset:8192
  ds_read_b128 a[240:243], v180 offset:8192
  ds_read_b128 a[244:247], v181 offset:8192
  ds_read_b128 a[248:251], v182 offset:8192
  ds_read_b128 a[252:255], v183 offset:8192
  v_mfma_f32_16x16x32_bf16 v[96:99], v[236:239], v[48:51], v[96:99]
  ds_read_b64_tr_b16 v[32:33], v20 offset:49152
  ds_read_b64_tr_b16 v[34:35], v20 offset:49664
  v_mfma_f32_16x16x32_bf16 v[100:103], v[236:239], v[52:55], v[100:103]
  ds_read_b64_tr_b16 v[36:37], v21 offset:49152
  ds_read_b64_tr_b16 v[38:39], v21 offset:49664
  s_add_u32 s13, s73, 512
  s_add_u32 m0, s19, 65536
  s_nop 0
  buffer_load_dwordx4 v168, s[56:59], s13 offen offset:0 lds
  v_mfma_f32_16x16x32_bf16 v[104:107], v[236:239], v[56:59], v[104:107]
  ds_read_b64_tr_b16 v[40:41], v22 offset:49152
  ds_read_b64_tr_b16 v[42:43], v22 offset:49664
  v_mfma_f32_16x16x32_bf16 v[108:111], v[236:239], v[60:63], v[108:111]
  ds_read_b64_tr_b16 v[44:45], v23 offset:49152
  ds_read_b64_tr_b16 v[46:47], v23 offset:49664
  buffer_load_dwordx4 v169, s[56:59], s13 offen offset:1024 lds
  s_waitcnt lgkmcnt(0)
  v_mfma_f32_16x16x32_bf16 v[96:99], v[240:243], v[32:35], v[96:99]
  ds_read_b64_tr_b16 v[48:49], v20 offset:53248
  ds_read_b64_tr_b16 v[50:51], v20 offset:53760
  v_mfma_f32_16x16x32_bf16 v[100:103], v[240:243], v[36:39], v[100:103]
  ds_read_b64_tr_b16 v[52:53], v21 offset:53248
  ds_read_b64_tr_b16 v[54:55], v21 offset:53760
  buffer_load_dwordx4 v170, s[56:59], s13 offen offset:2048 lds
  v_mfma_f32_16x16x32_bf16 v[104:107], v[240:243], v[40:43], v[104:107]
  ds_read_b64_tr_b16 v[56:57], v22 offset:53248
  ds_read_b64_tr_b16 v[58:59], v22 offset:53760
  v_mfma_f32_16x16x32_bf16 v[108:111], v[240:243], v[44:47], v[108:111]
  ds_read_b64_tr_b16 v[60:61], v23 offset:53248
  ds_read_b64_tr_b16 v[62:63], v23 offset:53760
  buffer_load_dwordx4 v171, s[56:59], s13 offen offset:3072 lds
  s_waitcnt lgkmcnt(0)
  v_mfma_f32_16x16x32_bf16 v[96:99], v[244:247], v[48:51], v[96:99]
  ds_read_b64_tr_b16 v[32:33], v20 offset:57344
  ds_read_b64_tr_b16 v[34:35], v20 offset:57856
  v_mfma_f32_16x16x32_bf16 v[100:103], v[244:247], v[52:55], v[100:103]
  ds_read_b64_tr_b16 v[36:37], v21 offset:57344
  ds_read_b64_tr_b16 v[38:39], v21 offset:57856
  s_add_u32 m0, s19, 69632
  s_nop 0
  buffer_load_dwordx4 v172, s[56:59], s13 offen offset:0 lds
  v_mfma_f32_16x16x32_bf16 v[104:107], v[244:247], v[56:59], v[104:107]
  ds_read_b64_tr_b16 v[40:41], v22 offset:57344
  ds_read_b64_tr_b16 v[42:43], v22 offset:57856
  v_mfma_f32_16x16x32_bf16 v[108:111], v[244:247], v[60:63], v[108:111]
  ds_read_b64_tr_b16 v[44:45], v23 offset:57344
  ds_read_b64_tr_b16 v[46:47], v23 offset:57856
  buffer_load_dwordx4 v173, s[56:59], s13 offen offset:1024 lds
  s_waitcnt lgkmcnt(0)
  v_mfma_f32_16x16x32_bf16 v[96:99], v[248:251], v[32:35], v[96:99]
  ds_read_b64_tr_b16 v[48:49], v20 offset:61440
  ds_read_b64_tr_b16 v[50:51], v20 offset:61952
  v_mfma_f32_16x16x32_bf16 v[100:103], v[248:251], v[36:39], v[100:103]
  ds_read_b64_tr_b16 v[52:53], v21 offset:61440
  ds_read_b64_tr_b16 v[54:55], v21 offset:61952
  buffer_load_dwordx4 v174, s[56:59], s13 offen offset:2048 lds
  v_mfma_f32_16x16x32_bf16 v[104:107], v[248:251], v[40:43], v[104:107]
  ds_read_b64_tr_b16 v[56:57], v22 offset:61440
  ds_read_b64_tr_b16 v[58:59], v22 offset:61952
  v_mfma_f32_16x16x32_bf16 v[108:111], v[248:251], v[44:47], v[108:111]
  ds_read_b64_tr_b16 v[60:61], v23 offset:61440
  ds_read_b64_tr_b16 v[62:63], v23 offset:61952
  buffer_load_dwordx4 v175, s[56:59], s13 offen offset:3072 lds
  s_waitcnt lgkmcnt(0)
  v_mfma_f32_16x16x32_bf16 v[96:99], v[252:255], v[48:51], v[96:99]
  v_mfma_f32_16x16x32_bf16 v[100:103], v[252:255], v[52:55], v[100:103]
  s_add_u32 s13, s73, 640
  s_add_u32 m0, s19, 73728
  s_nop 0
  buffer_load_dwordx4 v168, s[56:59], s13 offen offset:0 lds
  v_mfma_f32_16x16x32_bf16 v[104:107], v[252:255], v[56:59], v[104:107]
  v_mfma_f32_16x16x32_bf16 v[108:111], v[252:255], v[60:63], v[108:111]
  buffer_load_dwordx4 v169, s[56:59], s13 offen offset:1024 lds
  buffer_load_dwordx4 v170, s[56:59], s13 offen offset:2048 lds
  buffer_load_dwordx4 v171, s[56:59], s13 offen offset:3072 lds
  s_add_u32 m0, s19, 77824
  s_nop 0
  buffer_load_dwordx4 v172, s[56:59], s13 offen offset:0 lds
  buffer_load_dwordx4 v173, s[56:59], s13 offen offset:1024 lds
  buffer_load_dwordx4 v174, s[56:59], s13 offen offset:2048 lds
  buffer_load_dwordx4 v175, s[56:59], s13 offen offset:3072 lds
  v_pk_fma_f32 v[144:145], v[128:129], v[136:137], v[132:133] op_sel:[0,1,0] op_sel_hi:[1,1,1] neg_lo:[0,1,0] neg_hi:[0,1,0]
  v_pk_fma_f32 v[146:147], v[130:131], v[136:137], v[134:135] op_sel:[0,1,0] op_sel_hi:[1,1,1] neg_lo:[0,1,0] neg_hi:[0,1,0]
  v_pk_fma_f32 v[96:97], v[96:97], v[136:137], v[144:145] op_sel_hi:[1,0,1]
  v_pk_fma_f32 v[98:99], v[98:99], v[136:137], v[146:147] op_sel_hi:[1,0,1]
  v_pk_mul_f32 v[144:145], v[96:97], v[96:97]
  v_pk_mul_f32 v[146:147], v[98:99], v[98:99]
  v_pk_fma_f32 v[144:145], v[144:145], s[18:19], v[30:31] op_sel_hi:[1,0,1]
  v_pk_fma_f32 v[146:147], v[146:147], s[18:19], v[30:31] op_sel_hi:[1,0,1]
  v_pk_mul_f32 v[144:145], v[144:145], v[96:97]
  v_pk_mul_f32 v[146:147], v[146:147], v[98:99]
  v_exp_f32 v144, v144
  v_exp_f32 v146, v146
  v_exp_f32 v145, v145
  v_exp_f32 v147, v147
  v_pk_add_f32 v[144:145], v[144:145], 1.0 op_sel_hi:[1,0]
  v_pk_add_f32 v[146:147], v[146:147], 1.0 op_sel_hi:[1,0]
  v_rcp_f32 v144, v144
  v_rcp_f32 v146, v146
  v_rcp_f32 v145, v145
  v_rcp_f32 v147, v147
  v_pk_mul_f32 v[96:97], v[96:97], v[144:145]
  v_pk_mul_f32 v[98:99], v[98:99], v[146:147]
  v_cvt_pk_bf16_f32 v96, v96, v97
  v_cvt_pk_bf16_f32 v97, v98, v99
  v_pk_fma_f32 v[144:145], v[128:129], v[138:139], v[132:133] op_sel:[0,1,0] op_sel_hi:[1,1,1] neg_lo:[0,1,0] neg_hi:[0,1,0]
  v_pk_fma_f32 v[146:147], v[130:131], v[138:139], v[134:135] op_sel:[0,1,0] op_sel_hi:[1,1,1] neg_lo:[0,1,0] neg_hi:[0,1,0]
  v_pk_fma_f32 v[100:101], v[100:101], v[138:139], v[144:145] op_sel_hi:[1,0,1]
  v_pk_fma_f32 v[102:103], v[102:103], v[138:139], v[146:147] op_sel_hi:[1,0,1]
  v_pk_mul_f32 v[144:145], v[100:101], v[100:101]
  v_pk_mul_f32 v[146:147], v[102:103], v[102:103]
  v_pk_fma_f32 v[144:145], v[144:145], s[18:19], v[30:31] op_sel_hi:[1,0,1]
  v_pk_fma_f32 v[146:147], v[146:147], s[18:19], v[30:31] op_sel_hi:[1,0,1]
  v_pk_mul_f32 v[144:145], v[144:145], v[100:101]
  v_pk_mul_f32 v[146:147], v[146:147], v[102:103]
  v_exp_f32 v144, v144
  v_exp_f32 v146, v146
  v_exp_f32 v145, v145
  v_exp_f32 v147, v147
  v_pk_add_f32 v[144:145], v[144:145], 1.0 op_sel_hi:[1,0]
  v_pk_add_f32 v[146:147], v[146:147], 1.0 op_sel_hi:[1,0]
  v_rcp_f32 v144, v144
  v_rcp_f32 v146, v146
  v_rcp_f32 v145, v145
  v_rcp_f32 v147, v147
  v_pk_mul_f32 v[100:101], v[100:101], v[144:145]
  v_pk_mul_f32 v[102:103], v[102:103], v[146:147]
  v_cvt_pk_bf16_f32 v100, v100, v101
  v_cvt_pk_bf16_f32 v101, v102, v103
  v_pk_fma_f32 v[144:145], v[128:129], v[140:141], v[132:133] op_sel:[0,1,0] op_sel_hi:[1,1,1] neg_lo:[0,1,0] neg_hi:[0,1,0]
  v_pk_fma_f32 v[146:147], v[130:131], v[140:141], v[134:135] op_sel:[0,1,0] op_sel_hi:[1,1,1] neg_lo:[0,1,0] neg_hi:[0,1,0]
  v_pk_fma_f32 v[104:105], v[104:105], v[140:141], v[144:145] op_sel_hi:[1,0,1]
  v_pk_fma_f32 v[106:107], v[106:107], v[140:141], v[146:147] op_sel_hi:[1,0,1]
  v_pk_mul_f32 v[144:145], v[104:105], v[104:105]
  v_pk_mul_f32 v[146:147], v[106:107], v[106:107]
  v_pk_fma_f32 v[144:145], v[144:145], s[18:19], v[30:31] op_sel_hi:[1,0,1]
  v_pk_fma_f32 v[146:147], v[146:147], s[18:19], v[30:31] op_sel_hi:[1,0,1]
  v_pk_mul_f32 v[144:145], v[144:145], v[104:105]
  v_pk_mul_f32 v[146:147], v[146:147], v[106:107]
  v_exp_f32 v144, v144
  v_exp_f32 v146, v146
  v_exp_f32 v145, v145
  v_exp_f32 v147, v147
  v_pk_add_f32 v[144:145], v[144:145], 1.0 op_sel_hi:[1,0]
  v_pk_add_f32 v[146:147], v[146:147], 1.0 op_sel_hi:[1,0]
  v_rcp_f32 v144, v144
  v_rcp_f32 v146, v146
  v_rcp_f32 v145, v145
  v_rcp_f32 v147, v147
  v_pk_mul_f32 v[104:105], v[104:105], v[144:145]
  v_pk_mul_f32 v[106:107], v[106:107], v[146:147]
  v_cvt_pk_bf16_f32 v104, v104, v105
  v_cvt_pk_bf16_f32 v105, v106, v107
  v_pk_fma_f32 v[144:145], v[128:129], v[142:143], v[132:133] op_sel:[0,1,0] op_sel_hi:[1,1,1] neg_lo:[0,1,0] neg_hi:[0,1,0]
  v_pk_fma_f32 v[146:147], v[130:131], v[142:143], v[134:135] op_sel:[0,1,0] op_sel_hi:[1,1,1] neg_lo:[0,1,0] neg_hi:[0,1,0]
  v_pk_fma_f32 v[108:109], v[108:109], v[142:143], v[144:145] op_sel_hi:[1,0,1]
  v_pk_fma_f32 v[110:111], v[110:111], v[142:143], v[146:147] op_sel_hi:[1,0,1]
  v_pk_mul_f32 v[144:145], v[108:109], v[108:109]
  v_pk_mul_f32 v[146:147], v[110:111], v[110:111]
  v_pk_fma_f32 v[144:145], v[144:145], s[18:19], v[30:31] op_sel_hi:[1,0,1]
  v_pk_fma_f32 v[146:147], v[146:147], s[18:19], v[30:31] op_sel_hi:[1,0,1]
  v_pk_mul_f32 v[144:145], v[144:145], v[108:109]
  v_pk_mul_f32 v[146:147], v[146:147], v[110:111]
  v_exp_f32 v144, v144
  v_exp_f32 v146, v146
  v_exp_f32 v145, v145
  v_exp_f32 v147, v147
  v_pk_add_f32 v[144:145], v[144:145], 1.0 op_sel_hi:[1,0]
  v_pk_add_f32 v[146:147], v[146:147], 1.0 op_sel_hi:[1,0]
  v_rcp_f32 v144, v144
  v_rcp_f32 v146, v146
  v_rcp_f32 v145, v145
  v_rcp_f32 v147, v147
  v_pk_mul_f32 v[108:109], v[108:109], v[144:145]
  v_pk_mul_f32 v[110:111], v[110:111], v[146:147]
  v_cvt_pk_bf16_f32 v108, v108, v109
  v_cvt_pk_bf16_f32 v109, v110, v111
  ds_write_b64 v184, v[96:97] offset:10240
  ds_write_b64 v185, v[100:101] offset:10240
  ds_write_b64 v186, v[104:105] offset:10240
  ds_write_b64 v187, v[108:109] offset:10240
  s_branch G1_NS
G1_S3:
  s_waitcnt vmcnt(0)
  s_barrier
  s_mov_b64 exec, 1
  buffer_atomic_add v2, v3, s[24:27], s48 offen sc0 sc1
  s_mov_b64 exec, -1
  ds_read_b128 a[192:195], v176 offset:0
  ds_read_b128 a[196:199], v177 offset:0
  ds_read_b128 a[200:203], v178 offset:0
  ds_read_b128 a[204:207], v179 offset:0
  ds_read_b128 a[208:211], v180 offset:0
  ds_read_b128 a[212:215], v181 offset:0
  ds_read_b128 a[216:219], v182 offset:0
  ds_read_b128 a[220:223], v183 offset:0
  ds_read_b128 a[224:227], v176 offset:8192
  ds_read_b128 a[228:231], v177 offset:8192
  ds_read_b128 a[232:235], v178 offset:8192
  ds_read_b128 a[236:239], v179 offset:8192
  ds_read_b128 a[240:243], v180 offset:8192
  ds_read_b128 a[244:247], v181 offset:8192
  ds_read_b128 a[248:251], v182 offset:8192
  ds_read_b128 a[252:255], v183 offset:8192
  s_waitcnt vmcnt(0) lgkmcnt(0)
  s_mov_b64 exec, 1
  v_cmp_eq_u32 vcc, 31, v2
  s_cbranch_vccz G1_S4
  v_mov_b32 v2, 1
  buffer_store_dword v2, v3, s[24:27], s48 offen offset:128 sc0 sc1
G1_S4:
  s_mov_b64 exec, -1
  s_waitcnt lgkmcnt(0)
  s_add_u32 s13, s73, 512
  s_add_u32 m0, s19, 65536
  s_nop 0
  buffer_load_dwordx4 v168, s[56:59], s13 offen offset:0 lds
  buffer_load_dwordx4 v169, s[56:59], s13 offen offset:1024 lds
  buffer_load_dwordx4 v170, s[56:59], s13 offen offset:2048 lds
  buffer_load_dwordx4 v171, s[56:59], s13 offen offset:3072 lds
  s_add_u32 m0, s19, 69632
  s_nop 0
  buffer_load_dwordx4 v172, s[56:59], s13 offen offset:0 lds
  buffer_load_dwordx4 v173, s[56:59], s13 offen offset:1024 lds
  buffer_load_dwordx4 v174, s[56:59], s13 offen offset:2048 lds
  buffer_load_dwordx4 v175, s[56:59], s13 offen offset:3072 lds
  s_add_u32 s13, s73, 640
  s_add_u32 m0, s19, 73728
  s_nop 0
  buffer_load_dwordx4 v168, s[56:59], s13 offen offset:0 lds
  buffer_load_dwordx4 v169, s[56:59], s13 offen offset:1024 lds
  buffer_load_dwordx4 v170, s[56:59], s13 offen offset:2048 lds
  buffer_load_dwordx4 v171, s[56:59], s13 offen offset:3072 lds
  s_add_u32 m0, s19, 77824
  s_nop 0
  buffer_load_dwordx4 v172, s[56:59], s13 offen offset:0 lds
  buffer_load_dwordx4 v173, s[56:59], s13 offen offset:1024 lds
  buffer_load_dwordx4 v174, s[56:59], s13 offen offset:2048 lds
  buffer_load_dwordx4 v175, s[56:59], s13 offen offset:3072 lds
G1_NS:
  v_add_u32 v16, s45, v16
  ds_read_b64_tr_b16 v[20:21], v16
  v_xor_b32 v15, 32, v16
  ds_read_b64_tr_b16 v[22:23], v15
  v_xor_b32 v15, 64, v16
  ds_read_b64_tr_b16 v[24:25], v15
  v_xor_b32 v15, 96, v16
  ds_read_b64_tr_b16 v[26:27], v15
  s_waitcnt lgkmcnt(0)
  s_barrier
  s_add_u32 s13, s73, 768
  s_add_u32 m0, s19, 0
  s_nop 0
  buffer_load_dwordx4 v168, s[56:59], s13 offen offset:0 lds
  buffer_load_dwordx4 v169, s[56:59], s13 offen offset:1024 lds
  buffer_load_dwordx4 v170, s[56:59], s13 offen offset:2048 lds
  buffer_load_dwordx4 v171, s[56:59], s13 offen offset:3072 lds
  s_add_u32 m0, s19, 4096
  s_nop 0
  buffer_load_dwordx4 v172, s[56:59], s13 offen offset:0 lds
  buffer_load_dwordx4 v173, s[56:59], s13 offen offset:1024 lds
  buffer_load_dwordx4 v174, s[56:59], s13 offen offset:2048 lds
  buffer_load_dwordx4 v175, s[56:59], s13 offen offset:3072 lds
  s_add_u32 s13, s73, 896
  s_add_u32 m0, s19, 8192
  s_nop 0
  buffer_load_dwordx4 v168, s[56:59], s13 offen offset:0 lds
  buffer_load_dwordx4 v169, s[56:59], s13 offen offset:1024 lds
  buffer_load_dwordx4 v170, s[56:59], s13 offen offset:2048 lds
  buffer_load_dwordx4 v171, s[56:59], s13 offen offset:3072 lds
  s_add_u32 m0, s19, 12288
  s_nop 0
  buffer_load_dwordx4 v172, s[56:59], s13 offen offset:0 lds
  buffer_load_dwordx4 v173, s[56:59], s13 offen offset:1024 lds
  buffer_load_dwordx4 v174, s[56:59], s13 offen offset:2048 lds
  buffer_load_dwordx4 v175, s[56:59], s13 offen offset:3072 lds
  s_waitcnt vmcnt(16)
  ds_read_b128 a[0:3], v176 offset:0
  ds_read_b128 a[4:7], v177 offset:0
  ds_read_b128 a[8:11], v178 offset:0
  ds_read_b128 a[12:15], v179 offset:0
  ds_read_b128 a[16:19], v180 offset:0
  ds_read_b128 a[20:23], v181 offset:0
  ds_read_b128 a[24:27], v182 offset:0
  ds_read_b128 a[28:31], v183 offset:0
  ds_read_b128 a[32:35], v176 offset:8192
  ds_read_b128 a[36:39], v177 offset:8192
  ds_read_b128 a[40:43], v178 offset:8192
  ds_read_b128 a[44:47], v179 offset:8192
  ds_read_b128 a[48:51], v180 offset:8192
  ds_read_b128 a[52:55], v181 offset:8192
  ds_read_b128 a[56:59], v182 offset:8192
  ds_read_b128 a[60:63], v183 offset:8192
  v_subrev_u32 v176, 65536, v176
  v_subrev_u32 v177, 65536, v177
  v_subrev_u32 v178, 65536, v178
  v_subrev_u32 v179, 65536, v179
  v_subrev_u32 v180, 65536, v180
  v_subrev_u32 v181, 65536, v181
  v_subrev_u32 v182, 65536, v182
  v_subrev_u32 v183, 65536, v183
  s_movk_i32 s9, 4096
  s_cmp_ge_u32 s5, 3
  s_cselect_b32 s9, 0x7f000000, s9
  v_add_u32 v9, s9, v8
  s_mul_i32 s8, s4, 22
  s_mul_i32 s10, s5, 6
  s_add_u32 s8, s8, s10
  s_mul_i32 s7, s20, 704
  s_add_u32 s7, s7, s8
  s_lshl_b32 s7, s7, 10
  s_add_u32 s7, s7, 20971520
  v_add_u32 v11, s43, v12
  v_lshlrev_b32 v11, 1, v11
  s_lshl_b32 s41, s40, 2
  s_add_u32 s41, s41, s20
  s_mul_i32 s41, s41, 24576
  s_add_u32 s41, s41, 14680064
  s_lshl_b32 s18, s3, 7
  v_lshlrev_b32 v13, 5, v10
  s_lshl_b32 s49, s44, 2
  s_add_u32 s49, s49, 10240
  v_mov_b32 v2, 0
  s_lshl_b32 s50, s20, 9
  s_lshl_b32 s51, s4, 8
  s_add_u32 s50, s50, s51
  s_add_u32 s50, s50, 53376
  s_mov_b32 s53, 0
  s_mov_b64 exec, 1
G2_P1:
  buffer_load_dword v3, v2, s[24:27], s50 offen sc1
  s_add_u32 s53, s53, 1
  s_waitcnt vmcnt(0)
  v_cmp_ne_u32 vcc, 1, v3
  s_cmp_gt_u32 s53, 400000
  s_cbranch_scc1 G2_G1
  s_cbranch_vccnz G2_P1
G2_G1:
  s_mov_b64 exec, -1
  ds_read_b128 a[64:67], v176 offset:0
  ds_read_b128 a[68:71], v177 offset:0
  ds_read_b128 a[72:75], v178 offset:0
  ds_read_b128 a[76:79], v179 offset:0
  ds_read_b128 a[80:83], v180 offset:0
  ds_read_b128 a[84:87], v181 offset:0
  ds_read_b128 a[88:91], v182 offset:0
  ds_read_b128 a[92:95], v183 offset:0
  ds_read_b128 a[96:99], v176 offset:8192
  ds_read_b128 a[100:103], v177 offset:8192
  ds_read_b128 a[104:107], v178 offset:8192
  ds_read_b128 a[108:111], v179 offset:8192
  ds_read_b128 a[112:115], v180 offset:8192
  ds_read_b128 a[116:119], v181 offset:8192
  ds_read_b128 a[120:123], v182 offset:8192
  ds_read_b128 a[124:127], v183 offset:8192
  s_add_u32 s12, s7, 0
  buffer_load_dwordx4 v[184:187], v8, s[24:27], s12 offen offset:0 sc0 sc1
  buffer_load_dwordx4 v[188:191], v8, s[24:27], s12 offen offset:1024 sc0 sc1
  buffer_load_dwordx4 v[192:195], v8, s[24:27], s12 offen offset:2048 sc0 sc1
  buffer_load_dwordx4 v[196:199], v8, s[24:27], s12 offen offset:3072 sc0 sc1
  buffer_load_dwordx4 v[200:203], v9, s[24:27], s12 offen offset:0 sc0 sc1
  buffer_load_dwordx4 v[204:207], v9, s[24:27], s12 offen offset:1024 sc0 sc1
  s_add_u32 s12, s7, 45056
  buffer_load_dwordx4 v[208:211], v8, s[24:27], s12 offen offset:0 sc0 sc1
  buffer_load_dwordx4 v[212:215], v8, s[24:27], s12 offen offset:1024 sc0 sc1
  buffer_load_dwordx4 v[216:219], v8, s[24:27], s12 offen offset:2048 sc0 sc1
  buffer_load_dwordx4 v[220:223], v8, s[24:27], s12 offen offset:3072 sc0 sc1
  buffer_load_dwordx4 v[224:227], v9, s[24:27], s12 offen offset:0 sc0 sc1
  buffer_load_dwordx4 v[228:231], v9, s[24:27], s12 offen offset:1024 sc0 sc1
  s_add_u32 s12, s7, 90112
  buffer_load_dwordx4 v[232:235], v8, s[24:27], s12 offen offset:0 sc0 sc1
  buffer_load_dwordx4 v[236:239], v8, s[24:27], s12 offen offset:1024 sc0 sc1
  buffer_load_dwordx4 v[240:243], v8, s[24:27], s12 offen offset:2048 sc0 sc1
  buffer_load_dwordx4 v[244:247], v8, s[24:27], s12 offen offset:3072 sc0 sc1
  buffer_load_dwordx4 v[248:251], v9, s[24:27], s12 offen offset:0 sc0 sc1
  buffer_load_dwordx4 v[252:255], v9, s[24:27], s12 offen offset:1024 sc0 sc1
  s_add_u32 s12, s7, 135168
  buffer_load_dwordx4 v[32:35], v8, s[24:27], s12 offen offset:0 sc0 sc1
  buffer_load_dwordx4 v[36:39], v8, s[24:27], s12 offen offset:1024 sc0 sc1
  buffer_load_dwordx4 v[40:43], v8, s[24:27], s12 offen offset:2048 sc0 sc1
  buffer_load_dwordx4 v[44:47], v8, s[24:27], s12 offen offset:3072 sc0 sc1
  buffer_load_dwordx4 v[48:51], v9, s[24:27], s12 offen offset:0 sc0 sc1
  buffer_load_dwordx4 v[52:55], v9, s[24:27], s12 offen offset:1024 sc0 sc1
  s_add_u32 s12, s7, 180224
  buffer_load_dwordx4 v[160:163], v8, s[24:27], s12 offen offset:0 sc0 sc1
  buffer_load_dwordx4 v[164:167], v8, s[24:27], s12 offen offset:1024 sc0 sc1
  buffer_load_dwordx4 v[168:171], v8, s[24:27], s12 offen offset:2048 sc0 sc1
  buffer_load_dwordx4 v[172:175], v8, s[24:27], s12 offen offset:3072 sc0 sc1
  buffer_load_dwordx4 v[176:179], v9, s[24:27], s12 offen offset:0 sc0 sc1
  buffer_load_dwordx4 v[180:183], v9, s[24:27], s12 offen offset:1024 sc0 sc1
  s_waitcnt lgkmcnt(0)
  s_waitcnt vmcnt(24)
  v_mfma_f32_16x16x32_bf16 v[64:67], v[184:187], a[128:131], 0
  v_mfma_f32_16x16x32_bf16 v[68:71], v[188:191], a[128:131], 0
  v_mfma_f32_16x16x32_bf16 v[72:75], v[192:195], a[128:131], 0
  v_mfma_f32_16x16x32_bf16 v[76:79], v[196:199], a[128:131], 0
  v_mfma_f32_16x16x32_bf16 v[80:83], v[200:203], a[128:131], 0
  v_mfma_f32_16x16x32_bf16 v[84:87], v[204:207], a[128:131], 0
  v_mfma_f32_16x16x32_bf16 v[88:91], v[184:187], a[132:135], 0
  v_mfma_f32_16x16x32_bf16 v[92:95], v[188:191], a[132:135], 0
  v_mfma_f32_16x16x32_bf16 v[96:99], v[192:195], a[132:135], 0
  v_mfma_f32_16x16x32_bf16 v[100:103], v[196:199], a[132:135], 0
  v_mfma_f32_16x16x32_bf16 v[104:107], v[200:203], a[132:135], 0
  v_mfma_f32_16x16x32_bf16 v[108:111], v[204:207], a[132:135], 0
  v_mfma_f32_16x16x32_bf16 v[112:115], v[184:187], a[136:139], 0
  v_mfma_f32_16x16x32_bf16 v[116:119], v[188:191], a[136:139], 0
  v_mfma_f32_16x16x32_bf16 v[120:123], v[192:195], a[136:139], 0
  v_mfma_f32_16x16x32_bf16 v[124:127], v[196:199], a[136:139], 0
  v_mfma_f32_16x16x32_bf16 v[128:131], v[200:203], a[136:139], 0
  v_mfma_f32_16x16x32_bf16 v[132:135], v[204:207], a[136:139], 0
  v_mfma_f32_16x16x32_bf16 v[136:139], v[184:187], a[140:143], 0
  v_mfma_f32_16x16x32_bf16 v[140:143], v[188:191], a[140:143], 0
  v_mfma_f32_16x16x32_bf16 v[144:147], v[192:195], a[140:143], 0
  v_mfma_f32_16x16x32_bf16 v[148:151], v[196:199], a[140:143], 0
  v_mfma_f32_16x16x32_bf16 v[152:155], v[200:203], a[140:143], 0
  v_mfma_f32_16x16x32_bf16 v[156:159], v[204:207], a[140:143], 0
  s_waitcnt vmcnt(18)
  v_mfma_f32_16x16x32_bf16 v[64:67], v[208:211], a[144:147], v[64:67]
  v_mfma_f32_16x16x32_bf16 v[68:71], v[212:215], a[144:147], v[68:71]
  v_mfma_f32_16x16x32_bf16 v[72:75], v[216:219], a[144:147], v[72:75]
  s_add_u32 s12, s7, 225280
  buffer_load_dwordx4 v[184:187], v8, s[24:27], s12 offen offset:0 sc0 sc1
  v_mfma_f32_16x16x32_bf16 v[76:79], v[220:223], a[144:147], v[76:79]
  v_mfma_f32_16x16x32_bf16 v[80:83], v[224:227], a[144:147], v[80:83]
  v_mfma_f32_16x16x32_bf16 v[84:87], v[228:231], a[144:147], v[84:87]
  buffer_load_dwordx4 v[188:191], v8, s[24:27], s12 offen offset:1024 sc0 sc1
  v_mfma_f32_16x16x32_bf16 v[88:91], v[208:211], a[148:151], v[88:91]
  v_mfma_f32_16x16x32_bf16 v[92:95], v[212:215], a[148:151], v[92:95]
  v_mfma_f32_16x16x32_bf16 v[96:99], v[216:219], a[148:151], v[96:99]
  buffer_load_dwordx4 v[192:195], v8, s[24:27], s12 offen offset:2048 sc0 sc1
  v_mfma_f32_16x16x32_bf16 v[100:103], v[220:223], a[148:151], v[100:103]
  v_mfma_f32_16x16x32_bf16 v[104:107], v[224:227], a[148:151], v[104:107]
  v_mfma_f32_16x16x32_bf16 v[108:111], v[228:231], a[148:151], v[108:111]
  buffer_load_dwordx4 v[196:199], v8, s[24:27], s12 offen offset:3072 sc0 sc1
  v_mfma_f32_16x16x32_bf16 v[112:115], v[208:211], a[152:155], v[112:115]
  v_mfma_f32_16x16x32_bf16 v[116:119], v[212:215], a[152:155], v[116:119]
  v_mfma_f32_16x16x32_bf16 v[120:123], v[216:219], a[152:155], v[120:123]
  buffer_load_dwordx4 v[200:203], v9, s[24:27], s12 offen offset:0 sc0 sc1
  v_mfma_f32_16x16x32_bf16 v[124:127], v[220:223], a[152:155], v[124:127]
  v_mfma_f32_16x16x32_bf16 v[128:131], v[224:227], a[152:155], v[128:131]
  v_mfma_f32_16x16x32_bf16 v[132:135], v[228:231], a[152:155], v[132:135]
  buffer_load_dwordx4 v[204:207], v9, s[24:27], s12 offen offset:1024 sc0 sc1
  v_mfma_f32_16x16x32_bf16 v[136:139], v[208:211], a[156:159], v[136:139]
  v_mfma_f32_16x16x32_bf16 v[140:143], v[212:215], a[156:159], v[140:143]
  v_mfma_f32_16x16x32_bf16 v[144:147], v[216:219], a[156:159], v[144:147]
  v_mfma_f32_16x16x32_bf16 v[148:151], v[220:223], a[156:159], v[148:151]
  v_mfma_f32_16x16x32_bf16 v[152:155], v[224:227], a[156:159], v[152:155]
  v_mfma_f32_16x16x32_bf16 v[156:159], v[228:231], a[156:159], v[156:159]
  s_waitcnt vmcnt(18)
  v_mfma_f32_16x16x32_bf16 v[64:67], v[232:235], a[160:163], v[64:67]
  v_mfma_f32_16x16x32_bf16 v[68:71], v[236:239], a[160:163], v[68:71]
  v_mfma_f32_16x16x32_bf16 v[72:75], v[240:243], a[160:163], v[72:75]
  s_add_u32 s12, s7, 270336
  buffer_load_dwordx4 v[208:211], v8, s[24:27], s12 offen offset:0 sc0 sc1
  v_mfma_f32_16x16x32_bf16 v[76:79], v[244:247], a[160:163], v[76:79]
  v_mfma_f32_16x16x32_bf16 v[80:83], v[248:251], a[160:163], v[80:83]
  v_mfma_f32_16x16x32_bf16 v[84:87], v[252:255], a[160:163], v[84:87]
  buffer_load_dwordx4 v[212:215], v8, s[24:27], s12 offen offset:1024 sc0 sc1
  v_mfma_f32_16x16x32_bf16 v[88:91], v[232:235], a[164:167], v[88:91]
  v_mfma_f32_16x16x32_bf16 v[92:95], v[236:239], a[164:167], v[92:95]
  v_mfma_f32_16x16x32_bf16 v[96:99], v[240:243], a[164:167], v[96:99]
  buffer_load_dwordx4 v[216:219], v8, s[24:27], s12 offen offset:2048 sc0 sc1
  v_mfma_f32_16x16x32_bf16 v[100:103], v[244:247], a[164:167], v[100:103]
  v_mfma_f32_16x16x32_bf16 v[104:107], v[248:251], a[164:167], v[104:107]
  v_mfma_f32_16x16x32_bf16 v[108:111], v[252:255], a[164:167], v[108:111]
  buffer_load_dwordx4 v[220:223], v8, s[24:27], s12 offen offset:3072 sc0 sc1
  v_mfma_f32_16x16x32_bf16 v[112:115], v[232:235], a[168:171], v[112:115]
  v_mfma_f32_16x16x32_bf16 v[116:119], v[236:239], a[168:171], v[116:119]
  v_mfma_f32_16x16x32_bf16 v[120:123], v[240:243], a[168:171], v[120:123]
  buffer_load_dwordx4 v[224:227], v9, s[24:27], s12 offen offset:0 sc0 sc1
  v_mfma_f32_16x16x32_bf16 v[124:127], v[244:247], a[168:171], v[124:127]
  v_mfma_f32_16x16x32_bf16 v[128:131], v[248:251], a[168:171], v[128:131]
  v_mfma_f32_16x16x32_bf16 v[132:135], v[252:255], a[168:171], v[132:135]
  buffer_load_dwordx4 v[228:231], v9, s[24:27], s12 offen offset:1024 sc0 sc1
  v_mfma_f32_16x16x32_bf16 v[136:139], v[232:235], a[172:175], v[136:139]
  v_mfma_f32_16x16x32_bf16 v[140:143], v[236:239], a[172:175], v[140:143]
  v_mfma_f32_16x16x32_bf16 v[144:147], v[240:243], a[172:175], v[144:147]
  v_mfma_f32_16x16x32_bf16 v[148:151], v[244:247], a[172:175], v[148:151]
  v_mfma_f32_16x16x32_bf16 v[152:155], v[248:251], a[172:175], v[152:155]
  v_mfma_f32_16x16x32_bf16 v[156:159], v[252:255], a[172:175], v[156:159]
  s_waitcnt vmcnt(18)
  v_mfma_f32_16x16x32_bf16 v[64:67], v[32:35], a[176:179], v[64:67]
  v_mfma_f32_16x16x32_bf16 v[68:71], v[36:39], a[176:179], v[68:71]
  v_mfma_f32_16x16x32_bf16 v[72:75], v[40:43], a[176:179], v[72:75]
  s_add_u32 s12, s7, 315392
  buffer_load_dwordx4 v[232:235], v8, s[24:27], s12 offen offset:0 sc0 sc1
  v_mfma_f32_16x16x32_bf16 v[76:79], v[44:47], a[176:179], v[76:79]
  v_mfma_f32_16x16x32_bf16 v[80:83], v[48:51], a[176:179], v[80:83]
  v_mfma_f32_16x16x32_bf16 v[84:87], v[52:55], a[176:179], v[84:87]
  buffer_load_dwordx4 v[236:239], v8, s[24:27], s12 offen offset:1024 sc0 sc1
  v_mfma_f32_16x16x32_bf16 v[88:91], v[32:35], a[180:183], v[88:91]
  v_mfma_f32_16x16x32_bf16 v[92:95], v[36:39], a[180:183], v[92:95]
  v_mfma_f32_16x16x32_bf16 v[96:99], v[40:43], a[180:183], v[96:99]
  buffer_load_dwordx4 v[240:243], v8, s[24:27], s12 offen offset:2048 sc0 sc1
  v_mfma_f32_16x16x32_bf16 v[100:103], v[44:47], a[180:183], v[100:103]
  v_mfma_f32_16x16x32_bf16 v[104:107], v[48:51], a[180:183], v[104:107]
  v_mfma_f32_16x16x32_bf16 v[108:111], v[52:55], a[180:183], v[108:111]
  buffer_load_dwordx4 v[244:247], v8, s[24:27], s12 offen offset:3072 sc0 sc1
  v_mfma_f32_16x16x32_bf16 v[112:115], v[32:35], a[184:187], v[112:115]
  v_mfma_f32_16x16x32_bf16 v[116:119], v[36:39], a[184:187], v[116:119]
  v_mfma_f32_16x16x32_bf16 v[120:123], v[40:43], a[184:187], v[120:123]
  buffer_load_dwordx4 v[248:251], v9, s[24:27], s12 offen offset:0 sc0 sc1
  v_mfma_f32_16x16x32_bf16 v[124:127], v[44:47], a[184:187], v[124:127]
  v_mfma_f32_16x16x32_bf16 v[128:131], v[48:51], a[184:187], v[128:131]
  v_mfma_f32_16x16x32_bf16 v[132:135], v[52:55], a[184:187], v[132:135]
  buffer_load_dwordx4 v[252:255], v9, s[24:27], s12 offen offset:1024 sc0 sc1
  v_mfma_f32_16x16x32_bf16 v[136:139], v[32:35], a[188:191], v[136:139]
  v_mfma_f32_16x16x32_bf16 v[140:143], v[36:39], a[188:191], v[140:143]
  v_mfma_f32_16x16x32_bf16 v[144:147], v[40:43], a[188:191], v[144:147]
  v_mfma_f32_16x16x32_bf16 v[148:151], v[44:47], a[188:191], v[148:151]
  v_mfma_f32_16x16x32_bf16 v[152:155], v[48:51], a[188:191], v[152:155]
  v_mfma_f32_16x16x32_bf16 v[156:159], v[52:55], a[188:191], v[156:159]
  s_waitcnt vmcnt(18)
  v_mfma_f32_16x16x32_bf16 v[64:67], v[160:163], a[192:195], v[64:67]
  v_mfma_f32_16x16x32_bf16 v[68:71], v[164:167], a[192:195], v[68:71]
  v_mfma_f32_16x16x32_bf16 v[72:75], v[168:171], a[192:195], v[72:75]
  s_add_u32 s12, s7, 360448
  buffer_load_dwordx4 v[32:35], v8, s[24:27], s12 offen offset:0 sc0 sc1
  v_mfma_f32_16x16x32_bf16 v[76:79], v[172:175], a[192:195], v[76:79]
  v_mfma_f32_16x16x32_bf16 v[80:83], v[176:179], a[192:195], v[80:83]
  v_mfma_f32_16x16x32_bf16 v[84:87], v[180:183], a[192:195], v[84:87]
  buffer_load_dwordx4 v[36:39], v8, s[24:27], s12 offen offset:1024 sc0 sc1
  v_mfma_f32_16x16x32_bf16 v[88:91], v[160:163], a[196:199], v[88:91]
  v_mfma_f32_16x16x32_bf16 v[92:95], v[164:167], a[196:199], v[92:95]
  v_mfma_f32_16x16x32_bf16 v[96:99], v[168:171], a[196:199], v[96:99]
  buffer_load_dwordx4 v[40:43], v8, s[24:27], s12 offen offset:2048 sc0 sc1
  v_mfma_f32_16x16x32_bf16 v[100:103], v[172:175], a[196:199], v[100:103]
  v_mfma_f32_16x16x32_bf16 v[104:107], v[176:179], a[196:199], v[104:107]
  v_mfma_f32_16x16x32_bf16 v[108:111], v[180:183], a[196:199], v[108:111]
  buffer_load_dwordx4 v[44:47], v8, s[24:27], s12 offen offset:3072 sc0 sc1
  v_mfma_f32_16x16x32_bf16 v[112:115], v[160:163], a[200:203], v[112:115]
  v_mfma_f32_16x16x32_bf16 v[116:119], v[164:167], a[200:203], v[116:119]
  v_mfma_f32_16x16x32_bf16 v[120:123], v[168:171], a[200:203], v[120:123]
  buffer_load_dwordx4 v[48:51], v9, s[24:27], s12 offen offset:0 sc0 sc1
  v_mfma_f32_16x16x32_bf16 v[124:127], v[172:175], a[200:203], v[124:127]
  v_mfma_f32_16x16x32_bf16 v[128:131], v[176:179], a[200:203], v[128:131]
  v_mfma_f32_16x16x32_bf16 v[132:135], v[180:183], a[200:203], v[132:135]
  buffer_load_dwordx4 v[52:55], v9, s[24:27], s12 offen offset:1024 sc0 sc1
  v_mfma_f32_16x16x32_bf16 v[136:139], v[160:163], a[204:207], v[136:139]
  v_mfma_f32_16x16x32_bf16 v[140:143], v[164:167], a[204:207], v[140:143]
  v_mfma_f32_16x16x32_bf16 v[144:147], v[168:171], a[204:207], v[144:147]
  v_mfma_f32_16x16x32_bf16 v[148:151], v[172:175], a[204:207], v[148:151]
  v_mfma_f32_16x16x32_bf16 v[152:155], v[176:179], a[204:207], v[152:155]
  v_mfma_f32_16x16x32_bf16 v[156:159], v[180:183], a[204:207], v[156:159]
  s_waitcnt vmcnt(18)
  v_mfma_f32_16x16x32_bf16 v[64:67], v[184:187], a[208:211], v[64:67]
  v_mfma_f32_16x16x32_bf16 v[68:71], v[188:191], a[208:211], v[68:71]
  v_mfma_f32_16x16x32_bf16 v[72:75], v[192:195], a[208:211], v[72:75]
  s_add_u32 s12, s7, 405504
  buffer_load_dwordx4 v[160:163], v8, s[24:27], s12 offen offset:0 sc0 sc1
  v_mfma_f32_16x16x32_bf16 v[76:79], v[196:199], a[208:211], v[76:79]
  v_mfma_f32_16x16x32_bf16 v[80:83], v[200:203], a[208:211], v[80:83]
  v_mfma_f32_16x16x32_bf16 v[84:87], v[204:207], a[208:211], v[84:87]
  buffer_load_dwordx4 v[164:167], v8, s[24:27], s12 offen offset:1024 sc0 sc1
  v_mfma_f32_16x16x32_bf16 v[88:91], v[184:187], a[212:215], v[88:91]
  v_mfma_f32_16x16x32_bf16 v[92:95], v[188:191], a[212:215], v[92:95]
  v_mfma_f32_16x16x32_bf16 v[96:99], v[192:195], a[212:215], v[96:99]
  buffer_load_dwordx4 v[168:171], v8, s[24:27], s12 offen offset:2048 sc0 sc1
  v_mfma_f32_16x16x32_bf16 v[100:103], v[196:199], a[212:215], v[100:103]
  v_mfma_f32_16x16x32_bf16 v[104:107], v[200:203], a[212:215], v[104:107]
  v_mfma_f32_16x16x32_bf16 v[108:111], v[204:207], a[212:215], v[108:111]
  buffer_load_dwordx4 v[172:175], v8, s[24:27], s12 offen offset:3072 sc0 sc1
  v_mfma_f32_16x16x32_bf16 v[112:115], v[184:187], a[216:219], v[112:115]
  v_mfma_f32_16x16x32_bf16 v[116:119], v[188:191], a[216:219], v[116:119]
  v_mfma_f32_16x16x32_bf16 v[120:123], v[192:195], a[216:219], v[120:123]
  buffer_load_dwordx4 v[176:179], v9, s[24:27], s12 offen offset:0 sc0 sc1
  v_mfma_f32_16x16x32_bf16 v[124:127], v[196:199], a[216:219], v[124:127]
  v_mfma_f32_16x16x32_bf16 v[128:131], v[200:203], a[216:219], v[128:131]
  v_mfma_f32_16x16x32_bf16 v[132:135], v[204:207], a[216:219], v[132:135]
  buffer_load_dwordx4 v[180:183], v9, s[24:27], s12 offen offset:1024 sc0 sc1
  v_mfma_f32_16x16x32_bf16 v[136:139], v[184:187], a[220:223], v[136:139]
  v_mfma_f32_16x16x32_bf16 v[140:143], v[188:191], a[220:223], v[140:143]
  v_mfma_f32_16x16x32_bf16 v[144:147], v[192:195], a[220:223], v[144:147]
  v_mfma_f32_16x16x32_bf16 v[148:151], v[196:199], a[220:223], v[148:151]
  v_mfma_f32_16x16x32_bf16 v[152:155], v[200:203], a[220:223], v[152:155]
  v_mfma_f32_16x16x32_bf16 v[156:159], v[204:207], a[220:223], v[156:159]
  s_waitcnt vmcnt(18)
  v_mfma_f32_16x16x32_bf16 v[64:67], v[208:211], a[224:227], v[64:67]
  v_mfma_f32_16x16x32_bf16 v[68:71], v[212:215], a[224:227], v[68:71]
  v_mfma_f32_16x16x32_bf16 v[72:75], v[216:219], a[224:227], v[72:75]
  s_add_u32 s12, s7, 450560
  buffer_load_dwordx4 v[184:187], v8, s[24:27], s12 offen offset:0 sc0 sc1
  v_mfma_f32_16x16x32_bf16 v[76:79], v[220:223], a[224:227], v[76:79]
  v_mfma_f32_16x16x32_bf16 v[80:83], v[224:227], a[224:227], v[80:83]
  v_mfma_f32_16x16x32_bf16 v[84:87], v[228:231], a[224:227], v[84:87]
  buffer_load_dwordx4 v[188:191], v8, s[24:27], s12 offen offset:1024 sc0 sc1
  v_mfma_f32_16x16x32_bf16 v[88:91], v[208:211], a[228:231], v[88:91]
  v_mfma_f32_16x16x32_bf16 v[92:95], v[212:215], a[228:231], v[92:95]
  v_mfma_f32_16x16x32_bf16 v[96:99], v[216:219], a[228:231], v[96:99]
  buffer_load_dwordx4 v[192:195], v8, s[24:27], s12 offen offset:2048 sc0 sc1
  v_mfma_f32_16x16x32_bf16 v[100:103], v[220:223], a[228:231], v[100:103]
  v_mfma_f32_16x16x32_bf16 v[104:107], v[224:227], a[228:231], v[104:107]
  v_mfma_f32_16x16x32_bf16 v[108:111], v[228:231], a[228:231], v[108:111]
  buffer_load_dwordx4 v[196:199], v8, s[24:27], s12 offen offset:3072 sc0 sc1
  v_mfma_f32_16x16x32_bf16 v[112:115], v[208:211], a[232:235], v[112:115]
  v_mfma_f32_16x16x32_bf16 v[116:119], v[212:215], a[232:235], v[116:119]
  v_mfma_f32_16x16x32_bf16 v[120:123], v[216:219], a[232:235], v[120:123]
  buffer_load_dwordx4 v[200:203], v9, s[24:27], s12 offen offset:0 sc0 sc1
  v_mfma_f32_16x16x32_bf16 v[124:127], v[220:223], a[232:235], v[124:127]
  v_mfma_f32_16x16x32_bf16 v[128:131], v[224:227], a[232:235], v[128:131]
  v_mfma_f32_16x16x32_bf16 v[132:135], v[228:231], a[232:235], v[132:135]
  buffer_load_dwordx4 v[204:207], v9, s[24:27], s12 offen offset:1024 sc0 sc1
  v_mfma_f32_16x16x32_bf16 v[136:139], v[208:211], a[236:239], v[136:139]
  v_mfma_f32_16x16x32_bf16 v[140:143], v[212:215], a[236:239], v[140:143]
  v_mfma_f32_16x16x32_bf16 v[144:147], v[216:219], a[236:239], v[144:147]
  v_mfma_f32_16x16x32_bf16 v[148:151], v[220:223], a[236:239], v[148:151]
  v_mfma_f32_16x16x32_bf16 v[152:155], v[224:227], a[236:239], v[152:155]
  v_mfma_f32_16x16x32_bf16 v[156:159], v[228:231], a[236:239], v[156:159]
  s_waitcnt vmcnt(18)
  v_mfma_f32_16x16x32_bf16 v[64:67], v[232:235], a[240:243], v[64:67]
  v_mfma_f32_16x16x32_bf16 v[68:71], v[236:239], a[240:243], v[68:71]
  v_mfma_f32_16x16x32_bf16 v[72:75], v[240:243], a[240:243], v[72:75]
  s_add_u32 s12, s7, 495616
  buffer_load_dwordx4 v[208:211], v8, s[24:27], s12 offen offset:0 sc0 sc1
  v_mfma_f32_16x16x32_bf16 v[76:79], v[244:247], a[240:243], v[76:79]
  v_mfma_f32_16x16x32_bf16 v[80:83], v[248:251], a[240:243], v[80:83]
  v_mfma_f32_16x16x32_bf16 v[84:87], v[252:255], a[240:243], v[84:87]
  buffer_load_dwordx4 v[212:215], v8, s[24:27], s12 offen offset:1024 sc0 sc1
  v_mfma_f32_16x16x32_bf16 v[88:91], v[232:235], a[244:247], v[88:91]
  v_mfma_f32_16x16x32_bf16 v[92:95], v[236:239], a[244:247], v[92:95]
  v_mfma_f32_16x16x32_bf16 v[96:99], v[240:243], a[244:247], v[96:99]
  buffer_load_dwordx4 v[216:219], v8, s[24:27], s12 offen offset:2048 sc0 sc1
  v_mfma_f32_16x16x32_bf16 v[100:103], v[244:247], a[244:247], v[100:103]
  v_mfma_f32_16x16x32_bf16 v[104:107], v[248:251], a[244:247], v[104:107]
  v_mfma_f32_16x16x32_bf16 v[108:111], v[252:255], a[244:247], v[108:111]
  buffer_load_dwordx4 v[220:223], v8, s[24:27], s12 offen offset:3072 sc0 sc1
  v_mfma_f32_16x16x32_bf16 v[112:115], v[232:235], a[248:251], v[112:115]
  v_mfma_f32_16x16x32_bf16 v[116:119], v[236:239], a[248:251], v[116:119]
  v_mfma_f32_16x16x32_bf16 v[120:123], v[240:243], a[248:251], v[120:123]
  buffer_load_dwordx4 v[224:227], v9, s[24:27], s12 offen offset:0 sc0 sc1
  v_mfma_f32_16x16x32_bf16 v[124:127], v[244:247], a[248:251], v[124:127]
  v_mfma_f32_16x16x32_bf16 v[128:131], v[248:251], a[248:251], v[128:131]
  v_mfma_f32_16x16x32_bf16 v[132:135], v[252:255], a[248:251], v[132:135]
  buffer_load_dwordx4 v[228:231], v9, s[24:27], s12 offen offset:1024 sc0 sc1
  v_mfma_f32_16x16x32_bf16 v[136:139], v[232:235], a[252:255], v[136:139]
  v_mfma_f32_16x16x32_bf16 v[140:143], v[236:239], a[252:255], v[140:143]
  v_mfma_f32_16x16x32_bf16 v[144:147], v[240:243], a[252:255], v[144:147]
  v_mfma_f32_16x16x32_bf16 v[148:151], v[244:247], a[252:255], v[148:151]
  v_mfma_f32_16x16x32_bf16 v[152:155], v[248:251], a[252:255], v[152:155]
  v_mfma_f32_16x16x32_bf16 v[156:159], v[252:255], a[252:255], v[156:159]
  s_waitcnt vmcnt(18)
  v_mfma_f32_16x16x32_bf16 v[64:67], v[32:35], a[0:3], v[64:67]
  v_mfma_f32_16x16x32_bf16 v[68:71], v[36:39], a[0:3], v[68:71]
  v_mfma_f32_16x16x32_bf16 v[72:75], v[40:43], a[0:3], v[72:75]
  s_add_u32 s12, s7, 540672
  buffer_load_dwordx4 v[232:235], v8, s[24:27], s12 offen offset:0 sc0 sc1
  v_mfma_f32_16x16x32_bf16 v[76:79], v[44:47], a[0:3], v[76:79]
  v_mfma_f32_16x16x32_bf16 v[80:83], v[48:51], a[0:3], v[80:83]
  v_mfma_f32_16x16x32_bf16 v[84:87], v[52:55], a[0:3], v[84:87]
  buffer_load_dwordx4 v[236:239], v8, s[24:27], s12 offen offset:1024 sc0 sc1
  v_mfma_f32_16x16x32_bf16 v[88:91], v[32:35], a[4:7], v[88:91]
  v_mfma_f32_16x16x32_bf16 v[92:95], v[36:39], a[4:7], v[92:95]
  v_mfma_f32_16x16x32_bf16 v[96:99], v[40:43], a[4:7], v[96:99]
  buffer_load_dwordx4 v[240:243], v8, s[24:27], s12 offen offset:2048 sc0 sc1
  v_mfma_f32_16x16x32_bf16 v[100:103], v[44:47], a[4:7], v[100:103]
  v_mfma_f32_16x16x32_bf16 v[104:107], v[48:51], a[4:7], v[104:107]
  v_mfma_f32_16x16x32_bf16 v[108:111], v[52:55], a[4:7], v[108:111]
  buffer_load_dwordx4 v[244:247], v8, s[24:27], s12 offen offset:3072 sc0 sc1
  v_mfma_f32_16x16x32_bf16 v[112:115], v[32:35], a[8:11], v[112:115]
  v_mfma_f32_16x16x32_bf16 v[116:119], v[36:39], a[8:11], v[116:119]
  v_mfma_f32_16x16x32_bf16 v[120:123], v[40:43], a[8:11], v[120:123]
  buffer_load_dwordx4 v[248:251], v9, s[24:27], s12 offen offset:0 sc0 sc1
  v_mfma_f32_16x16x32_bf16 v[124:127], v[44:47], a[8:11], v[124:127]
  v_mfma_f32_16x16x32_bf16 v[128:131], v[48:51], a[8:11], v[128:131]
  v_mfma_f32_16x16x32_bf16 v[132:135], v[52:55], a[8:11], v[132:135]
  buffer_load_dwordx4 v[252:255], v9, s[24:27], s12 offen offset:1024 sc0 sc1
  v_mfma_f32_16x16x32_bf16 v[136:139], v[32:35], a[12:15], v[136:139]
  v_mfma_f32_16x16x32_bf16 v[140:143], v[36:39], a[12:15], v[140:143]
  v_mfma_f32_16x16x32_bf16 v[144:147], v[40:43], a[12:15], v[144:147]
  v_mfma_f32_16x16x32_bf16 v[148:151], v[44:47], a[12:15], v[148:151]
  v_mfma_f32_16x16x32_bf16 v[152:155], v[48:51], a[12:15], v[152:155]
  v_mfma_f32_16x16x32_bf16 v[156:159], v[52:55], a[12:15], v[156:159]
  s_waitcnt vmcnt(18)
  v_mfma_f32_16x16x32_bf16 v[64:67], v[160:163], a[16:19], v[64:67]
  v_mfma_f32_16x16x32_bf16 v[68:71], v[164:167], a[16:19], v[68:71]
  v_mfma_f32_16x16x32_bf16 v[72:75], v[168:171], a[16:19], v[72:75]
  s_add_u32 s12, s7, 585728
  buffer_load_dwordx4 v[32:35], v8, s[24:27], s12 offen offset:0 sc0 sc1
  v_mfma_f32_16x16x32_bf16 v[76:79], v[172:175], a[16:19], v[76:79]
  v_mfma_f32_16x16x32_bf16 v[80:83], v[176:179], a[16:19], v[80:83]
  v_mfma_f32_16x16x32_bf16 v[84:87], v[180:183], a[16:19], v[84:87]
  buffer_load_dwordx4 v[36:39], v8, s[24:27], s12 offen offset:1024 sc0 sc1
  v_mfma_f32_16x16x32_bf16 v[88:91], v[160:163], a[20:23], v[88:91]
  v_mfma_f32_16x16x32_bf16 v[92:95], v[164:167], a[20:23], v[92:95]
  v_mfma_f32_16x16x32_bf16 v[96:99], v[168:171], a[20:23], v[96:99]
  buffer_load_dwordx4 v[40:43], v8, s[24:27], s12 offen offset:2048 sc0 sc1
  v_mfma_f32_16x16x32_bf16 v[100:103], v[172:175], a[20:23], v[100:103]
  v_mfma_f32_16x16x32_bf16 v[104:107], v[176:179], a[20:23], v[104:107]
  v_mfma_f32_16x16x32_bf16 v[108:111], v[180:183], a[20:23], v[108:111]
  buffer_load_dwordx4 v[44:47], v8, s[24:27], s12 offen offset:3072 sc0 sc1
  v_mfma_f32_16x16x32_bf16 v[112:115], v[160:163], a[24:27], v[112:115]
  v_mfma_f32_16x16x32_bf16 v[116:119], v[164:167], a[24:27], v[116:119]
  v_mfma_f32_16x16x32_bf16 v[120:123], v[168:171], a[24:27], v[120:123]
  buffer_load_dwordx4 v[48:51], v9, s[24:27], s12 offen offset:0 sc0 sc1
  v_mfma_f32_16x16x32_bf16 v[124:127], v[172:175], a[24:27], v[124:127]
  v_mfma_f32_16x16x32_bf16 v[128:131], v[176:179], a[24:27], v[128:131]
  v_mfma_f32_16x16x32_bf16 v[132:135], v[180:183], a[24:27], v[132:135]
  buffer_load_dwordx4 v[52:55], v9, s[24:27], s12 offen offset:1024 sc0 sc1
  v_mfma_f32_16x16x32_bf16 v[136:139], v[160:163], a[28:31], v[136:139]
  v_mfma_f32_16x16x32_bf16 v[140:143], v[164:167], a[28:31], v[140:143]
  v_mfma_f32_16x16x32_bf16 v[144:147], v[168:171], a[28:31], v[144:147]
  v_mfma_f32_16x16x32_bf16 v[148:151], v[172:175], a[28:31], v[148:151]
  v_mfma_f32_16x16x32_bf16 v[152:155], v[176:179], a[28:31], v[152:155]
  v_mfma_f32_16x16x32_bf16 v[156:159], v[180:183], a[28:31], v[156:159]
  s_waitcnt vmcnt(18)
  v_mfma_f32_16x16x32_bf16 v[64:67], v[184:187], a[32:35], v[64:67]
  v_mfma_f32_16x16x32_bf16 v[68:71], v[188:191], a[32:35], v[68:71]
  v_mfma_f32_16x16x32_bf16 v[72:75], v[192:195], a[32:35], v[72:75]
  s_add_u32 s12, s7, 630784
  buffer_load_dwordx4 v[160:163], v8, s[24:27], s12 offen offset:0 sc0 sc1
  v_mfma_f32_16x16x32_bf16 v[76:79], v[196:199], a[32:35], v[76:79]
  v_mfma_f32_16x16x32_bf16 v[80:83], v[200:203], a[32:35], v[80:83]
  v_mfma_f32_16x16x32_bf16 v[84:87], v[204:207], a[32:35], v[84:87]
  buffer_load_dwordx4 v[164:167], v8, s[24:27], s12 offen offset:1024 sc0 sc1
  v_mfma_f32_16x16x32_bf16 v[88:91], v[184:187], a[36:39], v[88:91]
  v_mfma_f32_16x16x32_bf16 v[92:95], v[188:191], a[36:39], v[92:95]
  v_mfma_f32_16x16x32_bf16 v[96:99], v[192:195], a[36:39], v[96:99]
  buffer_load_dwordx4 v[168:171], v8, s[24:27], s12 offen offset:2048 sc0 sc1
  v_mfma_f32_16x16x32_bf16 v[100:103], v[196:199], a[36:39], v[100:103]
  v_mfma_f32_16x16x32_bf16 v[104:107], v[200:203], a[36:39], v[104:107]
  v_mfma_f32_16x16x32_bf16 v[108:111], v[204:207], a[36:39], v[108:111]
  buffer_load_dwordx4 v[172:175], v8, s[24:27], s12 offen offset:3072 sc0 sc1
  v_mfma_f32_16x16x32_bf16 v[112:115], v[184:187], a[40:43], v[112:115]
  v_mfma_f32_16x16x32_bf16 v[116:119], v[188:191], a[40:43], v[116:119]
  v_mfma_f32_16x16x32_bf16 v[120:123], v[192:195], a[40:43], v[120:123]
  buffer_load_dwordx4 v[176:179], v9, s[24:27], s12 offen offset:0 sc0 sc1
  v_mfma_f32_16x16x32_bf16 v[124:127], v[196:199], a[40:43], v[124:127]
  v_mfma_f32_16x16x32_bf16 v[128:131], v[200:203], a[40:43], v[128:131]
  v_mfma_f32_16x16x32_bf16 v[132:135], v[204:207], a[40:43], v[132:135]
  buffer_load_dwordx4 v[180:183], v9, s[24:27], s12 offen offset:1024 sc0 sc1
  v_mfma_f32_16x16x32_bf16 v[136:139], v[184:187], a[44:47], v[136:139]
  v_mfma_f32_16x16x32_bf16 v[140:143], v[188:191], a[44:47], v[140:143]
  v_mfma_f32_16x16x32_bf16 v[144:147], v[192:195], a[44:47], v[144:147]
  v_mfma_f32_16x16x32_bf16 v[148:151], v[196:199], a[44:47], v[148:151]
  v_mfma_f32_16x16x32_bf16 v[152:155], v[200:203], a[44:47], v[152:155]
  v_mfma_f32_16x16x32_bf16 v[156:159], v[204:207], a[44:47], v[156:159]
  s_waitcnt vmcnt(18)
  v_mfma_f32_16x16x32_bf16 v[64:67], v[208:211], a[48:51], v[64:67]
  v_mfma_f32_16x16x32_bf16 v[68:71], v[212:215], a[48:51], v[68:71]
  v_mfma_f32_16x16x32_bf16 v[72:75], v[216:219], a[48:51], v[72:75]
  s_add_u32 s12, s7, 675840
  buffer_load_dwordx4 v[184:187], v8, s[24:27], s12 offen offset:0 sc0 sc1
  v_mfma_f32_16x16x32_bf16 v[76:79], v[220:223], a[48:51], v[76:79]
  v_mfma_f32_16x16x32_bf16 v[80:83], v[224:227], a[48:51], v[80:83]
  v_mfma_f32_16x16x32_bf16 v[84:87], v[228:231], a[48:51], v[84:87]
  buffer_load_dwordx4 v[188:191], v8, s[24:27], s12 offen offset:1024 sc0 sc1
  v_mfma_f32_16x16x32_bf16 v[88:91], v[208:211], a[52:55], v[88:91]
  v_mfma_f32_16x16x32_bf16 v[92:95], v[212:215], a[52:55], v[92:95]
  v_mfma_f32_16x16x32_bf16 v[96:99], v[216:219], a[52:55], v[96:99]
  buffer_load_dwordx4 v[192:195], v8, s[24:27], s12 offen offset:2048 sc0 sc1
  v_mfma_f32_16x16x32_bf16 v[100:103], v[220:223], a[52:55], v[100:103]
  v_mfma_f32_16x16x32_bf16 v[104:107], v[224:227], a[52:55], v[104:107]
  v_mfma_f32_16x16x32_bf16 v[108:111], v[228:231], a[52:55], v[108:111]
  buffer_load_dwordx4 v[196:199], v8, s[24:27], s12 offen offset:3072 sc0 sc1
  v_mfma_f32_16x16x32_bf16 v[112:115], v[208:211], a[56:59], v[112:115]
  v_mfma_f32_16x16x32_bf16 v[116:119], v[212:215], a[56:59], v[116:119]
  v_mfma_f32_16x16x32_bf16 v[120:123], v[216:219], a[56:59], v[120:123]
  buffer_load_dwordx4 v[200:203], v9, s[24:27], s12 offen offset:0 sc0 sc1
  v_mfma_f32_16x16x32_bf16 v[124:127], v[220:223], a[56:59], v[124:127]
  v_mfma_f32_16x16x32_bf16 v[128:131], v[224:227], a[56:59], v[128:131]
  v_mfma_f32_16x16x32_bf16 v[132:135], v[228:231], a[56:59], v[132:135]
  buffer_load_dwordx4 v[204:207], v9, s[24:27], s12 offen offset:1024 sc0 sc1
  v_mfma_f32_16x16x32_bf16 v[136:139], v[208:211], a[60:63], v[136:139]
  v_mfma_f32_16x16x32_bf16 v[140:143], v[212:215], a[60:63], v[140:143]
  v_mfma_f32_16x16x32_bf16 v[144:147], v[216:219], a[60:63], v[144:147]
  buffer_load_ushort v16, v11, s[60:63], s18 offen
  v_mfma_f32_16x16x32_bf16 v[148:151], v[220:223], a[60:63], v[148:151]
  v_mfma_f32_16x16x32_bf16 v[152:155], v[224:227], a[60:63], v[152:155]
  v_mfma_f32_16x16x32_bf16 v[156:159], v[228:231], a[60:63], v[156:159]
  buffer_load_dwordx4 v[4:7], v13, s[24:27], s49 offen
  s_waitcnt vmcnt(20)
  v_mfma_f32_16x16x32_bf16 v[64:67], v[232:235], a[64:67], v[64:67]
  v_mfma_f32_16x16x32_bf16 v[68:71], v[236:239], a[64:67], v[68:71]
  v_mfma_f32_16x16x32_bf16 v[72:75], v[240:243], a[64:67], v[72:75]
  v_mfma_f32_16x16x32_bf16 v[76:79], v[244:247], a[64:67], v[76:79]
  v_mfma_f32_16x16x32_bf16 v[80:83], v[248:251], a[64:67], v[80:83]
  v_mfma_f32_16x16x32_bf16 v[84:87], v[252:255], a[64:67], v[84:87]
  v_mfma_f32_16x16x32_bf16 v[88:91], v[232:235], a[68:71], v[88:91]
  v_mfma_f32_16x16x32_bf16 v[92:95], v[236:239], a[68:71], v[92:95]
  v_mfma_f32_16x16x32_bf16 v[96:99], v[240:243], a[68:71], v[96:99]
  v_mfma_f32_16x16x32_bf16 v[100:103], v[244:247], a[68:71], v[100:103]
  v_mfma_f32_16x16x32_bf16 v[104:107], v[248:251], a[68:71], v[104:107]
  v_mfma_f32_16x16x32_bf16 v[108:111], v[252:255], a[68:71], v[108:111]
  v_mfma_f32_16x16x32_bf16 v[112:115], v[232:235], a[72:75], v[112:115]
  v_mfma_f32_16x16x32_bf16 v[116:119], v[236:239], a[72:75], v[116:119]
  v_mfma_f32_16x16x32_bf16 v[120:123], v[240:243], a[72:75], v[120:123]
  v_mfma_f32_16x16x32_bf16 v[124:127], v[244:247], a[72:75], v[124:127]
  v_mfma_f32_16x16x32_bf16 v[128:131], v[248:251], a[72:75], v[128:131]
  v_mfma_f32_16x16x32_bf16 v[132:135], v[252:255], a[72:75], v[132:135]
  v_mfma_f32_16x16x32_bf16 v[136:139], v[232:235], a[76:79], v[136:139]
  v_mfma_f32_16x16x32_bf16 v[140:143], v[236:239], a[76:79], v[140:143]
  v_mfma_f32_16x16x32_bf16 v[144:147], v[240:243], a[76:79], v[144:147]
  v_mfma_f32_16x16x32_bf16 v[148:151], v[244:247], a[76:79], v[148:151]
  v_mfma_f32_16x16x32_bf16 v[152:155], v[248:251], a[76:79], v[152:155]
  v_mfma_f32_16x16x32_bf16 v[156:159], v[252:255], a[76:79], v[156:159]
  s_waitcnt vmcnt(14)
  v_mfma_f32_16x16x32_bf16 v[64:67], v[32:35], a[80:83], v[64:67]
  v_mfma_f32_16x16x32_bf16 v[68:71], v[36:39], a[80:83], v[68:71]
  v_mfma_f32_16x16x32_bf16 v[72:75], v[40:43], a[80:83], v[72:75]
  v_mfma_f32_16x16x32_bf16 v[76:79], v[44:47], a[80:83], v[76:79]
  v_mfma_f32_16x16x32_bf16 v[80:83], v[48:51], a[80:83], v[80:83]
  v_mfma_f32_16x16x32_bf16 v[84:87], v[52:55], a[80:83], v[84:87]
  v_mfma_f32_16x16x32_bf16 v[88:91], v[32:35], a[84:87], v[88:91]
  v_mfma_f32_16x16x32_bf16 v[92:95], v[36:39], a[84:87], v[92:95]
  v_mfma_f32_16x16x32_bf16 v[96:99], v[40:43], a[84:87], v[96:99]
  v_mfma_f32_16x16x32_bf16 v[100:103], v[44:47], a[84:87], v[100:103]
  v_mfma_f32_16x16x32_bf16 v[104:107], v[48:51], a[84:87], v[104:107]
  v_mfma_f32_16x16x32_bf16 v[108:111], v[52:55], a[84:87], v[108:111]
  v_mfma_f32_16x16x32_bf16 v[112:115], v[32:35], a[88:91], v[112:115]
  v_mfma_f32_16x16x32_bf16 v[116:119], v[36:39], a[88:91], v[116:119]
  v_mfma_f32_16x16x32_bf16 v[120:123], v[40:43], a[88:91], v[120:123]
  v_mfma_f32_16x16x32_bf16 v[124:127], v[44:47], a[88:91], v[124:127]
  v_mfma_f32_16x16x32_bf16 v[128:131], v[48:51], a[88:91], v[128:131]
  v_mfma_f32_16x16x32_bf16 v[132:135], v[52:55], a[88:91], v[132:135]
  v_mfma_f32_16x16x32_bf16 v[136:139], v[32:35], a[92:95], v[136:139]
  v_mfma_f32_16x16x32_bf16 v[140:143], v[36:39], a[92:95], v[140:143]
  v_mfma_f32_16x16x32_bf16 v[144:147], v[40:43], a[92:95], v[144:147]
  v_mfma_f32_16x16x32_bf16 v[148:151], v[44:47], a[92:95], v[148:151]
  v_mfma_f32_16x16x32_bf16 v[152:155], v[48:51], a[92:95], v[152:155]
  v_mfma_f32_16x16x32_bf16 v[156:159], v[52:55], a[92:95], v[156:159]
  s_waitcnt vmcnt(8)
  v_add_u32 v14, s19, v8
  v_add_u32 v15, 65536, v14
  v_mfma_f32_16x16x32_bf16 v[64:67], v[160:163], a[96:99], v[64:67]
  v_mfma_f32_16x16x32_bf16 v[68:71], v[164:167], a[96:99], v[68:71]
  v_mfma_f32_16x16x32_bf16 v[72:75], v[168:171], a[96:99], v[72:75]
  s_add_u32 s42, s41, 0
  buffer_load_dwordx4 a[128:131], v8, s[24:27], s42 offen offset:0
  v_mfma_f32_16x16x32_bf16 v[76:79], v[172:175], a[96:99], v[76:79]
  v_mfma_f32_16x16x32_bf16 v[80:83], v[176:179], a[96:99], v[80:83]
  v_mfma_f32_16x16x32_bf16 v[84:87], v[180:183], a[96:99], v[84:87]
  buffer_load_dwordx4 a[132:135], v8, s[24:27], s42 offen offset:1024
  v_mfma_f32_16x16x32_bf16 v[88:91], v[160:163], a[100:103], v[88:91]
  v_mfma_f32_16x16x32_bf16 v[92:95], v[164:167], a[100:103], v[92:95]
  v_mfma_f32_16x16x32_bf16 v[96:99], v[168:171], a[100:103], v[96:99]
  buffer_load_dwordx4 a[136:139], v8, s[24:27], s42 offen offset:2048
  v_mfma_f32_16x16x32_bf16 v[100:103], v[172:175], a[100:103], v[100:103]
  v_mfma_f32_16x16x32_bf16 v[104:107], v[176:179], a[100:103], v[104:107]
  v_mfma_f32_16x16x32_bf16 v[108:111], v[180:183], a[100:103], v[108:111]
  buffer_load_dwordx4 a[140:143], v8, s[24:27], s42 offen offset:3072
  v_mfma_f32_16x16x32_bf16 v[112:115], v[160:163], a[104:107], v[112:115]
  v_mfma_f32_16x16x32_bf16 v[116:119], v[164:167], a[104:107], v[116:119]
  v_mfma_f32_16x16x32_bf16 v[120:123], v[168:171], a[104:107], v[120:123]
  s_add_u32 s42, s41, 4096
  buffer_load_dwordx4 a[144:147], v8, s[24:27], s42 offen offset:0
  v_mfma_f32_16x16x32_bf16 v[124:127], v[172:175], a[104:107], v[124:127]
  v_mfma_f32_16x16x32_bf16 v[128:131], v[176:179], a[104:107], v[128:131]
  v_mfma_f32_16x16x32_bf16 v[132:135], v[180:183], a[104:107], v[132:135]
  buffer_load_dwordx4 a[148:151], v8, s[24:27], s42 offen offset:1024
  v_mfma_f32_16x16x32_bf16 v[136:139], v[160:163], a[108:111], v[136:139]
  v_mfma_f32_16x16x32_bf16 v[140:143], v[164:167], a[108:111], v[140:143]
  v_mfma_f32_16x16x32_bf16 v[144:147], v[168:171], a[108:111], v[144:147]
  buffer_load_dwordx4 a[152:155], v8, s[24:27], s42 offen offset:2048
  v_mfma_f32_16x16x32_bf16 v[148:151], v[172:175], a[108:111], v[148:151]
  v_mfma_f32_16x16x32_bf16 v[152:155], v[176:179], a[108:111], v[152:155]
  v_mfma_f32_16x16x32_bf16 v[156:159], v[180:183], a[108:111], v[156:159]
  buffer_load_dwordx4 a[156:159], v8, s[24:27], s42 offen offset:3072
  s_waitcnt vmcnt(10)
  v_mfma_f32_16x16x32_bf16 v[88:91], v[184:187], a[116:119], v[88:91]
  v_mfma_f32_16x16x32_bf16 v[92:95], v[188:191], a[116:119], v[92:95]
  v_mfma_f32_16x16x32_bf16 v[96:99], v[192:195], a[116:119], v[96:99]
  s_add_u32 s42, s41, 8192
  buffer_load_dwordx4 a[160:163], v8, s[24:27], s42 offen offset:0
  v_mfma_f32_16x16x32_bf16 v[100:103], v[196:199], a[116:119], v[100:103]
  v_mfma_f32_16x16x32_bf16 v[104:107], v[200:203], a[116:119], v[104:107]
  v_mfma_f32_16x16x32_bf16 v[108:111], v[204:207], a[116:119], v[108:111]
  buffer_load_dwordx4 a[164:167], v8, s[24:27], s42 offen offset:1024
  ds_write_b128 v14, v[88:91] offset:0
  v_mfma_f32_16x16x32_bf16 v[112:115], v[184:187], a[120:123], v[112:115]
  ds_write_b128 v14, v[92:95] offset:1024
  v_mfma_f32_16x16x32_bf16 v[116:119], v[188:191], a[120:123], v[116:119]
  ds_write_b128 v14, v[96:99] offset:2048
  v_mfma_f32_16x16x32_bf16 v[120:123], v[192:195], a[120:123], v[120:123]
  buffer_load_dwordx4 a[168:171], v8, s[24:27], s42 offen offset:2048
  ds_write_b128 v14, v[100:103] offset:3072
  v_mfma_f32_16x16x32_bf16 v[124:127], v[196:199], a[120:123], v[124:127]
  ds_write_b128 v14, v[104:107] offset:4096
  v_mfma_f32_16x16x32_bf16 v[128:131], v[200:203], a[120:123], v[128:131]
  ds_write_b128 v14, v[108:111] offset:5120
  v_mfma_f32_16x16x32_bf16 v[132:135], v[204:207], a[120:123], v[132:135]
  buffer_load_dwordx4 a[172:175], v8, s[24:27], s42 offen offset:3072
  ds_write_b128 v14, v[112:115] offset:6144
  v_mfma_f32_16x16x32_bf16 v[136:139], v[184:187], a[124:127], v[136:139]
  ds_write_b128 v14, v[116:119] offset:7168
  v_mfma_f32_16x16x32_bf16 v[140:143], v[188:191], a[124:127], v[140:143]
  ds_write_b128 v14, v[120:123] offset:8192
  v_mfma_f32_16x16x32_bf16 v[144:147], v[192:195], a[124:127], v[144:147]
  s_add_u32 s42, s41, 12288
  buffer_load_dwordx4 a[176:179], v8, s[24:27], s42 offen offset:0
  ds_write_b128 v14, v[124:127] offset:9216
  v_mfma_f32_16x16x32_bf16 v[148:151], v[196:199], a[124:127], v[148:151]
  ds_write_b128 v14, v[128:131] offset:10240
  v_mfma_f32_16x16x32_bf16 v[152:155], v[200:203], a[124:127], v[152:155]
  ds_write_b128 v14, v[132:135] offset:11264
  v_mfma_f32_16x16x32_bf16 v[156:159], v[204:207], a[124:127], v[156:159]
  buffer_load_dwordx4 a[180:183], v8, s[24:27], s42 offen offset:1024
  ds_write_b128 v15, v[136:139] offset:0
  v_mfma_f32_16x16x32_bf16 v[64:67], v[184:187], a[112:115], v[64:67]
  ds_write_b128 v15, v[140:143] offset:1024
  v_mfma_f32_16x16x32_bf16 v[68:71], v[188:191], a[112:115], v[68:71]
  ds_write_b128 v15, v[144:147] offset:2048
  v_mfma_f32_16x16x32_bf16 v[72:75], v[192:195], a[112:115], v[72:75]
  buffer_load_dwordx4 a[184:187], v8, s[24:27], s42 offen offset:2048
  ds_write_b128 v15, v[148:151] offset:3072
  v_mfma_f32_16x16x32_bf16 v[76:79], v[196:199], a[112:115], v[76:79]
  ds_write_b128 v15, v[152:155] offset:4096
  v_mfma_f32_16x16x32_bf16 v[80:83], v[200:203], a[112:115], v[80:83]
  ds_write_b128 v15, v[156:159] offset:5120
  v_mfma_f32_16x16x32_bf16 v[84:87], v[204:207], a[112:115], v[84:87]
  buffer_load_dwordx4 a[188:191], v8, s[24:27], s42 offen offset:3072
  s_add_u32 s42, s41, 16384
  buffer_load_dwordx4 a[192:195], v8, s[24:27], s42 offen offset:0
  buffer_load_dwordx4 a[196:199], v8, s[24:27], s42 offen offset:1024
  buffer_load_dwordx4 a[200:203], v8, s[24:27], s42 offen offset:2048
  buffer_load_dwordx4 a[204:207], v8, s[24:27], s42 offen offset:3072
  s_add_u32 s42, s41, 20480
  buffer_load_dwordx4 a[208:211], v8, s[24:27], s42 offen offset:0
  buffer_load_dwordx4 a[212:215], v8, s[24:27], s42 offen offset:1024
  s_xor_b32 s21, s20, 1
  s_lshl_b32 s22, s21, 14
  s_add_u32 s22, s22, 0
  v_add_u32 v29, s22, v8
  s_xor_b32 s21, s20, 2
  s_lshl_b32 s22, s21, 14
  s_add_u32 s22, s22, 6144
  v_add_u32 v30, s22, v8
  s_xor_b32 s21, s20, 3
  s_lshl_b32 s22, s21, 14
  s_add_u32 s22, s22, 65536
  v_add_u32 v31, s22, v8
  s_mul_i32 s22, s20, 3072
  v_add_u32 v28, s22, v28
  ds_read_b64 v[32:33], v28 offset:8192
  ds_read_b64 v[34:35], v28 offset:8704
  ds_read_b64 v[36:37], v28 offset:9216
  ds_read_b64 v[38:39], v28 offset:9728
  ds_read_b64 v[40:41], v28 offset:10240
  ds_read_b64 v[42:43], v28 offset:10752
  s_waitcnt vmcnt(22)
  v_lshlrev_b32 v16, 16, v16
  v_pk_add_f32 v[64:65], v[64:65], v[16:17] op_sel_hi:[1,0]
  v_pk_add_f32 v[66:67], v[66:67], v[16:17] op_sel_hi:[1,0]
  v_pk_add_f32 v[68:69], v[68:69], v[16:17] op_sel_hi:[1,0]
  v_pk_add_f32 v[70:71], v[70:71], v[16:17] op_sel_hi:[1,0]
  v_pk_add_f32 v[72:73], v[72:73], v[16:17] op_sel_hi:[1,0]
  v_pk_add_f32 v[74:75], v[74:75], v[16:17] op_sel_hi:[1,0]
  v_pk_add_f32 v[76:77], v[76:77], v[16:17] op_sel_hi:[1,0]
  v_pk_add_f32 v[78:79], v[78:79], v[16:17] op_sel_hi:[1,0]
  v_pk_add_f32 v[80:81], v[80:81], v[16:17] op_sel_hi:[1,0]
  v_pk_add_f32 v[82:83], v[82:83], v[16:17] op_sel_hi:[1,0]
  v_pk_add_f32 v[84:85], v[84:85], v[16:17] op_sel_hi:[1,0]
  v_pk_add_f32 v[86:87], v[86:87], v[16:17] op_sel_hi:[1,0]
  s_waitcnt lgkmcnt(0)
  s_barrier
  ds_read_b128 v[88:91], v29 offset:0
  ds_read_b128 v[92:95], v29 offset:1024
  ds_read_b128 v[96:99], v29 offset:2048
  ds_read_b128 v[100:103], v29 offset:3072
  ds_read_b128 v[104:107], v29 offset:4096
  ds_read_b128 v[108:111], v29 offset:5120
  ds_read_b128 v[112:115], v30 offset:0
  ds_read_b128 v[116:119], v30 offset:1024
  ds_read_b128 v[120:123], v30 offset:2048
  ds_read_b128 v[124:127], v30 offset:3072
  ds_read_b128 v[128:131], v30 offset:4096
  ds_read_b128 v[132:135], v30 offset:5120
  ds_read_b128 v[136:139], v31 offset:0
  ds_read_b128 v[140:143], v31 offset:1024
  ds_read_b128 v[144:147], v31 offset:2048
  ds_read_b128 v[148:151], v31 offset:3072
  ds_read_b128 v[152:155], v31 offset:4096
  ds_read_b128 v[156:159], v31 offset:5120
  s_lshl_b32 s16, s3, 2
  s_add_u32 s16, s16, s20
  s_mul_i32 s17, s16, 22
  s_lshr_b32 s22, s8, 1
  s_add_u32 s17, s17, s22
  s_lshl_b32 s17, s17, 10
  s_add_u32 s17, s17, 25165824
  v_add_u32 v15, -2048, v9
  s_waitcnt lgkmcnt(12)
  v_pk_add_f32 v[64:65], v[64:65], v[88:89]
  v_pk_add_f32 v[66:67], v[66:67], v[90:91]
  v_pk_add_f32 v[68:69], v[68:69], v[92:93]
  v_pk_add_f32 v[70:71], v[70:71], v[94:95]
  v_pk_add_f32 v[72:73], v[72:73], v[96:97]
  v_pk_add_f32 v[74:75], v[74:75], v[98:99]
  v_pk_add_f32 v[76:77], v[76:77], v[100:101]
  v_pk_add_f32 v[78:79], v[78:79], v[102:103]
  v_pk_add_f32 v[80:81], v[80:81], v[104:105]
  v_pk_add_f32 v[82:83], v[82:83], v[106:107]
  v_pk_add_f32 v[84:85], v[84:85], v[108:109]
  v_pk_add_f32 v[86:87], v[86:87], v[110:111]
  s_waitcnt lgkmcnt(6)
  v_pk_add_f32 v[64:65], v[64:65], v[112:113]
  v_pk_add_f32 v[66:67], v[66:67], v[114:115]
  v_pk_add_f32 v[68:69], v[68:69], v[116:117]
  v_pk_add_f32 v[70:71], v[70:71], v[118:119]
  v_pk_add_f32 v[72:73], v[72:73], v[120:121]
  v_pk_add_f32 v[74:75], v[74:75], v[122:123]
  v_pk_add_f32 v[76:77], v[76:77], v[124:125]
  v_pk_add_f32 v[78:79], v[78:79], v[126:127]
  v_pk_add_f32 v[80:81], v[80:81], v[128:129]
  v_pk_add_f32 v[82:83], v[82:83], v[130:131]
  v_pk_add_f32 v[84:85], v[84:85], v[132:133]
  v_pk_add_f32 v[86:87], v[86:87], v[134:135]
  s_waitcnt lgkmcnt(0)
  v_pk_add_f32 v[64:65], v[64:65], v[136:137]
  v_pk_add_f32 v[66:67], v[66:67], v[138:139]
  v_pk_add_f32 v[68:69], v[68:69], v[140:141]
  v_pk_add_f32 v[70:71], v[70:71], v[142:143]
  v_pk_add_f32 v[72:73], v[72:73], v[144:145]
  v_pk_add_f32 v[74:75], v[74:75], v[146:147]
  v_pk_add_f32 v[76:77], v[76:77], v[148:149]
  v_pk_add_f32 v[78:79], v[78:79], v[150:151]
  v_pk_add_f32 v[80:81], v[80:81], v[152:153]
  v_pk_add_f32 v[82:83], v[82:83], v[154:155]
  v_pk_add_f32 v[84:85], v[84:85], v[156:157]
  v_pk_add_f32 v[86:87], v[86:87], v[158:159]
  v_lshlrev_b32 v44, 16, v32
  v_and_b32 v45, 0xffff0000, v32
  v_pk_mul_f32 v[64:65], v[64:65], v[44:45]
  v_cvt_pk_bf16_f32 v48, v64, v65
  v_lshlrev_b32 v44, 16, v33
  v_and_b32 v45, 0xffff0000, v33
  v_pk_mul_f32 v[66:67], v[66:67], v[44:45]
  v_cvt_pk_bf16_f32 v49, v66, v67
  v_lshlrev_b32 v44, 16, v34
  v_and_b32 v45, 0xffff0000, v34
  v_pk_mul_f32 v[68:69], v[68:69], v[44:45]
  v_cvt_pk_bf16_f32 v50, v68, v69
  v_lshlrev_b32 v44, 16, v35
  v_and_b32 v45, 0xffff0000, v35
  v_pk_mul_f32 v[70:71], v[70:71], v[44:45]
  v_cvt_pk_bf16_f32 v51, v70, v71
  buffer_store_dwordx4 v[48:51], v8, s[24:27], s17 offen offset:0 sc0 sc1
  v_lshlrev_b32 v44, 16, v36
  v_and_b32 v45, 0xffff0000, v36
  v_pk_mul_f32 v[72:73], v[72:73], v[44:45]
  v_cvt_pk_bf16_f32 v52, v72, v73
  v_lshlrev_b32 v44, 16, v37
  v_and_b32 v45, 0xffff0000, v37
  v_pk_mul_f32 v[74:75], v[74:75], v[44:45]
  v_cvt_pk_bf16_f32 v53, v74, v75
  v_lshlrev_b32 v44, 16, v38
  v_and_b32 v45, 0xffff0000, v38
  v_pk_mul_f32 v[76:77], v[76:77], v[44:45]
  v_cvt_pk_bf16_f32 v54, v76, v77
  v_lshlrev_b32 v44, 16, v39
  v_and_b32 v45, 0xffff0000, v39
  v_pk_mul_f32 v[78:79], v[78:79], v[44:45]
  v_cvt_pk_bf16_f32 v55, v78, v79
  buffer_store_dwordx4 v[52:55], v8, s[24:27], s17 offen offset:1024 sc0 sc1
  v_lshlrev_b32 v44, 16, v40
  v_and_b32 v45, 0xffff0000, v40
  v_pk_mul_f32 v[80:81], v[80:81], v[44:45]
  v_cvt_pk_bf16_f32 v56, v80, v81
  v_lshlrev_b32 v44, 16, v41
  v_and_b32 v45, 0xffff0000, v41
  v_pk_mul_f32 v[82:83], v[82:83], v[44:45]
  v_cvt_pk_bf16_f32 v57, v82, v83
  v_lshlrev_b32 v44, 16, v42
  v_and_b32 v45, 0xffff0000, v42
  v_pk_mul_f32 v[84:85], v[84:85], v[44:45]
  v_cvt_pk_bf16_f32 v58, v84, v85
  v_lshlrev_b32 v44, 16, v43
  v_and_b32 v45, 0xffff0000, v43
  v_pk_mul_f32 v[86:87], v[86:87], v[44:45]
  v_cvt_pk_bf16_f32 v59, v86, v87
  buffer_store_dwordx4 v[56:59], v15, s[24:27], s17 offen offset:0 sc0 sc1
  v_mul_u32_u24 v2, 144, v12
  v_lshl_add_u32 v2, v10, 4, v2
  s_lshl_b32 s49, s43, 1
  s_add_u32 s49, s49, 98304
  v_add_u32 v18, s49, v2
  v_lshrrev_b32 v2, 3, v0
  v_and_b32 v3, 7, v0
  v_mul_u32_u24 v19, 144, v2
  v_lshl_add_u32 v19, v3, 4, v19
  v_add_u32 v19, 98304, v19
  v_lshlrev_b32 v13, 10, v2
  v_lshl_add_u32 v13, v3, 4, v13
  s_lshl_b32 s49, s3, 16
  s_lshl_b32 s50, s40, 7
  s_add_u32 s49, s49, s50
  s_add_u32 s50, s49, 32768
  s_mul_i32 s51, s16, 22528
  s_add_u32 s51, s51, 25165824
  s_mul_i32 s52, s20, 22528
  v_add_u32 v9, 45056, v8
  v_mov_b32 v2, 1
  v_mov_b32 v3, 0
  s_waitcnt vmcnt(0)
  s_barrier
  s_cmp_lg_u32 s20, 0
  s_cbranch_scc1 G2_GO
  s_mov_b64 exec, 1
  buffer_store_dword v2, v3, s[24:27], s47 offen sc0 sc1
  s_mov_b64 exec, -1
  v_lshlrev_b32 v2, 2, v1
  s_mov_b32 s53, 0
  s_mov_b64 exec, 0xff
G2_POLL:
  buffer_load_dword v3, v2, s[24:27], s46 offen sc1
  s_add_u32 s53, s53, 1
  s_waitcnt vmcnt(0)
  v_cmp_ne_u32 vcc, 1, v3
  s_cmp_gt_u32 s53, 400000
  s_cbranch_scc1 G2_GO
  s_cbranch_vccz G2_GO
  s_sleep 4
  s_branch G2_POLL
G2_GO:
  s_mov_b64 exec, -1
  s_barrier
  s_add_u32 m0, s52, 0
  s_add_u32 s54, s51, 0
  buffer_load_dwordx4 v8, s[24:27], s54 offen offset:0 sc0 sc1 lds
  buffer_load_dwordx4 v8, s[24:27], s54 offen offset:1024 sc0 sc1 lds
  buffer_load_dwordx4 v8, s[24:27], s54 offen offset:2048 sc0 sc1 lds
  buffer_load_dwordx4 v8, s[24:27], s54 offen offset:3072 sc0 sc1 lds
  s_add_u32 m0, s52, 4096
  s_add_u32 s54, s51, 4096
  buffer_load_dwordx4 v8, s[24:27], s54 offen offset:0 sc0 sc1 lds
  buffer_load_dwordx4 v8, s[24:27], s54 offen offset:1024 sc0 sc1 lds
  buffer_load_dwordx4 v8, s[24:27], s54 offen offset:2048 sc0 sc1 lds
  buffer_load_dwordx4 v8, s[24:27], s54 offen offset:3072 sc0 sc1 lds
  s_add_u32 m0, s52, 8192
  s_add_u32 s54, s51, 8192
  buffer_load_dwordx4 v8, s[24:27], s54 offen offset:0 sc0 sc1 lds
  buffer_load_dwordx4 v8, s[24:27], s54 offen offset:1024 sc0 sc1 lds
  buffer_load_dwordx4 v8, s[24:27], s54 offen offset:2048 sc0 sc1 lds
  buffer_load_dwordx4 v8, s[24:27], s54 offen offset:3072 sc0 sc1 lds
  s_add_u32 m0, s52, 12288
  s_add_u32 s54, s51, 12288
  buffer_load_dwordx4 v8, s[24:27], s54 offen offset:0 sc0 sc1 lds
  buffer_load_dwordx4 v8, s[24:27], s54 offen offset:1024 sc0 sc1 lds
  buffer_load_dwordx4 v8, s[24:27], s54 offen offset:2048 sc0 sc1 lds
  buffer_load_dwordx4 v8, s[24:27], s54 offen offset:3072 sc0 sc1 lds
  s_add_u32 m0, s52, 16384
  s_add_u32 s54, s51, 16384
  buffer_load_dwordx4 v8, s[24:27], s54 offen offset:0 sc0 sc1 lds
  buffer_load_dwordx4 v8, s[24:27], s54 offen offset:1024 sc0 sc1 lds
  buffer_load_dwordx4 v8, s[24:27], s54 offen offset:2048 sc0 sc1 lds
  buffer_load_dwordx4 v8, s[24:27], s54 offen offset:3072 sc0 sc1 lds
  s_add_u32 m0, s52, 20480
  s_add_u32 s54, s51, 20480
  buffer_load_dwordx4 v8, s[24:27], s54 offen offset:0 sc0 sc1 lds
  buffer_load_dwordx4 v8, s[24:27], s54 offen offset:1024 sc0 sc1 lds
  s_waitcnt vmcnt(16)
  s_barrier
  ds_read_b128 v[32:35], v8 offset:0
  ds_read_b128 v[36:39], v8 offset:22528
  ds_read_b128 v[40:43], v9 offset:0
  ds_read_b128 v[44:47], v9 offset:22528
  ds_read_b128 v[48:51], v8 offset:1024
  ds_read_b128 v[52:55], v8 offset:23552
  ds_read_b128 v[56:59], v9 offset:1024
  ds_read_b128 v[60:63], v9 offset:23552
  s_waitcnt lgkmcnt(4)
  v_mfma_f32_16x16x32_bf16 v[96:99], a[128:131], v[32:35], 0
  ds_read_b128 v[64:67], v8 offset:2048
  v_mfma_f32_16x16x32_bf16 v[100:103], a[128:131], v[36:39], 0
  ds_read_b128 v[68:71], v8 offset:24576
  v_mfma_f32_16x16x32_bf16 v[104:107], a[128:131], v[40:43], 0
  ds_read_b128 v[72:75], v9 offset:2048
  v_mfma_f32_16x16x32_bf16 v[108:111], a[128:131], v[44:47], 0
  ds_read_b128 v[76:79], v9 offset:24576
  s_waitcnt lgkmcnt(4)
  v_mfma_f32_16x16x32_bf16 v[96:99], a[132:135], v[48:51], v[96:99]
  ds_read_b128 v[32:35], v8 offset:3072
  v_mfma_f32_16x16x32_bf16 v[100:103], a[132:135], v[52:55], v[100:103]
  ds_read_b128 v[36:39], v8 offset:25600
  v_mfma_f32_16x16x32_bf16 v[104:107], a[132:135], v[56:59], v[104:107]
  ds_read_b128 v[40:43], v9 offset:3072
  v_mfma_f32_16x16x32_bf16 v[108:111], a[132:135], v[60:63], v[108:111]
  ds_read_b128 v[44:47], v9 offset:25600
  s_waitcnt lgkmcnt(4)
  v_mfma_f32_16x16x32_bf16 v[96:99], a[136:139], v[64:67], v[96:99]
  ds_read_b128 v[48:51], v8 offset:4096
  v_mfma_f32_16x16x32_bf16 v[100:103], a[136:139], v[68:71], v[100:103]
  ds_read_b128 v[52:55], v8 offset:26624
  v_mfma_f32_16x16x32_bf16 v[104:107], a[136:139], v[72:75], v[104:107]
  ds_read_b128 v[56:59], v9 offset:4096
  v_mfma_f32_16x16x32_bf16 v[108:111], a[136:139], v[76:79], v[108:111]
  ds_read_b128 v[60:63], v9 offset:26624
  s_waitcnt lgkmcnt(4)
  v_mfma_f32_16x16x32_bf16 v[96:99], a[140:143], v[32:35], v[96:99]
  ds_read_b128 v[64:67], v8 offset:5120
  v_mfma_f32_16x16x32_bf16 v[100:103], a[140:143], v[36:39], v[100:103]
  ds_read_b128 v[68:71], v8 offset:27648
  v_mfma_f32_16x16x32_bf16 v[104:107], a[140:143], v[40:43], v[104:107]
  ds_read_b128 v[72:75], v9 offset:5120
  v_mfma_f32_16x16x32_bf16 v[108:111], a[140:143], v[44:47], v[108:111]
  ds_read_b128 v[76:79], v9 offset:27648
  s_waitcnt lgkmcnt(4)
  v_mfma_f32_16x16x32_bf16 v[96:99], a[144:147], v[48:51], v[96:99]
  v_mfma_f32_16x16x32_bf16 v[100:103], a[144:147], v[52:55], v[100:103]
  v_mfma_f32_16x16x32_bf16 v[104:107], a[144:147], v[56:59], v[104:107]
  v_mfma_f32_16x16x32_bf16 v[108:111], a[144:147], v[60:63], v[108:111]
  s_waitcnt lgkmcnt(0)
  v_mfma_f32_16x16x32_bf16 v[96:99], a[148:151], v[64:67], v[96:99]
  v_mfma_f32_16x16x32_bf16 v[100:103], a[148:151], v[68:71], v[100:103]
  v_mfma_f32_16x16x32_bf16 v[104:107], a[148:151], v[72:75], v[104:107]
  v_mfma_f32_16x16x32_bf16 v[108:111], a[148:151], v[76:79], v[108:111]
  s_waitcnt vmcnt(8)
  s_barrier
  ds_read_b128 v[32:35], v8 offset:6144
  ds_read_b128 v[36:39], v8 offset:28672
  ds_read_b128 v[40:43], v9 offset:6144
  ds_read_b128 v[44:47], v9 offset:28672
  ds_read_b128 v[48:51], v8 offset:7168
  ds_read_b128 v[52:55], v8 offset:29696
  ds_read_b128 v[56:59], v9 offset:7168
  ds_read_b128 v[60:63], v9 offset:29696
  s_waitcnt lgkmcnt(4)
  v_mfma_f32_16x16x32_bf16 v[96:99], a[152:155], v[32:35], v[96:99]
  ds_read_b128 v[64:67], v8 offset:8192
  v_mfma_f32_16x16x32_bf16 v[100:103], a[152:155], v[36:39], v[100:103]
  ds_read_b128 v[68:71], v8 offset:30720
  v_mfma_f32_16x16x32_bf16 v[104:107], a[152:155], v[40:43], v[104:107]
  ds_read_b128 v[72:75], v9 offset:8192
  v_mfma_f32_16x16x32_bf16 v[108:111], a[152:155], v[44:47], v[108:111]
  ds_read_b128 v[76:79], v9 offset:30720
  s_waitcnt lgkmcnt(4)
  v_mfma_f32_16x16x32_bf16 v[96:99], a[156:159], v[48:51], v[96:99]
  ds_read_b128 v[32:35], v8 offset:9216
  v_mfma_f32_16x16x32_bf16 v[100:103], a[156:159], v[52:55], v[100:103]
  ds_read_b128 v[36:39], v8 offset:31744
  v_mfma_f32_16x16x32_bf16 v[104:107], a[156:159], v[56:59], v[104:107]
  ds_read_b128 v[40:43], v9 offset:9216
  v_mfma_f32_16x16x32_bf16 v[108:111], a[156:159], v[60:63], v[108:111]
  ds_read_b128 v[44:47], v9 offset:31744
  s_waitcnt lgkmcnt(4)
  v_mfma_f32_16x16x32_bf16 v[96:99], a[160:163], v[64:67], v[96:99]
  ds_read_b128 v[48:51], v8 offset:10240
  v_mfma_f32_16x16x32_bf16 v[100:103], a[160:163], v[68:71], v[100:103]
  ds_read_b128 v[52:55], v8 offset:32768
  v_mfma_f32_16x16x32_bf16 v[104:107], a[160:163], v[72:75], v[104:107]
  ds_read_b128 v[56:59], v9 offset:10240
  v_mfma_f32_16x16x32_bf16 v[108:111], a[160:163], v[76:79], v[108:111]
  ds_read_b128 v[60:63], v9 offset:32768
  s_waitcnt lgkmcnt(4)
  v_mfma_f32_16x16x32_bf16 v[96:99], a[164:167], v[32:35], v[96:99]
  ds_read_b128 v[64:67], v8 offset:11264
  v_mfma_f32_16x16x32_bf16 v[100:103], a[164:167], v[36:39], v[100:103]
  ds_read_b128 v[68:71], v8 offset:33792
  v_mfma_f32_16x16x32_bf16 v[104:107], a[164:167], v[40:43], v[104:107]
  ds_read_b128 v[72:75], v9 offset:11264
  v_mfma_f32_16x16x32_bf16 v[108:111], a[164:167], v[44:47], v[108:111]
  ds_read_b128 v[76:79], v9 offset:33792
  s_waitcnt lgkmcnt(4)
  v_mfma_f32_16x16x32_bf16 v[96:99], a[168:171], v[48:51], v[96:99]
  ds_read_b128 v[32:35], v8 offset:12288
  v_mfma_f32_16x16x32_bf16 v[100:103], a[168:171], v[52:55], v[100:103]
  ds_read_b128 v[36:39], v8 offset:34816
  v_mfma_f32_16x16x32_bf16 v[104:107], a[168:171], v[56:59], v[104:107]
  ds_read_b128 v[40:43], v9 offset:12288
  v_mfma_f32_16x16x32_bf16 v[108:111], a[168:171], v[60:63], v[108:111]
  ds_read_b128 v[44:47], v9 offset:34816
  s_waitcnt lgkmcnt(4)
  v_mfma_f32_16x16x32_bf16 v[96:99], a[172:175], v[64:67], v[96:99]
  ds_read_b128 v[48:51], v8 offset:13312
  v_mfma_f32_16x16x32_bf16 v[100:103], a[172:175], v[68:71], v[100:103]
  ds_read_b128 v[52:55], v8 offset:35840
  v_mfma_f32_16x16x32_bf16 v[104:107], a[172:175], v[72:75], v[104:107]
  ds_read_b128 v[56:59], v9 offset:13312
  v_mfma_f32_16x16x32_bf16 v[108:111], a[172:175], v[76:79], v[108:111]
  ds_read_b128 v[60:63], v9 offset:35840
  s_waitcnt lgkmcnt(4)
  v_mfma_f32_16x16x32_bf16 v[96:99], a[176:179], v[32:35], v[96:99]
  v_mfma_f32_16x16x32_bf16 v[100:103], a[176:179], v[36:39], v[100:103]
  v_mfma_f32_16x16x32_bf16 v[104:107], a[176:179], v[40:43], v[104:107]
  v_mfma_f32_16x16x32_bf16 v[108:111], a[176:179], v[44:47], v[108:111]
  s_waitcnt lgkmcnt(0)
  v_mfma_f32_16x16x32_bf16 v[96:99], a[180:183], v[48:51], v[96:99]
  v_mfma_f32_16x16x32_bf16 v[100:103], a[180:183], v[52:55], v[100:103]
  v_mfma_f32_16x16x32_bf16 v[104:107], a[180:183], v[56:59], v[104:107]
  v_mfma_f32_16x16x32_bf16 v[108:111], a[180:183], v[60:63], v[108:111]
  s_waitcnt vmcnt(0)
  s_barrier
  ds_read_b128 v[64:67], v8 offset:14336
  ds_read_b128 v[68:71], v8 offset:36864
  ds_read_b128 v[72:75], v9 offset:14336
  ds_read_b128 v[76:79], v9 offset:36864
  ds_read_b128 v[32:35], v8 offset:15360
  ds_read_b128 v[36:39], v8 offset:37888
  ds_read_b128 v[40:43], v9 offset:15360
  ds_read_b128 v[44:47], v9 offset:37888
  s_waitcnt lgkmcnt(4)
  v_mfma_f32_16x16x32_bf16 v[96:99], a[184:187], v[64:67], v[96:99]
  ds_read_b128 v[48:51], v8 offset:16384
  v_mfma_f32_16x16x32_bf16 v[100:103], a[184:187], v[68:71], v[100:103]
  ds_read_b128 v[52:55], v8 offset:38912
  v_mfma_f32_16x16x32_bf16 v[104:107], a[184:187], v[72:75], v[104:107]
  ds_read_b128 v[56:59], v9 offset:16384
  v_mfma_f32_16x16x32_bf16 v[108:111], a[184:187], v[76:79], v[108:111]
  ds_read_b128 v[60:63], v9 offset:38912
  s_waitcnt lgkmcnt(4)
  v_mfma_f32_16x16x32_bf16 v[96:99], a[188:191], v[32:35], v[96:99]
  ds_read_b128 v[64:67], v8 offset:17408
  v_mfma_f32_16x16x32_bf16 v[100:103], a[188:191], v[36:39], v[100:103]
  ds_read_b128 v[68:71], v8 offset:39936
  v_mfma_f32_16x16x32_bf16 v[104:107], a[188:191], v[40:43], v[104:107]
  ds_read_b128 v[72:75], v9 offset:17408
  v_mfma_f32_16x16x32_bf16 v[108:111], a[188:191], v[44:47], v[108:111]
  ds_read_b128 v[76:79], v9 offset:39936
  s_waitcnt lgkmcnt(4)
  v_mfma_f32_16x16x32_bf16 v[96:99], a[192:195], v[48:51], v[96:99]
  ds_read_b128 v[32:35], v8 offset:18432
  v_mfma_f32_16x16x32_bf16 v[100:103], a[192:195], v[52:55], v[100:103]
  ds_read_b128 v[36:39], v8 offset:40960
  v_mfma_f32_16x16x32_bf16 v[104:107], a[192:195], v[56:59], v[104:107]
  ds_read_b128 v[40:43], v9 offset:18432
  v_mfma_f32_16x16x32_bf16 v[108:111], a[192:195], v[60:63], v[108:111]
  ds_read_b128 v[44:47], v9 offset:40960
  s_waitcnt lgkmcnt(4)
  v_mfma_f32_16x16x32_bf16 v[96:99], a[196:199], v[64:67], v[96:99]
  ds_read_b128 v[48:51], v8 offset:19456
  v_mfma_f32_16x16x32_bf16 v[100:103], a[196:199], v[68:71], v[100:103]
  ds_read_b128 v[52:55], v8 offset:41984
  v_mfma_f32_16x16x32_bf16 v[104:107], a[196:199], v[72:75], v[104:107]
  ds_read_b128 v[56:59], v9 offset:19456
  v_mfma_f32_16x16x32_bf16 v[108:111], a[196:199], v[76:79], v[108:111]
  ds_read_b128 v[60:63], v9 offset:41984
  s_waitcnt lgkmcnt(4)
  v_mfma_f32_16x16x32_bf16 v[96:99], a[200:203], v[32:35], v[96:99]
  ds_read_b128 v[64:67], v8 offset:20480
  v_mfma_f32_16x16x32_bf16 v[100:103], a[200:203], v[36:39], v[100:103]
  ds_read_b128 v[68:71], v8 offset:43008
  v_mfma_f32_16x16x32_bf16 v[104:107], a[200:203], v[40:43], v[104:107]
  ds_read_b128 v[72:75], v9 offset:20480
  v_mfma_f32_16x16x32_bf16 v[108:111], a[200:203], v[44:47], v[108:111]
  ds_read_b128 v[76:79], v9 offset:43008
  s_waitcnt lgkmcnt(4)
  v_mfma_f32_16x16x32_bf16 v[96:99], a[204:207], v[48:51], v[96:99]
  ds_read_b128 v[32:35], v8 offset:21504
  v_mfma_f32_16x16x32_bf16 v[100:103], a[204:207], v[52:55], v[100:103]
  ds_read_b128 v[36:39], v8 offset:44032
  v_mfma_f32_16x16x32_bf16 v[104:107], a[204:207], v[56:59], v[104:107]
  ds_read_b128 v[40:43], v9 offset:21504
  v_mfma_f32_16x16x32_bf16 v[108:111], a[204:207], v[60:63], v[108:111]
  ds_read_b128 v[44:47], v9 offset:44032
  s_waitcnt lgkmcnt(4)
  v_mfma_f32_16x16x32_bf16 v[96:99], a[208:211], v[64:67], v[96:99]
  v_mfma_f32_16x16x32_bf16 v[100:103], a[208:211], v[68:71], v[100:103]
  v_mfma_f32_16x16x32_bf16 v[104:107], a[208:211], v[72:75], v[104:107]
  v_mfma_f32_16x16x32_bf16 v[108:111], a[208:211], v[76:79], v[108:111]
  s_waitcnt lgkmcnt(0)
  v_mfma_f32_16x16x32_bf16 v[96:99], a[212:215], v[32:35], v[96:99]
  v_mfma_f32_16x16x32_bf16 v[100:103], a[212:215], v[36:39], v[100:103]
  v_mfma_f32_16x16x32_bf16 v[104:107], a[212:215], v[40:43], v[104:107]
  v_mfma_f32_16x16x32_bf16 v[108:111], a[212:215], v[44:47], v[108:111]
  s_nop 4
  v_cvt_pk_bf16_f32 v96, v96, v97
  v_and_b32 v97, 0xffff0000, v96
  v_lshlrev_b32 v96, 16, v96
  v_pk_mul_f32 v[96:97], v[96:97], v[4:5]
  v_cvt_pk_bf16_f32 v96, v96, v97
  v_and_b32 v97, 0xffff0000, v96
  v_lshlrev_b32 v96, 16, v96
  v_lshlrev_b32 v120, 16, v20
  v_and_b32 v121, 0xffff0000, v20
  v_pk_add_f32 v[96:97], v[96:97], v[120:121]
  v_cvt_pk_bf16_f32 v124, v96, v97
  v_cvt_pk_bf16_f32 v98, v98, v99
  v_and_b32 v99, 0xffff0000, v98
  v_lshlrev_b32 v98, 16, v98
  v_pk_mul_f32 v[98:99], v[98:99], v[6:7]
  v_cvt_pk_bf16_f32 v98, v98, v99
  v_and_b32 v99, 0xffff0000, v98
  v_lshlrev_b32 v98, 16, v98
  v_lshlrev_b32 v120, 16, v21
  v_and_b32 v121, 0xffff0000, v21
  v_pk_add_f32 v[98:99], v[98:99], v[120:121]
  v_cvt_pk_bf16_f32 v125, v98, v99
  ds_write_b64 v18, v[124:125] offset:0
  v_cvt_pk_bf16_f32 v100, v100, v101
  v_and_b32 v101, 0xffff0000, v100
  v_lshlrev_b32 v100, 16, v100
  v_pk_mul_f32 v[100:101], v[100:101], v[4:5]
  v_cvt_pk_bf16_f32 v100, v100, v101
  v_and_b32 v101, 0xffff0000, v100
  v_lshlrev_b32 v100, 16, v100
  v_lshlrev_b32 v120, 16, v22
  v_and_b32 v121, 0xffff0000, v22
  v_pk_add_f32 v[100:101], v[100:101], v[120:121]
  v_cvt_pk_bf16_f32 v126, v100, v101
  v_cvt_pk_bf16_f32 v102, v102, v103
  v_and_b32 v103, 0xffff0000, v102
  v_lshlrev_b32 v102, 16, v102
  v_pk_mul_f32 v[102:103], v[102:103], v[6:7]
  v_cvt_pk_bf16_f32 v102, v102, v103
  v_and_b32 v103, 0xffff0000, v102
  v_lshlrev_b32 v102, 16, v102
  v_lshlrev_b32 v120, 16, v23
  v_and_b32 v121, 0xffff0000, v23
  v_pk_add_f32 v[102:103], v[102:103], v[120:121]
  v_cvt_pk_bf16_f32 v127, v102, v103
  ds_write_b64 v18, v[126:127] offset:576
  v_cvt_pk_bf16_f32 v104, v104, v105
  v_and_b32 v105, 0xffff0000, v104
  v_lshlrev_b32 v104, 16, v104
  v_pk_mul_f32 v[104:105], v[104:105], v[4:5]
  v_cvt_pk_bf16_f32 v104, v104, v105
  v_and_b32 v105, 0xffff0000, v104
  v_lshlrev_b32 v104, 16, v104
  v_lshlrev_b32 v120, 16, v24
  v_and_b32 v121, 0xffff0000, v24
  v_pk_add_f32 v[104:105], v[104:105], v[120:121]
  v_cvt_pk_bf16_f32 v128, v104, v105
  v_cvt_pk_bf16_f32 v106, v106, v107
  v_and_b32 v107, 0xffff0000, v106
  v_lshlrev_b32 v106, 16, v106
  v_pk_mul_f32 v[106:107], v[106:107], v[6:7]
  v_cvt_pk_bf16_f32 v106, v106, v107
  v_and_b32 v107, 0xffff0000, v106
  v_lshlrev_b32 v106, 16, v106
  v_lshlrev_b32 v120, 16, v25
  v_and_b32 v121, 0xffff0000, v25
  v_pk_add_f32 v[106:107], v[106:107], v[120:121]
  v_cvt_pk_bf16_f32 v129, v106, v107
  ds_write_b64 v18, v[128:129] offset:4608
  v_cvt_pk_bf16_f32 v108, v108, v109
  v_and_b32 v109, 0xffff0000, v108
  v_lshlrev_b32 v108, 16, v108
  v_pk_mul_f32 v[108:109], v[108:109], v[4:5]
  v_cvt_pk_bf16_f32 v108, v108, v109
  v_and_b32 v109, 0xffff0000, v108
  v_lshlrev_b32 v108, 16, v108
  v_lshlrev_b32 v120, 16, v26
  v_and_b32 v121, 0xffff0000, v26
  v_pk_add_f32 v[108:109], v[108:109], v[120:121]
  v_cvt_pk_bf16_f32 v130, v108, v109
  v_cvt_pk_bf16_f32 v110, v110, v111
  v_and_b32 v111, 0xffff0000, v110
  v_lshlrev_b32 v110, 16, v110
  v_pk_mul_f32 v[110:111], v[110:111], v[6:7]
  v_cvt_pk_bf16_f32 v110, v110, v111
  v_and_b32 v111, 0xffff0000, v110
  v_lshlrev_b32 v110, 16, v110
  v_lshlrev_b32 v120, 16, v27
  v_and_b32 v121, 0xffff0000, v27
  v_pk_add_f32 v[110:111], v[110:111], v[120:121]
  v_cvt_pk_bf16_f32 v131, v110, v111
  ds_write_b64 v18, v[130:131] offset:5184
  s_waitcnt lgkmcnt(0)
  s_barrier
  ds_read_b128 v[32:35], v19
  ds_read_b128 v[36:39], v19 offset:4608
  s_waitcnt lgkmcnt(1)
  buffer_store_dwordx4 v[32:35], v13, s[64:67], s49 offen sc1
  s_waitcnt lgkmcnt(0)
  buffer_store_dwordx4 v[36:39], v13, s[64:67], s50 offen sc1
G_END:
  s_endpgm
G_CODE_END:
.section .rodata,"a"
.p2align 6
.amdhsa_kernel f1_kernel
  .amdhsa_next_free_vgpr 148
  .amdhsa_next_free_sgpr 101
  .amdhsa_accum_offset 148
  .amdhsa_group_segment_fixed_size 0
  .amdhsa_kernarg_size 136
  .amdhsa_user_sgpr_count 2
  .amdhsa_user_sgpr_kernarg_segment_ptr 1
  .amdhsa_system_sgpr_workgroup_id_x 1
.end_amdhsa_kernel
.section .rodata,"a"
.p2align 6
.amdhsa_kernel g123_kernel
  .amdhsa_next_free_vgpr 512
  .amdhsa_next_free_sgpr 75
  .amdhsa_accum_offset 256
  .amdhsa_group_segment_fixed_size 0
  .amdhsa_kernarg_size 136
  .amdhsa_user_sgpr_count 2
  .amdhsa_user_sgpr_kernarg_segment_ptr 1
  .amdhsa_system_sgpr_workgroup_id_x 1
.end_amdhsa_kernel
```
